```python
import torch

def _softmax(x, axis=-1):
    return torch.softmax(x, dim=axis)

def _gelu(x):
    return torch.nn.functional.gelu(x, approximate='tanh')

def _silu(x):
    return torch.nn.functional.silu(x)

def _sigmoid(x):
    return torch.sigmoid(x)

def _layernorm(x, axis=-1, eps=1e-05):
    m = x.mean(dim=axis, keepdim=True)
    v = x.var(dim=axis, keepdim=True, unbiased=False)
    return (x - m) / torch.sqrt(v + eps)

def _scatter_add(tgt, idx, src, axis=0):
    return tgt.clone().index_add_(axis, idx, src)

def _segment_sum(src, seg, n):
    out = torch.zeros((n,) + src.shape[1:], dtype=src.dtype)
    return out.index_add_(0, seg, src)

def _pad(x, pw):
    flat = tuple((v for pair in reversed(pw) for v in pair))
    return torch.nn.functional.pad(x, flat)
kernel_name = 'interleave_layers__ssm_conv_h3__mixer_gmlp__prompt'

def setup_inputs():

    _w = lambda a: (lambda t: t.to(torch.bfloat16) if t.is_floating_point() else t)(torch.as_tensor(a))

    def _A_setup():
        B, S, D = (1, 2048, 640)
        ks = 4
        return {'q': _w((lambda *s: torch.randn(*s, dtype=torch.bfloat16) * 0.05)(B, S, D)), 'k': _w((lambda *s: torch.randn(*s, dtype=torch.bfloat16) * 0.8)(B, S, D)), 'v': _w((lambda *s: torch.randn(*s, dtype=torch.bfloat16) * 0.8)(B, S, D)), 'shift_k': _w((lambda *s: torch.randn(*s, dtype=torch.bfloat16) * 0.8)(D, ks) * 0.5), 'ssm_k': _w((lambda *s: torch.randn(*s, dtype=torch.bfloat16) * 0.8)(D, S) * (1.0 / S ** 0.5)), 'ssm_D': _w((lambda *s: torch.randn(*s, dtype=torch.bfloat16) * 0.8)(D))}
    _A_in = _A_setup()

    def _B_setup():
        B, S, D, F = (1, 2048, 640, 1536)
        Fh = F // 2
        return {'x': _w((lambda *s: torch.randn(*s, dtype=torch.bfloat16) * 0.05)(B, S, D)), 'w_in': _w((lambda *s: torch.randn(*s, dtype=torch.bfloat16) * 0.4)(D, 2 * Fh)), 'w_sp': _w(0.01 * (lambda *s: torch.randn(*s, dtype=torch.bfloat16) * 0.4)(S, S)), 'b_sp': _w(1.0 + 0.01 * (lambda *s: torch.randn(*s, dtype=torch.bfloat16) * 0.1)(S)), 'w_out': _w((lambda *s: torch.randn(*s, dtype=torch.bfloat16) * 0.1)(Fh, D))}
    _B_in = _B_setup()
    return {'A_q': _A_in['q'], 'A_k': _A_in['k'], 'A_v': _A_in['v'], 'A_shift_k': _A_in['shift_k'], 'A_ssm_k': _A_in['ssm_k'], 'A_ssm_D': _A_in['ssm_D'], 'B_x': _B_in['x'], 'B_w_in': _B_in['w_in'], 'B_w_sp': _B_in['w_sp'], 'B_b_sp': _B_in['b_sp'], 'B_w_out': _B_in['w_out']}

def reference(A_q, A_k, A_v, A_shift_k, A_ssm_k, A_ssm_D, B_x, B_w_in, B_w_sp, B_b_sp, B_w_out):

    def _A_ref(q, k, v, shift_k, ssm_k, ssm_D):
        B, S, D = q.shape
        ks = shift_k.shape[-1]
        k_pad = _pad(k, ((0, 0), (ks - 1, 0), (0, 0)))
        k_shift = torch.zeros_like(k)
        for t in range(ks):
            k_shift = k_shift + k_pad[:, t:t + S, :] * shift_k[:, ks - 1 - t][None, None, :]
        kv = k_shift * v
        L = 2 * S
        kv_pad = _pad(kv, ((0, 0), (0, S), (0, 0)))
        kf_pad = _pad(ssm_k, ((0, 0), (0, S)))
        kv_f = (lambda x, axes=(-2, -1): torch.fft.rfft2(x.float(), dim=axes))(kv_pad[:, None, :, :], axes=(1, 2))
        kf_f = (lambda x, axes=(-2, -1): torch.fft.rfft2(x.float(), dim=axes))(kf_pad[:, None, :], axes=(1, 2))
        kf_f = (lambda x, *d: x.permute(*d))(kf_f, 1, 2, 0)
        y_f = kv_f * kf_f[None, :, :, :]
        y = (lambda x, s, axes=(-2, -1): torch.fft.irfft2(x, s=s, dim=axes).to(torch.bfloat16))(y_f, (1, L), axes=(1, 2))[:, 0, :S, :]
        y = y + kv * ssm_D[None, None, :]
        return q * y

    def _B_ref(x, w_in, w_sp, b_sp, w_out):
        B, S, D = x.shape
        F = w_in.shape[-1]
        Fh = F // 2
        z = _gelu(torch.einsum('bsd,df->bsf', x, w_in))
        z1 = z[..., :Fh].clone()
        z2 = _layernorm(z[..., Fh:], axis=-1)
        g = torch.einsum('ts,bsf->btf', w_sp, z2) + b_sp[None, :, None]
        return torch.einsum('bsf,fd->bsd', z1 * g, w_out)
    x = A_q
    x = x + _A_ref(_layernorm(x, axis=-1), A_k, A_v, A_shift_k, A_ssm_k, A_ssm_D)
    x = x + _B_ref(_layernorm(x, axis=-1), B_w_in, B_w_sp, B_b_sp, B_w_out)
    x = x + _A_ref(_layernorm(x, axis=-1), A_k, A_v, A_shift_k, A_ssm_k, A_ssm_D)
    x = x + _B_ref(_layernorm(x, axis=-1), B_w_in, B_w_sp, B_b_sp, B_w_out)
    return x
```

```asm
; @launch kernel=prep_kernel grid=(696,1,1) block=(256,1,1) lds=8704
; @launch kernel=conv_kernel grid=(214,1,1) block=(256,1,1) lds=135552
; @launch kernel=g1f0_kernel grid=(256,1,1) block=(512,1,1) lds=147456
; @launch kernel=mid_kernel grid=(256,1,1) block=(512,1,1) lds=147456
; @launch kernel=last_kernel grid=(256,1,1) block=(512,1,1) lds=147456
.amdgcn_target "amdgcn-amd-amdhsa--gfx950"
.text
.globl prep_kernel
.p2align 8
.type prep_kernel,@function
prep_kernel:
  s_cmp_ge_u32 s2, 696
  s_cbranch_scc1 Lend_1
  s_load_dwordx16 s[16:31], s[0:1], 0
  s_load_dwordx8 s[32:39], s[0:1], 64
  s_load_dwordx4 s[40:43], s[0:1], 96
  v_and_b32 v1, 7, v0
  v_lshrrev_b32 v2, 3, v0
  s_waitcnt lgkmcnt(0)
  s_cmp_lt_u32 s2, 680
  s_cbranch_scc1 Lnz_6
  s_add_u32 s44, s42, 35651584
  s_addc_u32 s45, s43, 0
  s_mov_b32 s46, 65536
  s_mov_b32 s47, 0x20000
  s_sub_u32 s3, s2, 680
  s_lshl_b32 s3, s3, 12
  v_lshlrev_b32 v3, 4, v0
  v_mov_b32 v4, 0
  v_mov_b32 v5, 0
  v_mov_b32 v6, 0
  v_mov_b32 v7, 0
  buffer_store_dwordx4 v[4:7], v3, s[44:47], s3 offen
  s_getpc_b64 s[60:61]
  s_add_u32 s60, s60, 2048
  s_addc_u32 s61, s61, 0
  global_load_dwordx4 v[8:11], v3, s[60:61]
  s_add_u32 s60, s60, 4096
  s_addc_u32 s61, s61, 0
  global_load_dwordx4 v[12:15], v3, s[60:61]
  s_add_u32 s60, s60, 4096
  s_addc_u32 s61, s61, 0
  global_load_dwordx4 v[16:19], v3, s[60:61]
  s_add_u32 s60, s60, 4096
  s_addc_u32 s61, s61, 0
  s_waitcnt vmcnt(0)
  s_branch Lend_1
Lnz_6:
  s_cmp_ge_u32 s2, 320
  s_cbranch_scc1 Lw1_2
  s_mov_b32 s4, 0x1999999a
  s_mul_hi_u32 s5, s2, s4
  s_mul_i32 s6, s5, 10
  s_sub_u32 s6, s2, s6
  s_mov_b32 s44, s18
  s_mov_b32 s45, s19
  s_mov_b32 s46, 2621440
  s_mov_b32 s47, 0x20000
  s_mov_b32 s48, s20
  s_mov_b32 s49, s21
  s_mov_b32 s50, 2621440
  s_mov_b32 s51, 0x20000
  s_mov_b32 s56, s22
  s_mov_b32 s57, s23
  s_mov_b32 s58, 5120
  s_mov_b32 s59, 0x20000
  s_add_u32 s52, s42, 3145728
  s_addc_u32 s53, s43, 0
  s_mov_b32 s54, 2703360
  s_mov_b32 s55, 0x20000
  s_mul_i32 s7, s5, 64*1280
  s_lshl_b32 s8, s6, 7
  s_add_u32 s7, s7, s8
  v_mul_u32_u24 v3, 2560, v2
  v_lshl_add_u32 v3, v1, 4, v3
  v_add_u32 v3, s7, v3
  v_subrev_u32 v10, 3840, v3
  buffer_load_dwordx4 v[16:19], v10, s[44:47], 0 offen
  v_subrev_u32 v11, 2560, v3
  buffer_load_dwordx4 v[20:23], v11, s[44:47], 0 offen
  v_subrev_u32 v12, 1280, v3
  buffer_load_dwordx4 v[24:27], v12, s[44:47], 0 offen
  buffer_load_dwordx4 v[28:31], v3, s[44:47], 0 offen offset:0
  buffer_load_dwordx4 v[32:35], v3, s[44:47], 0 offen offset:1280
  buffer_load_dwordx4 v[36:39], v3, s[48:51], 0 offen offset:0
  buffer_load_dwordx4 v[40:43], v3, s[48:51], 0 offen offset:1280
  s_lshl_b32 s8, s6, 9
  v_lshlrev_b32 v5, 6, v1
  v_add_u32 v5, s8, v5
  buffer_load_dwordx4 v[44:47], v5, s[56:59], 0 offen offset:0
  buffer_load_dwordx4 v[48:51], v5, s[56:59], 0 offen offset:16
  buffer_load_dwordx4 v[52:55], v5, s[56:59], 0 offen offset:32
  buffer_load_dwordx4 v[56:59], v5, s[56:59], 0 offen offset:48
  s_waitcnt vmcnt(0)
  v_lshlrev_b32 v64, 16, v16
  v_lshlrev_b32 v65, 16, v20
  v_lshlrev_b32 v66, 16, v24
  v_lshlrev_b32 v67, 16, v28
  v_lshlrev_b32 v68, 16, v32
  v_lshlrev_b32 v74, 16, v36
  v_lshlrev_b32 v75, 16, v40
  v_lshlrev_b32 v70, 16, v44
  v_and_b32 v71, 0xffff0000, v44
  v_lshlrev_b32 v72, 16, v45
  v_and_b32 v73, 0xffff0000, v45
  v_mul_f32 v76, v64, v73
  v_mul_f32 v77, v65, v73
  v_cvt_pk_bf16_f32 v80, v76, v77
  v_lshlrev_b32 v76, 16, v80
  v_and_b32 v77, 0xffff0000, v80
  v_mul_f32 v78, v65, v72
  v_mul_f32 v79, v66, v72
  v_cvt_pk_bf16_f32 v80, v78, v79
  v_lshlrev_b32 v78, 16, v80
  v_and_b32 v79, 0xffff0000, v80
  v_add_f32 v76, v76, v78
  v_add_f32 v77, v77, v79
  v_cvt_pk_bf16_f32 v80, v76, v77
  v_lshlrev_b32 v76, 16, v80
  v_and_b32 v77, 0xffff0000, v80
  v_mul_f32 v78, v66, v71
  v_mul_f32 v79, v67, v71
  v_cvt_pk_bf16_f32 v80, v78, v79
  v_lshlrev_b32 v78, 16, v80
  v_and_b32 v79, 0xffff0000, v80
  v_add_f32 v76, v76, v78
  v_add_f32 v77, v77, v79
  v_cvt_pk_bf16_f32 v80, v76, v77
  v_lshlrev_b32 v76, 16, v80
  v_and_b32 v77, 0xffff0000, v80
  v_mul_f32 v78, v67, v70
  v_mul_f32 v79, v68, v70
  v_cvt_pk_bf16_f32 v80, v78, v79
  v_lshlrev_b32 v78, 16, v80
  v_and_b32 v79, 0xffff0000, v80
  v_add_f32 v76, v76, v78
  v_add_f32 v77, v77, v79
  v_cvt_pk_bf16_f32 v80, v76, v77
  v_lshlrev_b32 v76, 16, v80
  v_and_b32 v77, 0xffff0000, v80
  v_mul_f32 v76, v76, v74
  v_mul_f32 v77, v77, v75
  v_cvt_pk_bf16_f32 v84, v76, v77
  v_and_b32 v64, 0xffff0000, v16
  v_and_b32 v65, 0xffff0000, v20
  v_and_b32 v66, 0xffff0000, v24
  v_and_b32 v67, 0xffff0000, v28
  v_and_b32 v68, 0xffff0000, v32
  v_and_b32 v74, 0xffff0000, v36
  v_and_b32 v75, 0xffff0000, v40
  v_lshlrev_b32 v70, 16, v46
  v_and_b32 v71, 0xffff0000, v46
  v_lshlrev_b32 v72, 16, v47
  v_and_b32 v73, 0xffff0000, v47
  v_mul_f32 v76, v64, v73
  v_mul_f32 v77, v65, v73
  v_cvt_pk_bf16_f32 v80, v76, v77
  v_lshlrev_b32 v76, 16, v80
  v_and_b32 v77, 0xffff0000, v80
  v_mul_f32 v78, v65, v72
  v_mul_f32 v79, v66, v72
  v_cvt_pk_bf16_f32 v80, v78, v79
  v_lshlrev_b32 v78, 16, v80
  v_and_b32 v79, 0xffff0000, v80
  v_add_f32 v76, v76, v78
  v_add_f32 v77, v77, v79
  v_cvt_pk_bf16_f32 v80, v76, v77
  v_lshlrev_b32 v76, 16, v80
  v_and_b32 v77, 0xffff0000, v80
  v_mul_f32 v78, v66, v71
  v_mul_f32 v79, v67, v71
  v_cvt_pk_bf16_f32 v80, v78, v79
  v_lshlrev_b32 v78, 16, v80
  v_and_b32 v79, 0xffff0000, v80
  v_add_f32 v76, v76, v78
  v_add_f32 v77, v77, v79
  v_cvt_pk_bf16_f32 v80, v76, v77
  v_lshlrev_b32 v76, 16, v80
  v_and_b32 v77, 0xffff0000, v80
  v_mul_f32 v78, v67, v70
  v_mul_f32 v79, v68, v70
  v_cvt_pk_bf16_f32 v80, v78, v79
  v_lshlrev_b32 v78, 16, v80
  v_and_b32 v79, 0xffff0000, v80
  v_add_f32 v76, v76, v78
  v_add_f32 v77, v77, v79
  v_cvt_pk_bf16_f32 v80, v76, v77
  v_lshlrev_b32 v76, 16, v80
  v_and_b32 v77, 0xffff0000, v80
  v_mul_f32 v76, v76, v74
  v_mul_f32 v77, v77, v75
  v_cvt_pk_bf16_f32 v85, v76, v77
  v_lshlrev_b32 v64, 16, v17
  v_lshlrev_b32 v65, 16, v21
  v_lshlrev_b32 v66, 16, v25
  v_lshlrev_b32 v67, 16, v29
  v_lshlrev_b32 v68, 16, v33
  v_lshlrev_b32 v74, 16, v37
  v_lshlrev_b32 v75, 16, v41
  v_lshlrev_b32 v70, 16, v48
  v_and_b32 v71, 0xffff0000, v48
  v_lshlrev_b32 v72, 16, v49
  v_and_b32 v73, 0xffff0000, v49
  v_mul_f32 v76, v64, v73
  v_mul_f32 v77, v65, v73
  v_cvt_pk_bf16_f32 v80, v76, v77
  v_lshlrev_b32 v76, 16, v80
  v_and_b32 v77, 0xffff0000, v80
  v_mul_f32 v78, v65, v72
  v_mul_f32 v79, v66, v72
  v_cvt_pk_bf16_f32 v80, v78, v79
  v_lshlrev_b32 v78, 16, v80
  v_and_b32 v79, 0xffff0000, v80
  v_add_f32 v76, v76, v78
  v_add_f32 v77, v77, v79
  v_cvt_pk_bf16_f32 v80, v76, v77
  v_lshlrev_b32 v76, 16, v80
  v_and_b32 v77, 0xffff0000, v80
  v_mul_f32 v78, v66, v71
  v_mul_f32 v79, v67, v71
  v_cvt_pk_bf16_f32 v80, v78, v79
  v_lshlrev_b32 v78, 16, v80
  v_and_b32 v79, 0xffff0000, v80
  v_add_f32 v76, v76, v78
  v_add_f32 v77, v77, v79
  v_cvt_pk_bf16_f32 v80, v76, v77
  v_lshlrev_b32 v76, 16, v80
  v_and_b32 v77, 0xffff0000, v80
  v_mul_f32 v78, v67, v70
  v_mul_f32 v79, v68, v70
  v_cvt_pk_bf16_f32 v80, v78, v79
  v_lshlrev_b32 v78, 16, v80
  v_and_b32 v79, 0xffff0000, v80
  v_add_f32 v76, v76, v78
  v_add_f32 v77, v77, v79
  v_cvt_pk_bf16_f32 v80, v76, v77
  v_lshlrev_b32 v76, 16, v80
  v_and_b32 v77, 0xffff0000, v80
  v_mul_f32 v76, v76, v74
  v_mul_f32 v77, v77, v75
  v_cvt_pk_bf16_f32 v86, v76, v77
  v_and_b32 v64, 0xffff0000, v17
  v_and_b32 v65, 0xffff0000, v21
  v_and_b32 v66, 0xffff0000, v25
  v_and_b32 v67, 0xffff0000, v29
  v_and_b32 v68, 0xffff0000, v33
  v_and_b32 v74, 0xffff0000, v37
  v_and_b32 v75, 0xffff0000, v41
  v_lshlrev_b32 v70, 16, v50
  v_and_b32 v71, 0xffff0000, v50
  v_lshlrev_b32 v72, 16, v51
  v_and_b32 v73, 0xffff0000, v51
  v_mul_f32 v76, v64, v73
  v_mul_f32 v77, v65, v73
  v_cvt_pk_bf16_f32 v80, v76, v77
  v_lshlrev_b32 v76, 16, v80
  v_and_b32 v77, 0xffff0000, v80
  v_mul_f32 v78, v65, v72
  v_mul_f32 v79, v66, v72
  v_cvt_pk_bf16_f32 v80, v78, v79
  v_lshlrev_b32 v78, 16, v80
  v_and_b32 v79, 0xffff0000, v80
  v_add_f32 v76, v76, v78
  v_add_f32 v77, v77, v79
  v_cvt_pk_bf16_f32 v80, v76, v77
  v_lshlrev_b32 v76, 16, v80
  v_and_b32 v77, 0xffff0000, v80
  v_mul_f32 v78, v66, v71
  v_mul_f32 v79, v67, v71
  v_cvt_pk_bf16_f32 v80, v78, v79
  v_lshlrev_b32 v78, 16, v80
  v_and_b32 v79, 0xffff0000, v80
  v_add_f32 v76, v76, v78
  v_add_f32 v77, v77, v79
  v_cvt_pk_bf16_f32 v80, v76, v77
  v_lshlrev_b32 v76, 16, v80
  v_and_b32 v77, 0xffff0000, v80
  v_mul_f32 v78, v67, v70
  v_mul_f32 v79, v68, v70
  v_cvt_pk_bf16_f32 v80, v78, v79
  v_lshlrev_b32 v78, 16, v80
  v_and_b32 v79, 0xffff0000, v80
  v_add_f32 v76, v76, v78
  v_add_f32 v77, v77, v79
  v_cvt_pk_bf16_f32 v80, v76, v77
  v_lshlrev_b32 v76, 16, v80
  v_and_b32 v77, 0xffff0000, v80
  v_mul_f32 v76, v76, v74
  v_mul_f32 v77, v77, v75
  v_cvt_pk_bf16_f32 v87, v76, v77
  v_lshlrev_b32 v64, 16, v18
  v_lshlrev_b32 v65, 16, v22
  v_lshlrev_b32 v66, 16, v26
  v_lshlrev_b32 v67, 16, v30
  v_lshlrev_b32 v68, 16, v34
  v_lshlrev_b32 v74, 16, v38
  v_lshlrev_b32 v75, 16, v42
  v_lshlrev_b32 v70, 16, v52
  v_and_b32 v71, 0xffff0000, v52
  v_lshlrev_b32 v72, 16, v53
  v_and_b32 v73, 0xffff0000, v53
  v_mul_f32 v76, v64, v73
  v_mul_f32 v77, v65, v73
  v_cvt_pk_bf16_f32 v80, v76, v77
  v_lshlrev_b32 v76, 16, v80
  v_and_b32 v77, 0xffff0000, v80
  v_mul_f32 v78, v65, v72
  v_mul_f32 v79, v66, v72
  v_cvt_pk_bf16_f32 v80, v78, v79
  v_lshlrev_b32 v78, 16, v80
  v_and_b32 v79, 0xffff0000, v80
  v_add_f32 v76, v76, v78
  v_add_f32 v77, v77, v79
  v_cvt_pk_bf16_f32 v80, v76, v77
  v_lshlrev_b32 v76, 16, v80
  v_and_b32 v77, 0xffff0000, v80
  v_mul_f32 v78, v66, v71
  v_mul_f32 v79, v67, v71
  v_cvt_pk_bf16_f32 v80, v78, v79
  v_lshlrev_b32 v78, 16, v80
  v_and_b32 v79, 0xffff0000, v80
  v_add_f32 v76, v76, v78
  v_add_f32 v77, v77, v79
  v_cvt_pk_bf16_f32 v80, v76, v77
  v_lshlrev_b32 v76, 16, v80
  v_and_b32 v77, 0xffff0000, v80
  v_mul_f32 v78, v67, v70
  v_mul_f32 v79, v68, v70
  v_cvt_pk_bf16_f32 v80, v78, v79
  v_lshlrev_b32 v78, 16, v80
  v_and_b32 v79, 0xffff0000, v80
  v_add_f32 v76, v76, v78
  v_add_f32 v77, v77, v79
  v_cvt_pk_bf16_f32 v80, v76, v77
  v_lshlrev_b32 v76, 16, v80
  v_and_b32 v77, 0xffff0000, v80
  v_mul_f32 v76, v76, v74
  v_mul_f32 v77, v77, v75
  v_cvt_pk_bf16_f32 v88, v76, v77
  v_and_b32 v64, 0xffff0000, v18
  v_and_b32 v65, 0xffff0000, v22
  v_and_b32 v66, 0xffff0000, v26
  v_and_b32 v67, 0xffff0000, v30
  v_and_b32 v68, 0xffff0000, v34
  v_and_b32 v74, 0xffff0000, v38
  v_and_b32 v75, 0xffff0000, v42
  v_lshlrev_b32 v70, 16, v54
  v_and_b32 v71, 0xffff0000, v54
  v_lshlrev_b32 v72, 16, v55
  v_and_b32 v73, 0xffff0000, v55
  v_mul_f32 v76, v64, v73
  v_mul_f32 v77, v65, v73
  v_cvt_pk_bf16_f32 v80, v76, v77
  v_lshlrev_b32 v76, 16, v80
  v_and_b32 v77, 0xffff0000, v80
  v_mul_f32 v78, v65, v72
  v_mul_f32 v79, v66, v72
  v_cvt_pk_bf16_f32 v80, v78, v79
  v_lshlrev_b32 v78, 16, v80
  v_and_b32 v79, 0xffff0000, v80
  v_add_f32 v76, v76, v78
  v_add_f32 v77, v77, v79
  v_cvt_pk_bf16_f32 v80, v76, v77
  v_lshlrev_b32 v76, 16, v80
  v_and_b32 v77, 0xffff0000, v80
  v_mul_f32 v78, v66, v71
  v_mul_f32 v79, v67, v71
  v_cvt_pk_bf16_f32 v80, v78, v79
  v_lshlrev_b32 v78, 16, v80
  v_and_b32 v79, 0xffff0000, v80
  v_add_f32 v76, v76, v78
  v_add_f32 v77, v77, v79
  v_cvt_pk_bf16_f32 v80, v76, v77
  v_lshlrev_b32 v76, 16, v80
  v_and_b32 v77, 0xffff0000, v80
  v_mul_f32 v78, v67, v70
  v_mul_f32 v79, v68, v70
  v_cvt_pk_bf16_f32 v80, v78, v79
  v_lshlrev_b32 v78, 16, v80
  v_and_b32 v79, 0xffff0000, v80
  v_add_f32 v76, v76, v78
  v_add_f32 v77, v77, v79
  v_cvt_pk_bf16_f32 v80, v76, v77
  v_lshlrev_b32 v76, 16, v80
  v_and_b32 v77, 0xffff0000, v80
  v_mul_f32 v76, v76, v74
  v_mul_f32 v77, v77, v75
  v_cvt_pk_bf16_f32 v89, v76, v77
  v_lshlrev_b32 v64, 16, v19
  v_lshlrev_b32 v65, 16, v23
  v_lshlrev_b32 v66, 16, v27
  v_lshlrev_b32 v67, 16, v31
  v_lshlrev_b32 v68, 16, v35
  v_lshlrev_b32 v74, 16, v39
  v_lshlrev_b32 v75, 16, v43
  v_lshlrev_b32 v70, 16, v56
  v_and_b32 v71, 0xffff0000, v56
  v_lshlrev_b32 v72, 16, v57
  v_and_b32 v73, 0xffff0000, v57
  v_mul_f32 v76, v64, v73
  v_mul_f32 v77, v65, v73
  v_cvt_pk_bf16_f32 v80, v76, v77
  v_lshlrev_b32 v76, 16, v80
  v_and_b32 v77, 0xffff0000, v80
  v_mul_f32 v78, v65, v72
  v_mul_f32 v79, v66, v72
  v_cvt_pk_bf16_f32 v80, v78, v79
  v_lshlrev_b32 v78, 16, v80
  v_and_b32 v79, 0xffff0000, v80
  v_add_f32 v76, v76, v78
  v_add_f32 v77, v77, v79
  v_cvt_pk_bf16_f32 v80, v76, v77
  v_lshlrev_b32 v76, 16, v80
  v_and_b32 v77, 0xffff0000, v80
  v_mul_f32 v78, v66, v71
  v_mul_f32 v79, v67, v71
  v_cvt_pk_bf16_f32 v80, v78, v79
  v_lshlrev_b32 v78, 16, v80
  v_and_b32 v79, 0xffff0000, v80
  v_add_f32 v76, v76, v78
  v_add_f32 v77, v77, v79
  v_cvt_pk_bf16_f32 v80, v76, v77
  v_lshlrev_b32 v76, 16, v80
  v_and_b32 v77, 0xffff0000, v80
  v_mul_f32 v78, v67, v70
  v_mul_f32 v79, v68, v70
  v_cvt_pk_bf16_f32 v80, v78, v79
  v_lshlrev_b32 v78, 16, v80
  v_and_b32 v79, 0xffff0000, v80
  v_add_f32 v76, v76, v78
  v_add_f32 v77, v77, v79
  v_cvt_pk_bf16_f32 v80, v76, v77
  v_lshlrev_b32 v76, 16, v80
  v_and_b32 v77, 0xffff0000, v80
  v_mul_f32 v76, v76, v74
  v_mul_f32 v77, v77, v75
  v_cvt_pk_bf16_f32 v90, v76, v77
  v_and_b32 v64, 0xffff0000, v19
  v_and_b32 v65, 0xffff0000, v23
  v_and_b32 v66, 0xffff0000, v27
  v_and_b32 v67, 0xffff0000, v31
  v_and_b32 v68, 0xffff0000, v35
  v_and_b32 v74, 0xffff0000, v39
  v_and_b32 v75, 0xffff0000, v43
  v_lshlrev_b32 v70, 16, v58
  v_and_b32 v71, 0xffff0000, v58
  v_lshlrev_b32 v72, 16, v59
  v_and_b32 v73, 0xffff0000, v59
  v_mul_f32 v76, v64, v73
  v_mul_f32 v77, v65, v73
  v_cvt_pk_bf16_f32 v80, v76, v77
  v_lshlrev_b32 v76, 16, v80
  v_and_b32 v77, 0xffff0000, v80
  v_mul_f32 v78, v65, v72
  v_mul_f32 v79, v66, v72
  v_cvt_pk_bf16_f32 v80, v78, v79
  v_lshlrev_b32 v78, 16, v80
  v_and_b32 v79, 0xffff0000, v80
  v_add_f32 v76, v76, v78
  v_add_f32 v77, v77, v79
  v_cvt_pk_bf16_f32 v80, v76, v77
  v_lshlrev_b32 v76, 16, v80
  v_and_b32 v77, 0xffff0000, v80
  v_mul_f32 v78, v66, v71
  v_mul_f32 v79, v67, v71
  v_cvt_pk_bf16_f32 v80, v78, v79
  v_lshlrev_b32 v78, 16, v80
  v_and_b32 v79, 0xffff0000, v80
  v_add_f32 v76, v76, v78
  v_add_f32 v77, v77, v79
  v_cvt_pk_bf16_f32 v80, v76, v77
  v_lshlrev_b32 v76, 16, v80
  v_and_b32 v77, 0xffff0000, v80
  v_mul_f32 v78, v67, v70
  v_mul_f32 v79, v68, v70
  v_cvt_pk_bf16_f32 v80, v78, v79
  v_lshlrev_b32 v78, 16, v80
  v_and_b32 v79, 0xffff0000, v80
  v_add_f32 v76, v76, v78
  v_add_f32 v77, v77, v79
  v_cvt_pk_bf16_f32 v80, v76, v77
  v_lshlrev_b32 v76, 16, v80
  v_and_b32 v77, 0xffff0000, v80
  v_mul_f32 v76, v76, v74
  v_mul_f32 v77, v77, v75
  v_cvt_pk_bf16_f32 v91, v76, v77
  s_mov_b32 s60, 4224
  s_mul_i32 s61, s6, 270336
  s_lshl_b32 s8, s5, 7
  s_add_u32 s61, s61, s8
  s_branch Ltr2_5
Lw1_2:
  s_cmp_ge_u32 s2, 560
  s_cbranch_scc1 Lw2_3
  s_sub_u32 s3, s2, 320
  s_mov_b32 s4, 0x0aaaaaab
  s_mul_hi_u32 s5, s3, s4
  s_mul_i32 s6, s5, 24
  s_sub_u32 s6, s3, s6
  s_mov_b32 s44, s30
  s_mov_b32 s45, s31
  s_mov_b32 s46, 1966080
  s_mov_b32 s47, 0x20000
  s_mov_b32 s52, s42
  s_mov_b32 s53, s43
  s_mov_b32 s54, 1966080
  s_mov_b32 s55, 0x20000
  s_mov_b32 s9, 3072
  s_mul_i32 s7, s5, 64*3072
  s_lshl_b32 s8, s6, 7
  s_add_u32 s7, s7, s8
  s_mov_b32 s60, 1280
  s_mul_i32 s61, s6, 64*1280
  s_lshl_b32 s8, s5, 7
  s_add_u32 s61, s61, s8
  s_branch Ltr_4
Lw2_3:
  s_sub_u32 s3, s2, 560
  s_mov_b32 s4, 0x1999999a
  s_mul_hi_u32 s5, s3, s4
  s_mul_i32 s6, s5, 10
  s_sub_u32 s6, s3, s6
  s_mov_b32 s44, s36
  s_mov_b32 s45, s37
  s_mov_b32 s46, 983040
  s_mov_b32 s47, 0x20000
  s_add_u32 s52, s42, 2097152
  s_addc_u32 s53, s43, 0
  s_mov_b32 s54, 983040
  s_mov_b32 s55, 0x20000
  s_mov_b32 s9, 1280
  s_mul_i32 s7, s5, 64*1280
  s_lshl_b32 s8, s6, 7
  s_add_u32 s7, s7, s8
  s_mov_b32 s60, 1536
  s_mul_i32 s61, s6, 64*1536
  s_lshl_b32 s8, s5, 7
  s_add_u32 s61, s61, s8
Ltr_4:
  v_lshlrev_b32 v3, 1, v2
  v_mul_lo_u32 v3, v3, s9
  v_lshl_add_u32 v3, v1, 4, v3
  v_add_u32 v3, s7, v3
  v_add_u32 v4, s9, v3
  buffer_load_dwordx4 v[16:19], v3, s[44:47], 0 offen
  buffer_load_dwordx4 v[20:23], v4, s[44:47], 0 offen
  s_mov_b32 s10, 0x05040100
  s_mov_b32 s11, 0x07060302
  s_waitcnt vmcnt(0)
  v_perm_b32 v84, v20, v16, s10
  v_perm_b32 v85, v20, v16, s11
  v_perm_b32 v86, v21, v17, s10
  v_perm_b32 v87, v21, v17, s11
  v_perm_b32 v88, v22, v18, s10
  v_perm_b32 v89, v22, v18, s11
  v_perm_b32 v90, v23, v19, s10
  v_perm_b32 v91, v23, v19, s11
Ltr2_5:
  v_mul_u32_u24 v5, 1088, v1
  v_lshl_add_u32 v5, v2, 2, v5
  ds_write_b32 v5, v84 offset:0
  ds_write_b32 v5, v85 offset:136
  ds_write_b32 v5, v86 offset:272
  ds_write_b32 v5, v87 offset:408
  ds_write_b32 v5, v88 offset:544
  ds_write_b32 v5, v89 offset:680
  ds_write_b32 v5, v90 offset:816
  ds_write_b32 v5, v91 offset:952
  v_lshrrev_b32 v6, 2, v0
  v_and_b32 v7, 3, v0
  v_mul_u32_u24 v8, 136, v6
  v_lshl_add_u32 v8, v7, 5, v8
  v_mul_lo_u32 v9, v6, s60
  v_lshl_add_u32 v9, v7, 5, v9
  v_add_u32 v9, s61, v9
  s_waitcnt lgkmcnt(0)
  s_barrier
  ds_read_b64 v[16:17], v8 offset:0
  ds_read_b64 v[18:19], v8 offset:8
  ds_read_b64 v[20:21], v8 offset:16
  ds_read_b64 v[22:23], v8 offset:24
  s_waitcnt lgkmcnt(0)
  buffer_store_dwordx4 v[16:19], v9, s[52:55], 0 offen
  buffer_store_dwordx4 v[20:23], v9, s[52:55], 0 offen offset:16
Lend_1:
  s_endpgm
.globl conv_kernel
.p2align 8
.type conv_kernel,@function
conv_kernel:
  s_cmp_ge_u32 s2, 214
  s_cbranch_scc1 Lend_7
  s_load_dwordx16 s[16:31], s[0:1], 0
  s_load_dwordx8 s[32:39], s[0:1], 64
  s_load_dwordx4 s[40:43], s[0:1], 96
  v_lshrrev_b32 v1, 6, v0
  v_and_b32 v0, 63, v0
  s_nop 0
  v_readfirstlane_b32 s3, v1
  s_nop 3
  s_cmp_eq_u32 s3, 3
  s_cbranch_scc1 Lwarm_8
  s_mul_i32 s4, s2, 3
  s_add_u32 s4, s4, s3
  s_cmp_ge_u32 s4, 640
  s_cbranch_scc1 Lend_7
  s_mul_i32 s5, s3, 45184
  s_lshl_b32 s6, s4, 12
  s_mul_i32 s13, s4, 4224
  s_waitcnt lgkmcnt(0)
  s_add_u32 s44, s24, s6
  s_addc_u32 s45, s25, 0
  s_mov_b32 s46, 4096
  s_mov_b32 s47, 0x20000
  s_add_u32 s48, s42, 3145728
  s_addc_u32 s49, s43, 0
  s_mov_b32 s50, 2703360
  s_mov_b32 s51, 0x20000
  s_add_u32 s52, s42, 6291456
  s_addc_u32 s53, s43, 0
  s_mov_b32 s54, 2703360
  s_mov_b32 s55, 0x20000
  s_mov_b32 s56, s26
  s_mov_b32 s57, s27
  s_mov_b32 s58, 1280
  s_mov_b32 s59, 0x20000
  v_lshlrev_b32 v2, 4, v0
  buffer_load_dwordx4 v[140:143], v2, s[44:47], 0 offen offset:0
  buffer_load_dwordx4 v[144:147], v2, s[44:47], 0 offen offset:16
  buffer_load_dwordx4 v[148:151], v2, s[44:47], 0 offen offset:1024
  buffer_load_dwordx4 v[152:155], v2, s[44:47], 0 offen offset:1040
  buffer_load_dwordx4 v[156:159], v2, s[44:47], 0 offen offset:2048
  buffer_load_dwordx4 v[160:163], v2, s[44:47], 0 offen offset:2064
  buffer_load_dwordx4 v[164:167], v2, s[44:47], 0 offen offset:3072
  buffer_load_dwordx4 v[168:171], v2, s[44:47], 0 offen offset:3088
  buffer_load_dwordx4 v[100:103], v2, s[48:51], s13 offen offset:0
  buffer_load_dwordx4 v[104:107], v2, s[48:51], s13 offen offset:1024
  buffer_load_dwordx4 v[108:111], v2, s[48:51], s13 offen offset:2048
  buffer_load_dwordx4 v[112:115], v2, s[48:51], s13 offen offset:3072
  v_lshrrev_b32 v3, 3, v0
  v_and_b32 v4, 7, v0
  v_add_u32 v3, v3, v4
  v_subrev_u32 v3, 7, v3
  v_max_i32 v4, 0, v3
  v_lshlrev_b32 v4, 1, v4
  buffer_load_ushort v5, v4, s[44:47], 0 offen
  s_lshl_b32 s7, s4, 1
  v_mov_b32 v6, 0
  buffer_load_ushort v7, v6, s[56:59], s7 offen
  v_and_b32 v8, 15, v0
  v_lshrrev_b32 v9, 4, v0
  v_lshlrev_b32 v10, 2, v9
  v_and_b32 v11, 2, v9
  v_lshlrev_b32 v11, 1, v11
  v_xor_b32 v10, v10, v11
  v_sub_u32 v18, 15, v8
  v_mul_u32_u24 v18, 96, v18
  v_lshlrev_b32 v19, 1, v10
  v_sub_u32 v18, v18, v19
  v_add_u32 v18, s5, v18
  v_add_u32 v18, 37528, v18
  v_lshlrev_b32 v10, 1, v10
  v_lshl_add_u32 v10, v8, 6, v10
  v_add_u32 v10, s5, v10
  v_mov_b32 v12, 0
  v_mov_b32 v13, 0
  v_mov_b32 v14, 0
  v_mov_b32 v15, 0
  v_min_u32 v16, 26, v0
  v_lshlrev_b32 v16, 4, v16
  v_add_u32 v16, s5, v16
  ds_write_b128 v16, v[12:15]
  v_lshlrev_b32 v16, 4, v0
  v_add_u32 v16, s5, v16
  ds_write_b128 v16, v[12:15] offset:43648
  v_min_u32 v16, 25, v0
  v_lshlrev_b32 v16, 4, v16
  v_add_u32 v16, s5, v16
  ds_write_b128 v16, v[12:15] offset:44672
  v_mul_u32_u24 v16, 144, v0
  v_add_u32 v16, s5, v16
  s_waitcnt vmcnt(12)
  v_alignbit_b32 v20, v141, v140, 16
  v_alignbit_b32 v21, v142, v141, 16
  v_alignbit_b32 v22, v143, v142, 16
  v_alignbit_b32 v23, v144, v143, 16
  v_alignbit_b32 v24, v145, v144, 16
  v_alignbit_b32 v25, v146, v145, 16
  v_alignbit_b32 v26, v147, v146, 16
  v_alignbit_b32 v30, v142, v141, 16
  v_mov_b32 v40, v141
  v_alignbit_b32 v31, v143, v142, 16
  v_mov_b32 v41, v142
  v_alignbit_b32 v32, v144, v143, 16
  v_mov_b32 v42, v143
  v_alignbit_b32 v33, v145, v144, 16
  v_mov_b32 v43, v144
  v_alignbit_b32 v34, v146, v145, 16
  v_mov_b32 v44, v145
  v_alignbit_b32 v35, v147, v146, 16
  v_mov_b32 v45, v146
  ds_write_b128 v16, v[140:143] offset:544
  ds_write_b128 v16, v[20:23] offset:576
  ds_write_b128 v16, v[40:43] offset:592
  ds_write_b128 v16, v[30:33] offset:608
  ds_write_b128 v16, v[142:145] offset:624
  ds_write_b128 v16, v[22:25] offset:640
  ds_write_b128 v16, v[42:45] offset:656
  ds_write_b128 v16, v[32:35] offset:672
  s_nop 1
  s_waitcnt vmcnt(10)
  v_alignbit_b32 v20, v149, v148, 16
  v_alignbit_b32 v21, v150, v149, 16
  v_alignbit_b32 v22, v151, v150, 16
  v_alignbit_b32 v23, v152, v151, 16
  v_alignbit_b32 v24, v153, v152, 16
  v_alignbit_b32 v25, v154, v153, 16
  v_alignbit_b32 v26, v155, v154, 16
  v_alignbit_b32 v30, v150, v149, 16
  v_mov_b32 v40, v149
  v_alignbit_b32 v31, v151, v150, 16
  v_mov_b32 v41, v150
  v_alignbit_b32 v32, v152, v151, 16
  v_mov_b32 v42, v151
  v_alignbit_b32 v33, v153, v152, 16
  v_mov_b32 v43, v152
  v_alignbit_b32 v34, v154, v153, 16
  v_mov_b32 v44, v153
  v_alignbit_b32 v35, v155, v154, 16
  v_mov_b32 v45, v154
  ds_write_b128 v16, v[148:151] offset:9760
  ds_write_b128 v16, v[20:23] offset:9792
  ds_write_b128 v16, v[40:43] offset:9808
  ds_write_b128 v16, v[30:33] offset:9824
  ds_write_b128 v16, v[150:153] offset:9840
  ds_write_b128 v16, v[22:25] offset:9856
  ds_write_b128 v16, v[42:45] offset:9872
  ds_write_b128 v16, v[32:35] offset:9888
  s_nop 1
  s_waitcnt vmcnt(8)
  v_alignbit_b32 v20, v157, v156, 16
  v_alignbit_b32 v21, v158, v157, 16
  v_alignbit_b32 v22, v159, v158, 16
  v_alignbit_b32 v23, v160, v159, 16
  v_alignbit_b32 v24, v161, v160, 16
  v_alignbit_b32 v25, v162, v161, 16
  v_alignbit_b32 v26, v163, v162, 16
  v_alignbit_b32 v30, v158, v157, 16
  v_mov_b32 v40, v157
  v_alignbit_b32 v31, v159, v158, 16
  v_mov_b32 v41, v158
  v_alignbit_b32 v32, v160, v159, 16
  v_mov_b32 v42, v159
  v_alignbit_b32 v33, v161, v160, 16
  v_mov_b32 v43, v160
  v_alignbit_b32 v34, v162, v161, 16
  v_mov_b32 v44, v161
  v_alignbit_b32 v35, v163, v162, 16
  v_mov_b32 v45, v162
  ds_write_b128 v16, v[156:159] offset:18976
  ds_write_b128 v16, v[20:23] offset:19008
  ds_write_b128 v16, v[40:43] offset:19024
  ds_write_b128 v16, v[30:33] offset:19040
  ds_write_b128 v16, v[158:161] offset:19056
  ds_write_b128 v16, v[22:25] offset:19072
  ds_write_b128 v16, v[42:45] offset:19088
  ds_write_b128 v16, v[32:35] offset:19104
  s_nop 1
  s_waitcnt vmcnt(6)
  v_alignbit_b32 v20, v165, v164, 16
  v_alignbit_b32 v21, v166, v165, 16
  v_alignbit_b32 v22, v167, v166, 16
  v_alignbit_b32 v23, v168, v167, 16
  v_alignbit_b32 v24, v169, v168, 16
  v_alignbit_b32 v25, v170, v169, 16
  v_alignbit_b32 v26, v171, v170, 16
  v_alignbit_b32 v30, v166, v165, 16
  v_mov_b32 v40, v165
  v_alignbit_b32 v31, v167, v166, 16
  v_mov_b32 v41, v166
  v_alignbit_b32 v32, v168, v167, 16
  v_mov_b32 v42, v167
  v_alignbit_b32 v33, v169, v168, 16
  v_mov_b32 v43, v168
  v_alignbit_b32 v34, v170, v169, 16
  v_mov_b32 v44, v169
  v_alignbit_b32 v35, v171, v170, 16
  v_mov_b32 v45, v170
  ds_write_b128 v16, v[164:167] offset:28192
  ds_write_b128 v16, v[20:23] offset:28224
  ds_write_b128 v16, v[40:43] offset:28240
  ds_write_b128 v16, v[30:33] offset:28256
  ds_write_b128 v16, v[166:169] offset:28272
  ds_write_b128 v16, v[22:25] offset:28288
  ds_write_b128 v16, v[42:45] offset:28304
  ds_write_b128 v16, v[32:35] offset:28320
  s_nop 1
  s_waitcnt vmcnt(0)
  s_barrier
  v_cmp_gt_i32 vcc, 0, v3
  s_nop 1
  v_cndmask_b32 v5, v5, v12, vcc
  v_lshlrev_b32 v16, 1, v0
  v_add_u32 v16, s5, v16
  ds_write_b16 v16, v5 offset:432
  v_sub_u32 v16, 63, v0
  v_lshrrev_b32 v17, 2, v16
  v_and_b32 v16, 3, v16
  v_mul_u32_u24 v17, 96, v17
  v_lshl_add_u32 v17, v16, 4, v17
  v_add_u32 v17, s5, v17
  v_alignbit_b32 v48, v103, v103, 16
  v_alignbit_b32 v49, v102, v102, 16
  v_alignbit_b32 v50, v101, v101, 16
  v_alignbit_b32 v51, v100, v100, 16
  ds_write_b128 v17, v[48:51] offset:42112
  v_alignbit_b32 v52, v107, v107, 16
  v_alignbit_b32 v53, v106, v106, 16
  v_alignbit_b32 v54, v105, v105, 16
  v_alignbit_b32 v55, v104, v104, 16
  ds_write_b128 v17, v[52:55] offset:40576
  v_alignbit_b32 v56, v111, v111, 16
  v_alignbit_b32 v57, v110, v110, 16
  v_alignbit_b32 v58, v109, v109, 16
  v_alignbit_b32 v59, v108, v108, 16
  ds_write_b128 v17, v[56:59] offset:39040
  v_alignbit_b32 v60, v115, v115, 16
  v_alignbit_b32 v61, v114, v114, 16
  v_alignbit_b32 v62, v113, v113, 16
  v_alignbit_b32 v63, v112, v112, 16
  ds_write_b128 v17, v[60:63] offset:37504
  v_lshrrev_b32 v16, 1, v8
  v_and_b32 v16, 4, v16
  v_xor_b32 v16, v8, v16
  v_lshl_add_u32 v16, v9, 3, v16
  v_lshrrev_b32 v17, 3, v16
  v_add_u32 v16, v16, v17
  v_lshlrev_b32 v16, 4, v16
  v_add_u32 v16, s5, v16
  v_sub_u32 v17, 15, v8
  v_mul_u32_u24 v17, 96, v17
  v_lshl_add_u32 v17, v9, 4, v17
  v_add_u32 v17, s5, v17
  v_add_u32 v17, 37504, v17
  v_mov_b32 v64, 0
  v_mov_b32 v65, 0
  v_mov_b32 v66, 0
  v_mov_b32 v67, 0
  v_mov_b32 v68, 0
  v_mov_b32 v69, 0
  v_mov_b32 v70, 0
  v_mov_b32 v71, 0
  v_mov_b32 v72, 0
  v_mov_b32 v73, 0
  v_mov_b32 v74, 0
  v_mov_b32 v75, 0
  v_mov_b32 v76, 0
  v_mov_b32 v77, 0
  v_mov_b32 v78, 0
  v_mov_b32 v79, 0
  v_mov_b32 v80, 0
  v_mov_b32 v81, 0
  v_mov_b32 v82, 0
  v_mov_b32 v83, 0
  v_mov_b32 v84, 0
  v_mov_b32 v85, 0
  v_mov_b32 v86, 0
  v_mov_b32 v87, 0
  v_mov_b32 v88, 0
  v_mov_b32 v89, 0
  v_mov_b32 v90, 0
  v_mov_b32 v91, 0
  v_mov_b32 v92, 0
  v_mov_b32 v93, 0
  v_mov_b32 v94, 0
  v_mov_b32 v95, 0
  v_mov_b32 v164, 0
  v_mov_b32 v165, 0
  v_mov_b32 v166, 0
  v_mov_b32 v167, 0
  v_mov_b32 v168, 0
  v_mov_b32 v169, 0
  v_mov_b32 v170, 0
  v_mov_b32 v171, 0
  v_mov_b32 v172, 0
  v_mov_b32 v173, 0
  v_mov_b32 v174, 0
  v_mov_b32 v175, 0
  v_mov_b32 v176, 0
  v_mov_b32 v177, 0
  v_mov_b32 v178, 0
  v_mov_b32 v179, 0
  s_waitcnt lgkmcnt(0)
  ds_read_b128 v[20:23], v16 offset:0
  ds_read_b128 v[24:27], v16 offset:288
  ds_read_b128 v[28:31], v17 offset:4608
  ds_read_b128 v[32:35], v17 offset:3072
  ds_read_b128 v[36:39], v17 offset:1536
  ds_read_b128 v[40:43], v17 offset:0
  ds_read_b128 v[140:143], v16 offset:576
  ds_read_b128 v[144:147], v16 offset:864
  ds_read_b128 v[148:151], v17 offset:4704
  ds_read_b128 v[152:155], v17 offset:3168
  ds_read_b128 v[156:159], v17 offset:1632
  ds_read_b128 v[160:163], v17 offset:96
  ds_read_b128 v[96:99], v16 offset:1152
  ds_read_b128 v[100:103], v16 offset:1440
  ds_read_b128 v[104:107], v17 offset:4800
  ds_read_b128 v[108:111], v17 offset:3264
  ds_read_b128 v[112:115], v17 offset:1728
  ds_read_b128 v[116:119], v17 offset:192
  s_waitcnt lgkmcnt(12)
  v_mfma_f32_16x16x32_bf16 v[64:67], v[20:23], v[28:31], v[64:67]
  v_mfma_f32_16x16x32_bf16 v[68:71], v[24:27], v[28:31], v[68:71]
  v_mfma_f32_16x16x32_bf16 v[72:75], v[20:23], v[32:35], v[72:75]
  v_mfma_f32_16x16x32_bf16 v[76:79], v[24:27], v[32:35], v[76:79]
  v_mfma_f32_16x16x32_bf16 v[80:83], v[20:23], v[36:39], v[80:83]
  v_mfma_f32_16x16x32_bf16 v[84:87], v[24:27], v[36:39], v[84:87]
  v_mfma_f32_16x16x32_bf16 v[88:91], v[20:23], v[40:43], v[88:91]
  v_mfma_f32_16x16x32_bf16 v[92:95], v[24:27], v[40:43], v[92:95]
  ds_read_b128 v[20:23], v16 offset:1728
  ds_read_b128 v[24:27], v16 offset:2016
  ds_read_b128 v[28:31], v17 offset:4896
  ds_read_b128 v[32:35], v17 offset:3360
  ds_read_b128 v[36:39], v17 offset:1824
  ds_read_b128 v[40:43], v17 offset:288
  s_waitcnt lgkmcnt(12)
  v_mfma_f32_16x16x32_bf16 v[64:67], v[140:143], v[148:151], v[64:67]
  v_mfma_f32_16x16x32_bf16 v[68:71], v[144:147], v[148:151], v[68:71]
  v_mfma_f32_16x16x32_bf16 v[72:75], v[140:143], v[152:155], v[72:75]
  v_mfma_f32_16x16x32_bf16 v[76:79], v[144:147], v[152:155], v[76:79]
  v_mfma_f32_16x16x32_bf16 v[80:83], v[140:143], v[156:159], v[80:83]
  v_mfma_f32_16x16x32_bf16 v[84:87], v[144:147], v[156:159], v[84:87]
  v_mfma_f32_16x16x32_bf16 v[88:91], v[140:143], v[160:163], v[88:91]
  v_mfma_f32_16x16x32_bf16 v[92:95], v[144:147], v[160:163], v[92:95]
  ds_read_b128 v[140:143], v16 offset:2304
  ds_read_b128 v[144:147], v16 offset:2592
  ds_read_b128 v[148:151], v17 offset:4992
  ds_read_b128 v[152:155], v17 offset:3456
  ds_read_b128 v[156:159], v17 offset:1920
  ds_read_b128 v[160:163], v17 offset:384
  s_waitcnt lgkmcnt(12)
  v_mfma_f32_16x16x32_bf16 v[64:67], v[96:99], v[104:107], v[64:67]
  v_mfma_f32_16x16x32_bf16 v[68:71], v[100:103], v[104:107], v[68:71]
  v_mfma_f32_16x16x32_bf16 v[72:75], v[96:99], v[108:111], v[72:75]
  v_mfma_f32_16x16x32_bf16 v[76:79], v[100:103], v[108:111], v[76:79]
  v_mfma_f32_16x16x32_bf16 v[80:83], v[96:99], v[112:115], v[80:83]
  v_mfma_f32_16x16x32_bf16 v[84:87], v[100:103], v[112:115], v[84:87]
  v_mfma_f32_16x16x32_bf16 v[88:91], v[96:99], v[116:119], v[88:91]
  v_mfma_f32_16x16x32_bf16 v[92:95], v[100:103], v[116:119], v[92:95]
  ds_read_b128 v[96:99], v16 offset:2880
  ds_read_b128 v[100:103], v16 offset:3168
  ds_read_b128 v[104:107], v17 offset:5088
  ds_read_b128 v[108:111], v17 offset:3552
  ds_read_b128 v[112:115], v17 offset:2016
  ds_read_b128 v[116:119], v17 offset:480
  s_waitcnt lgkmcnt(12)
  v_mfma_f32_16x16x32_bf16 v[64:67], v[20:23], v[28:31], v[64:67]
  v_mfma_f32_16x16x32_bf16 v[68:71], v[24:27], v[28:31], v[68:71]
  v_mfma_f32_16x16x32_bf16 v[72:75], v[20:23], v[32:35], v[72:75]
  v_mfma_f32_16x16x32_bf16 v[76:79], v[24:27], v[32:35], v[76:79]
  v_mfma_f32_16x16x32_bf16 v[80:83], v[20:23], v[36:39], v[80:83]
  v_mfma_f32_16x16x32_bf16 v[84:87], v[24:27], v[36:39], v[84:87]
  v_mfma_f32_16x16x32_bf16 v[88:91], v[20:23], v[40:43], v[88:91]
  v_mfma_f32_16x16x32_bf16 v[92:95], v[24:27], v[40:43], v[92:95]
  ds_read_b128 v[20:23], v16 offset:3456
  ds_read_b128 v[24:27], v16 offset:3744
  ds_read_b128 v[28:31], v17 offset:5184
  ds_read_b128 v[32:35], v17 offset:3648
  ds_read_b128 v[36:39], v17 offset:2112
  ds_read_b128 v[40:43], v17 offset:576
  s_waitcnt lgkmcnt(12)
  v_mfma_f32_16x16x32_bf16 v[64:67], v[140:143], v[148:151], v[64:67]
  v_mfma_f32_16x16x32_bf16 v[68:71], v[144:147], v[148:151], v[68:71]
  v_mfma_f32_16x16x32_bf16 v[72:75], v[140:143], v[152:155], v[72:75]
  v_mfma_f32_16x16x32_bf16 v[76:79], v[144:147], v[152:155], v[76:79]
  v_mfma_f32_16x16x32_bf16 v[80:83], v[140:143], v[156:159], v[80:83]
  v_mfma_f32_16x16x32_bf16 v[84:87], v[144:147], v[156:159], v[84:87]
  v_mfma_f32_16x16x32_bf16 v[88:91], v[140:143], v[160:163], v[88:91]
  v_mfma_f32_16x16x32_bf16 v[92:95], v[144:147], v[160:163], v[92:95]
  ds_read_b128 v[140:143], v16 offset:4032
  ds_read_b128 v[144:147], v16 offset:4320
  ds_read_b128 v[148:151], v17 offset:5280
  ds_read_b128 v[152:155], v17 offset:3744
  ds_read_b128 v[156:159], v17 offset:2208
  ds_read_b128 v[160:163], v17 offset:672
  s_waitcnt lgkmcnt(12)
  v_mfma_f32_16x16x32_bf16 v[64:67], v[96:99], v[104:107], v[64:67]
  v_mfma_f32_16x16x32_bf16 v[68:71], v[100:103], v[104:107], v[68:71]
  v_mfma_f32_16x16x32_bf16 v[72:75], v[96:99], v[108:111], v[72:75]
  v_mfma_f32_16x16x32_bf16 v[76:79], v[100:103], v[108:111], v[76:79]
  v_mfma_f32_16x16x32_bf16 v[80:83], v[96:99], v[112:115], v[80:83]
  v_mfma_f32_16x16x32_bf16 v[84:87], v[100:103], v[112:115], v[84:87]
  v_mfma_f32_16x16x32_bf16 v[88:91], v[96:99], v[116:119], v[88:91]
  v_mfma_f32_16x16x32_bf16 v[92:95], v[100:103], v[116:119], v[92:95]
  ds_read_b128 v[96:99], v16 offset:4608
  ds_read_b128 v[100:103], v16 offset:4896
  ds_read_b128 v[104:107], v17 offset:5376
  ds_read_b128 v[108:111], v17 offset:3840
  ds_read_b128 v[112:115], v17 offset:2304
  ds_read_b128 v[116:119], v17 offset:768
  s_waitcnt lgkmcnt(12)
  v_mfma_f32_16x16x32_bf16 v[64:67], v[20:23], v[28:31], v[64:67]
  v_mfma_f32_16x16x32_bf16 v[68:71], v[24:27], v[28:31], v[68:71]
  v_mfma_f32_16x16x32_bf16 v[72:75], v[20:23], v[32:35], v[72:75]
  v_mfma_f32_16x16x32_bf16 v[76:79], v[24:27], v[32:35], v[76:79]
  v_mfma_f32_16x16x32_bf16 v[80:83], v[20:23], v[36:39], v[80:83]
  v_mfma_f32_16x16x32_bf16 v[84:87], v[24:27], v[36:39], v[84:87]
  v_mfma_f32_16x16x32_bf16 v[88:91], v[20:23], v[40:43], v[88:91]
  v_mfma_f32_16x16x32_bf16 v[92:95], v[24:27], v[40:43], v[92:95]
  ds_read_b128 v[20:23], v16 offset:5184
  ds_read_b128 v[24:27], v16 offset:5472
  ds_read_b128 v[28:31], v17 offset:5472
  ds_read_b128 v[32:35], v17 offset:3936
  ds_read_b128 v[36:39], v17 offset:2400
  ds_read_b128 v[40:43], v17 offset:864
  s_waitcnt lgkmcnt(12)
  v_mfma_f32_16x16x32_bf16 v[64:67], v[140:143], v[148:151], v[64:67]
  v_mfma_f32_16x16x32_bf16 v[68:71], v[144:147], v[148:151], v[68:71]
  v_mfma_f32_16x16x32_bf16 v[72:75], v[140:143], v[152:155], v[72:75]
  v_mfma_f32_16x16x32_bf16 v[76:79], v[144:147], v[152:155], v[76:79]
  v_mfma_f32_16x16x32_bf16 v[80:83], v[140:143], v[156:159], v[80:83]
  v_mfma_f32_16x16x32_bf16 v[84:87], v[144:147], v[156:159], v[84:87]
  v_mfma_f32_16x16x32_bf16 v[88:91], v[140:143], v[160:163], v[88:91]
  v_mfma_f32_16x16x32_bf16 v[92:95], v[144:147], v[160:163], v[92:95]
  ds_read_b128 v[140:143], v16 offset:5760
  ds_read_b128 v[144:147], v16 offset:6048
  ds_read_b128 v[148:151], v17 offset:5568
  ds_read_b128 v[152:155], v17 offset:4032
  ds_read_b128 v[156:159], v17 offset:2496
  ds_read_b128 v[160:163], v17 offset:960
  s_waitcnt lgkmcnt(12)
  v_mfma_f32_16x16x32_bf16 v[64:67], v[96:99], v[104:107], v[64:67]
  v_mfma_f32_16x16x32_bf16 v[68:71], v[100:103], v[104:107], v[68:71]
  v_mfma_f32_16x16x32_bf16 v[72:75], v[96:99], v[108:111], v[72:75]
  v_mfma_f32_16x16x32_bf16 v[76:79], v[100:103], v[108:111], v[76:79]
  v_mfma_f32_16x16x32_bf16 v[80:83], v[96:99], v[112:115], v[80:83]
  v_mfma_f32_16x16x32_bf16 v[84:87], v[100:103], v[112:115], v[84:87]
  v_mfma_f32_16x16x32_bf16 v[88:91], v[96:99], v[116:119], v[88:91]
  v_mfma_f32_16x16x32_bf16 v[92:95], v[100:103], v[116:119], v[92:95]
  ds_read_b128 v[96:99], v16 offset:6336
  ds_read_b128 v[100:103], v16 offset:6624
  ds_read_b128 v[104:107], v17 offset:5664
  ds_read_b128 v[108:111], v17 offset:4128
  ds_read_b128 v[112:115], v17 offset:2592
  ds_read_b128 v[116:119], v17 offset:1056
  s_waitcnt lgkmcnt(12)
  v_mfma_f32_16x16x32_bf16 v[64:67], v[20:23], v[28:31], v[64:67]
  v_mfma_f32_16x16x32_bf16 v[68:71], v[24:27], v[28:31], v[68:71]
  v_mfma_f32_16x16x32_bf16 v[72:75], v[20:23], v[32:35], v[72:75]
  v_mfma_f32_16x16x32_bf16 v[76:79], v[24:27], v[32:35], v[76:79]
  v_mfma_f32_16x16x32_bf16 v[80:83], v[20:23], v[36:39], v[80:83]
  v_mfma_f32_16x16x32_bf16 v[84:87], v[24:27], v[36:39], v[84:87]
  v_mfma_f32_16x16x32_bf16 v[88:91], v[20:23], v[40:43], v[88:91]
  v_mfma_f32_16x16x32_bf16 v[92:95], v[24:27], v[40:43], v[92:95]
  ds_read_b128 v[20:23], v16 offset:6912
  ds_read_b128 v[24:27], v16 offset:7200
  ds_read_b128 v[28:31], v17 offset:5760
  ds_read_b128 v[32:35], v17 offset:4224
  ds_read_b128 v[36:39], v17 offset:2688
  ds_read_b128 v[40:43], v17 offset:1152
  s_waitcnt lgkmcnt(12)
  v_mfma_f32_16x16x32_bf16 v[64:67], v[140:143], v[148:151], v[64:67]
  v_mfma_f32_16x16x32_bf16 v[68:71], v[144:147], v[148:151], v[68:71]
  v_mfma_f32_16x16x32_bf16 v[72:75], v[140:143], v[152:155], v[72:75]
  v_mfma_f32_16x16x32_bf16 v[76:79], v[144:147], v[152:155], v[76:79]
  v_mfma_f32_16x16x32_bf16 v[80:83], v[140:143], v[156:159], v[80:83]
  v_mfma_f32_16x16x32_bf16 v[84:87], v[144:147], v[156:159], v[84:87]
  v_mfma_f32_16x16x32_bf16 v[88:91], v[140:143], v[160:163], v[88:91]
  v_mfma_f32_16x16x32_bf16 v[92:95], v[144:147], v[160:163], v[92:95]
  ds_read_b128 v[140:143], v16 offset:7488
  ds_read_b128 v[144:147], v16 offset:7776
  ds_read_b128 v[148:151], v17 offset:5856
  ds_read_b128 v[152:155], v17 offset:4320
  ds_read_b128 v[156:159], v17 offset:2784
  ds_read_b128 v[160:163], v17 offset:1248
  s_waitcnt lgkmcnt(12)
  v_mfma_f32_16x16x32_bf16 v[64:67], v[96:99], v[104:107], v[64:67]
  v_mfma_f32_16x16x32_bf16 v[68:71], v[100:103], v[104:107], v[68:71]
  v_mfma_f32_16x16x32_bf16 v[72:75], v[96:99], v[108:111], v[72:75]
  v_mfma_f32_16x16x32_bf16 v[76:79], v[100:103], v[108:111], v[76:79]
  v_mfma_f32_16x16x32_bf16 v[80:83], v[96:99], v[112:115], v[80:83]
  v_mfma_f32_16x16x32_bf16 v[84:87], v[100:103], v[112:115], v[84:87]
  v_mfma_f32_16x16x32_bf16 v[88:91], v[96:99], v[116:119], v[88:91]
  v_mfma_f32_16x16x32_bf16 v[92:95], v[100:103], v[116:119], v[92:95]
  ds_read_b128 v[96:99], v16 offset:8064
  ds_read_b128 v[100:103], v16 offset:8352
  ds_read_b128 v[104:107], v17 offset:5952
  ds_read_b128 v[108:111], v17 offset:4416
  ds_read_b128 v[112:115], v17 offset:2880
  ds_read_b128 v[116:119], v17 offset:1344
  s_waitcnt lgkmcnt(12)
  v_mfma_f32_16x16x32_bf16 v[64:67], v[20:23], v[28:31], v[64:67]
  v_mfma_f32_16x16x32_bf16 v[68:71], v[24:27], v[28:31], v[68:71]
  v_mfma_f32_16x16x32_bf16 v[72:75], v[20:23], v[32:35], v[72:75]
  v_mfma_f32_16x16x32_bf16 v[76:79], v[24:27], v[32:35], v[76:79]
  v_mfma_f32_16x16x32_bf16 v[80:83], v[20:23], v[36:39], v[80:83]
  v_mfma_f32_16x16x32_bf16 v[84:87], v[24:27], v[36:39], v[84:87]
  v_mfma_f32_16x16x32_bf16 v[88:91], v[20:23], v[40:43], v[88:91]
  v_mfma_f32_16x16x32_bf16 v[92:95], v[24:27], v[40:43], v[92:95]
  ds_read_b128 v[20:23], v16 offset:8640
  ds_read_b128 v[24:27], v16 offset:8928
  ds_read_b128 v[28:31], v17 offset:6048
  ds_read_b128 v[32:35], v17 offset:4512
  ds_read_b128 v[36:39], v17 offset:2976
  ds_read_b128 v[40:43], v17 offset:1440
  s_waitcnt lgkmcnt(12)
  v_mfma_f32_16x16x32_bf16 v[64:67], v[140:143], v[148:151], v[64:67]
  v_mfma_f32_16x16x32_bf16 v[68:71], v[144:147], v[148:151], v[68:71]
  v_mfma_f32_16x16x32_bf16 v[72:75], v[140:143], v[152:155], v[72:75]
  v_mfma_f32_16x16x32_bf16 v[76:79], v[144:147], v[152:155], v[76:79]
  v_mfma_f32_16x16x32_bf16 v[80:83], v[140:143], v[156:159], v[80:83]
  v_mfma_f32_16x16x32_bf16 v[84:87], v[144:147], v[156:159], v[84:87]
  v_mfma_f32_16x16x32_bf16 v[88:91], v[140:143], v[160:163], v[88:91]
  v_mfma_f32_16x16x32_bf16 v[92:95], v[144:147], v[160:163], v[92:95]
  ds_read_b128 v[140:143], v16 offset:9216
  ds_read_b128 v[144:147], v16 offset:9504
  ds_read_b128 v[152:155], v17 offset:4608
  ds_read_b128 v[156:159], v17 offset:3072
  ds_read_b128 v[160:163], v17 offset:1536
  s_waitcnt lgkmcnt(11)
  v_mfma_f32_16x16x32_bf16 v[64:67], v[96:99], v[104:107], v[64:67]
  v_mfma_f32_16x16x32_bf16 v[68:71], v[100:103], v[104:107], v[68:71]
  v_mfma_f32_16x16x32_bf16 v[72:75], v[96:99], v[108:111], v[72:75]
  v_mfma_f32_16x16x32_bf16 v[76:79], v[100:103], v[108:111], v[76:79]
  v_mfma_f32_16x16x32_bf16 v[80:83], v[96:99], v[112:115], v[80:83]
  v_mfma_f32_16x16x32_bf16 v[84:87], v[100:103], v[112:115], v[84:87]
  v_mfma_f32_16x16x32_bf16 v[88:91], v[96:99], v[116:119], v[88:91]
  v_mfma_f32_16x16x32_bf16 v[92:95], v[100:103], v[116:119], v[92:95]
  ds_read_b128 v[96:99], v16 offset:9792
  ds_read_b128 v[100:103], v16 offset:10080
  ds_read_b128 v[108:111], v17 offset:4704
  ds_read_b128 v[112:115], v17 offset:3168
  ds_read_b128 v[116:119], v17 offset:1632
  s_waitcnt lgkmcnt(10)
  v_mfma_f32_16x16x32_bf16 v[64:67], v[20:23], v[28:31], v[64:67]
  v_mfma_f32_16x16x32_bf16 v[68:71], v[24:27], v[28:31], v[68:71]
  v_mfma_f32_16x16x32_bf16 v[72:75], v[20:23], v[32:35], v[72:75]
  v_mfma_f32_16x16x32_bf16 v[76:79], v[24:27], v[32:35], v[76:79]
  v_mfma_f32_16x16x32_bf16 v[80:83], v[20:23], v[36:39], v[80:83]
  v_mfma_f32_16x16x32_bf16 v[84:87], v[24:27], v[36:39], v[84:87]
  v_mfma_f32_16x16x32_bf16 v[88:91], v[20:23], v[40:43], v[88:91]
  v_mfma_f32_16x16x32_bf16 v[92:95], v[24:27], v[40:43], v[92:95]
  ds_read_b128 v[20:23], v16 offset:10368
  ds_read_b128 v[24:27], v16 offset:10656
  ds_read_b128 v[32:35], v17 offset:4800
  ds_read_b128 v[36:39], v17 offset:3264
  ds_read_b128 v[40:43], v17 offset:1728
  s_waitcnt lgkmcnt(10)
  v_mfma_f32_16x16x32_bf16 v[72:75], v[140:143], v[152:155], v[72:75]
  v_mfma_f32_16x16x32_bf16 v[76:79], v[144:147], v[152:155], v[76:79]
  v_mfma_f32_16x16x32_bf16 v[80:83], v[140:143], v[156:159], v[80:83]
  v_mfma_f32_16x16x32_bf16 v[84:87], v[144:147], v[156:159], v[84:87]
  v_mfma_f32_16x16x32_bf16 v[88:91], v[140:143], v[160:163], v[88:91]
  v_mfma_f32_16x16x32_bf16 v[92:95], v[144:147], v[160:163], v[92:95]
  ds_read_b128 v[140:143], v16 offset:10944
  ds_read_b128 v[144:147], v16 offset:11232
  ds_read_b128 v[152:155], v17 offset:4896
  ds_read_b128 v[156:159], v17 offset:3360
  ds_read_b128 v[160:163], v17 offset:1824
  s_waitcnt lgkmcnt(10)
  v_mfma_f32_16x16x32_bf16 v[72:75], v[96:99], v[108:111], v[72:75]
  v_mfma_f32_16x16x32_bf16 v[76:79], v[100:103], v[108:111], v[76:79]
  v_mfma_f32_16x16x32_bf16 v[80:83], v[96:99], v[112:115], v[80:83]
  v_mfma_f32_16x16x32_bf16 v[84:87], v[100:103], v[112:115], v[84:87]
  v_mfma_f32_16x16x32_bf16 v[88:91], v[96:99], v[116:119], v[88:91]
  v_mfma_f32_16x16x32_bf16 v[92:95], v[100:103], v[116:119], v[92:95]
  ds_read_b128 v[96:99], v16 offset:11520
  ds_read_b128 v[100:103], v16 offset:11808
  ds_read_b128 v[108:111], v17 offset:4992
  ds_read_b128 v[112:115], v17 offset:3456
  ds_read_b128 v[116:119], v17 offset:1920
  s_waitcnt lgkmcnt(10)
  v_mfma_f32_16x16x32_bf16 v[72:75], v[20:23], v[32:35], v[72:75]
  v_mfma_f32_16x16x32_bf16 v[76:79], v[24:27], v[32:35], v[76:79]
  v_mfma_f32_16x16x32_bf16 v[80:83], v[20:23], v[36:39], v[80:83]
  v_mfma_f32_16x16x32_bf16 v[84:87], v[24:27], v[36:39], v[84:87]
  v_mfma_f32_16x16x32_bf16 v[88:91], v[20:23], v[40:43], v[88:91]
  v_mfma_f32_16x16x32_bf16 v[92:95], v[24:27], v[40:43], v[92:95]
  ds_read_b128 v[20:23], v16 offset:12096
  ds_read_b128 v[24:27], v16 offset:12384
  ds_read_b128 v[32:35], v17 offset:5088
  ds_read_b128 v[36:39], v17 offset:3552
  ds_read_b128 v[40:43], v17 offset:2016
  s_waitcnt lgkmcnt(10)
  v_mfma_f32_16x16x32_bf16 v[72:75], v[140:143], v[152:155], v[72:75]
  v_mfma_f32_16x16x32_bf16 v[76:79], v[144:147], v[152:155], v[76:79]
  v_mfma_f32_16x16x32_bf16 v[80:83], v[140:143], v[156:159], v[80:83]
  v_mfma_f32_16x16x32_bf16 v[84:87], v[144:147], v[156:159], v[84:87]
  v_mfma_f32_16x16x32_bf16 v[88:91], v[140:143], v[160:163], v[88:91]
  v_mfma_f32_16x16x32_bf16 v[92:95], v[144:147], v[160:163], v[92:95]
  ds_read_b128 v[140:143], v16 offset:12672
  ds_read_b128 v[144:147], v16 offset:12960
  ds_read_b128 v[152:155], v17 offset:5184
  ds_read_b128 v[156:159], v17 offset:3648
  ds_read_b128 v[160:163], v17 offset:2112
  s_waitcnt lgkmcnt(10)
  v_mfma_f32_16x16x32_bf16 v[72:75], v[96:99], v[108:111], v[72:75]
  v_mfma_f32_16x16x32_bf16 v[76:79], v[100:103], v[108:111], v[76:79]
  v_mfma_f32_16x16x32_bf16 v[80:83], v[96:99], v[112:115], v[80:83]
  v_mfma_f32_16x16x32_bf16 v[84:87], v[100:103], v[112:115], v[84:87]
  v_mfma_f32_16x16x32_bf16 v[88:91], v[96:99], v[116:119], v[88:91]
  v_mfma_f32_16x16x32_bf16 v[92:95], v[100:103], v[116:119], v[92:95]
  ds_read_b128 v[96:99], v16 offset:13248
  ds_read_b128 v[100:103], v16 offset:13536
  ds_read_b128 v[108:111], v17 offset:5280
  ds_read_b128 v[112:115], v17 offset:3744
  ds_read_b128 v[116:119], v17 offset:2208
  s_waitcnt lgkmcnt(10)
  v_mfma_f32_16x16x32_bf16 v[72:75], v[20:23], v[32:35], v[72:75]
  v_mfma_f32_16x16x32_bf16 v[76:79], v[24:27], v[32:35], v[76:79]
  v_mfma_f32_16x16x32_bf16 v[80:83], v[20:23], v[36:39], v[80:83]
  v_mfma_f32_16x16x32_bf16 v[84:87], v[24:27], v[36:39], v[84:87]
  v_mfma_f32_16x16x32_bf16 v[88:91], v[20:23], v[40:43], v[88:91]
  v_mfma_f32_16x16x32_bf16 v[92:95], v[24:27], v[40:43], v[92:95]
  ds_read_b128 v[20:23], v16 offset:13824
  ds_read_b128 v[24:27], v16 offset:14112
  ds_read_b128 v[32:35], v17 offset:5376
  ds_read_b128 v[36:39], v17 offset:3840
  ds_read_b128 v[40:43], v17 offset:2304
  s_waitcnt lgkmcnt(10)
  v_mfma_f32_16x16x32_bf16 v[72:75], v[140:143], v[152:155], v[72:75]
  v_mfma_f32_16x16x32_bf16 v[76:79], v[144:147], v[152:155], v[76:79]
  v_mfma_f32_16x16x32_bf16 v[80:83], v[140:143], v[156:159], v[80:83]
  v_mfma_f32_16x16x32_bf16 v[84:87], v[144:147], v[156:159], v[84:87]
  v_mfma_f32_16x16x32_bf16 v[88:91], v[140:143], v[160:163], v[88:91]
  v_mfma_f32_16x16x32_bf16 v[92:95], v[144:147], v[160:163], v[92:95]
  ds_read_b128 v[140:143], v16 offset:14400
  ds_read_b128 v[144:147], v16 offset:14688
  ds_read_b128 v[152:155], v17 offset:5472
  ds_read_b128 v[156:159], v17 offset:3936
  ds_read_b128 v[160:163], v17 offset:2400
  s_waitcnt lgkmcnt(10)
  v_mfma_f32_16x16x32_bf16 v[72:75], v[96:99], v[108:111], v[72:75]
  v_mfma_f32_16x16x32_bf16 v[76:79], v[100:103], v[108:111], v[76:79]
  v_mfma_f32_16x16x32_bf16 v[80:83], v[96:99], v[112:115], v[80:83]
  v_mfma_f32_16x16x32_bf16 v[84:87], v[100:103], v[112:115], v[84:87]
  v_mfma_f32_16x16x32_bf16 v[88:91], v[96:99], v[116:119], v[88:91]
  v_mfma_f32_16x16x32_bf16 v[92:95], v[100:103], v[116:119], v[92:95]
  ds_read_b128 v[96:99], v16 offset:14976
  ds_read_b128 v[100:103], v16 offset:15264
  ds_read_b128 v[108:111], v17 offset:5568
  ds_read_b128 v[112:115], v17 offset:4032
  ds_read_b128 v[116:119], v17 offset:2496
  s_waitcnt lgkmcnt(10)
  v_mfma_f32_16x16x32_bf16 v[72:75], v[20:23], v[32:35], v[72:75]
  v_mfma_f32_16x16x32_bf16 v[76:79], v[24:27], v[32:35], v[76:79]
  v_mfma_f32_16x16x32_bf16 v[80:83], v[20:23], v[36:39], v[80:83]
  v_mfma_f32_16x16x32_bf16 v[84:87], v[24:27], v[36:39], v[84:87]
  v_mfma_f32_16x16x32_bf16 v[88:91], v[20:23], v[40:43], v[88:91]
  v_mfma_f32_16x16x32_bf16 v[92:95], v[24:27], v[40:43], v[92:95]
  ds_read_b128 v[20:23], v16 offset:15552
  ds_read_b128 v[24:27], v16 offset:15840
  ds_read_b128 v[32:35], v17 offset:5664
  ds_read_b128 v[36:39], v17 offset:4128
  ds_read_b128 v[40:43], v17 offset:2592
  s_waitcnt lgkmcnt(10)
  v_mfma_f32_16x16x32_bf16 v[72:75], v[140:143], v[152:155], v[72:75]
  v_mfma_f32_16x16x32_bf16 v[76:79], v[144:147], v[152:155], v[76:79]
  v_mfma_f32_16x16x32_bf16 v[80:83], v[140:143], v[156:159], v[80:83]
  v_mfma_f32_16x16x32_bf16 v[84:87], v[144:147], v[156:159], v[84:87]
  v_mfma_f32_16x16x32_bf16 v[88:91], v[140:143], v[160:163], v[88:91]
  v_mfma_f32_16x16x32_bf16 v[92:95], v[144:147], v[160:163], v[92:95]
  ds_read_b128 v[140:143], v16 offset:16128
  ds_read_b128 v[144:147], v16 offset:16416
  ds_read_b128 v[152:155], v17 offset:5760
  ds_read_b128 v[156:159], v17 offset:4224
  ds_read_b128 v[160:163], v17 offset:2688
  s_waitcnt lgkmcnt(10)
  v_mfma_f32_16x16x32_bf16 v[72:75], v[96:99], v[108:111], v[72:75]
  v_mfma_f32_16x16x32_bf16 v[76:79], v[100:103], v[108:111], v[76:79]
  v_mfma_f32_16x16x32_bf16 v[80:83], v[96:99], v[112:115], v[80:83]
  v_mfma_f32_16x16x32_bf16 v[84:87], v[100:103], v[112:115], v[84:87]
  v_mfma_f32_16x16x32_bf16 v[88:91], v[96:99], v[116:119], v[88:91]
  v_mfma_f32_16x16x32_bf16 v[92:95], v[100:103], v[116:119], v[92:95]
  ds_read_b128 v[96:99], v16 offset:16704
  ds_read_b128 v[100:103], v16 offset:16992
  ds_read_b128 v[108:111], v17 offset:5856
  ds_read_b128 v[112:115], v17 offset:4320
  ds_read_b128 v[116:119], v17 offset:2784
  s_waitcnt lgkmcnt(10)
  v_mfma_f32_16x16x32_bf16 v[72:75], v[20:23], v[32:35], v[72:75]
  v_mfma_f32_16x16x32_bf16 v[76:79], v[24:27], v[32:35], v[76:79]
  v_mfma_f32_16x16x32_bf16 v[80:83], v[20:23], v[36:39], v[80:83]
  v_mfma_f32_16x16x32_bf16 v[84:87], v[24:27], v[36:39], v[84:87]
  v_mfma_f32_16x16x32_bf16 v[88:91], v[20:23], v[40:43], v[88:91]
  v_mfma_f32_16x16x32_bf16 v[92:95], v[24:27], v[40:43], v[92:95]
  ds_read_b128 v[20:23], v16 offset:17280
  ds_read_b128 v[24:27], v16 offset:17568
  ds_read_b128 v[32:35], v17 offset:5952
  ds_read_b128 v[36:39], v17 offset:4416
  ds_read_b128 v[40:43], v17 offset:2880
  s_waitcnt lgkmcnt(10)
  v_mfma_f32_16x16x32_bf16 v[72:75], v[140:143], v[152:155], v[72:75]
  v_mfma_f32_16x16x32_bf16 v[76:79], v[144:147], v[152:155], v[76:79]
  v_mfma_f32_16x16x32_bf16 v[80:83], v[140:143], v[156:159], v[80:83]
  v_mfma_f32_16x16x32_bf16 v[84:87], v[144:147], v[156:159], v[84:87]
  v_mfma_f32_16x16x32_bf16 v[88:91], v[140:143], v[160:163], v[88:91]
  v_mfma_f32_16x16x32_bf16 v[92:95], v[144:147], v[160:163], v[92:95]
  ds_read_b128 v[140:143], v16 offset:17856
  ds_read_b128 v[144:147], v16 offset:18144
  ds_read_b128 v[152:155], v17 offset:6048
  ds_read_b128 v[156:159], v17 offset:4512
  ds_read_b128 v[160:163], v17 offset:2976
  s_waitcnt lgkmcnt(10)
  v_mfma_f32_16x16x32_bf16 v[72:75], v[96:99], v[108:111], v[72:75]
  v_mfma_f32_16x16x32_bf16 v[76:79], v[100:103], v[108:111], v[76:79]
  v_mfma_f32_16x16x32_bf16 v[80:83], v[96:99], v[112:115], v[80:83]
  v_mfma_f32_16x16x32_bf16 v[84:87], v[100:103], v[112:115], v[84:87]
  v_mfma_f32_16x16x32_bf16 v[88:91], v[96:99], v[116:119], v[88:91]
  v_mfma_f32_16x16x32_bf16 v[92:95], v[100:103], v[116:119], v[92:95]
  ds_read_b128 v[96:99], v16 offset:18432
  ds_read_b128 v[100:103], v16 offset:18720
  ds_read_b128 v[112:115], v17 offset:4608
  ds_read_b128 v[116:119], v17 offset:3072
  s_waitcnt lgkmcnt(9)
  v_mfma_f32_16x16x32_bf16 v[72:75], v[20:23], v[32:35], v[72:75]
  v_mfma_f32_16x16x32_bf16 v[76:79], v[24:27], v[32:35], v[76:79]
  v_mfma_f32_16x16x32_bf16 v[80:83], v[20:23], v[36:39], v[80:83]
  v_mfma_f32_16x16x32_bf16 v[84:87], v[24:27], v[36:39], v[84:87]
  v_mfma_f32_16x16x32_bf16 v[88:91], v[20:23], v[40:43], v[88:91]
  v_mfma_f32_16x16x32_bf16 v[92:95], v[24:27], v[40:43], v[92:95]
  ds_read_b128 v[20:23], v16 offset:19008
  ds_read_b128 v[24:27], v16 offset:19296
  ds_read_b128 v[36:39], v17 offset:4704
  ds_read_b128 v[40:43], v17 offset:3168
  s_waitcnt lgkmcnt(8)
  v_mfma_f32_16x16x32_bf16 v[72:75], v[140:143], v[152:155], v[72:75]
  v_mfma_f32_16x16x32_bf16 v[76:79], v[144:147], v[152:155], v[76:79]
  v_mfma_f32_16x16x32_bf16 v[80:83], v[140:143], v[156:159], v[80:83]
  v_mfma_f32_16x16x32_bf16 v[84:87], v[144:147], v[156:159], v[84:87]
  v_mfma_f32_16x16x32_bf16 v[88:91], v[140:143], v[160:163], v[88:91]
  v_mfma_f32_16x16x32_bf16 v[92:95], v[144:147], v[160:163], v[92:95]
  ds_read_b128 v[140:143], v16 offset:19584
  ds_read_b128 v[144:147], v16 offset:19872
  ds_read_b128 v[156:159], v17 offset:4800
  ds_read_b128 v[160:163], v17 offset:3264
  s_waitcnt lgkmcnt(8)
  v_mfma_f32_16x16x32_bf16 v[80:83], v[96:99], v[112:115], v[80:83]
  v_mfma_f32_16x16x32_bf16 v[84:87], v[100:103], v[112:115], v[84:87]
  v_mfma_f32_16x16x32_bf16 v[88:91], v[96:99], v[116:119], v[88:91]
  v_mfma_f32_16x16x32_bf16 v[92:95], v[100:103], v[116:119], v[92:95]
  ds_read_b128 v[96:99], v16 offset:20160
  ds_read_b128 v[100:103], v16 offset:20448
  ds_read_b128 v[112:115], v17 offset:4896
  ds_read_b128 v[116:119], v17 offset:3360
  s_waitcnt lgkmcnt(8)
  v_mfma_f32_16x16x32_bf16 v[164:167], v[20:23], v[36:39], v[164:167]
  v_mfma_f32_16x16x32_bf16 v[168:171], v[24:27], v[36:39], v[168:171]
  v_mfma_f32_16x16x32_bf16 v[172:175], v[20:23], v[40:43], v[172:175]
  v_mfma_f32_16x16x32_bf16 v[176:179], v[24:27], v[40:43], v[176:179]
  ds_read_b128 v[20:23], v16 offset:20736
  ds_read_b128 v[24:27], v16 offset:21024
  ds_read_b128 v[36:39], v17 offset:4992
  ds_read_b128 v[40:43], v17 offset:3456
  s_waitcnt lgkmcnt(8)
  v_mfma_f32_16x16x32_bf16 v[80:83], v[140:143], v[156:159], v[80:83]
  v_mfma_f32_16x16x32_bf16 v[84:87], v[144:147], v[156:159], v[84:87]
  v_mfma_f32_16x16x32_bf16 v[88:91], v[140:143], v[160:163], v[88:91]
  v_mfma_f32_16x16x32_bf16 v[92:95], v[144:147], v[160:163], v[92:95]
  ds_read_b128 v[140:143], v16 offset:21312
  ds_read_b128 v[144:147], v16 offset:21600
  ds_read_b128 v[156:159], v17 offset:5088
  ds_read_b128 v[160:163], v17 offset:3552
  s_waitcnt lgkmcnt(8)
  v_mfma_f32_16x16x32_bf16 v[164:167], v[96:99], v[112:115], v[164:167]
  v_mfma_f32_16x16x32_bf16 v[168:171], v[100:103], v[112:115], v[168:171]
  v_mfma_f32_16x16x32_bf16 v[172:175], v[96:99], v[116:119], v[172:175]
  v_mfma_f32_16x16x32_bf16 v[176:179], v[100:103], v[116:119], v[176:179]
  ds_read_b128 v[96:99], v16 offset:21888
  ds_read_b128 v[100:103], v16 offset:22176
  ds_read_b128 v[112:115], v17 offset:5184
  ds_read_b128 v[116:119], v17 offset:3648
  s_waitcnt lgkmcnt(8)
  v_mfma_f32_16x16x32_bf16 v[80:83], v[20:23], v[36:39], v[80:83]
  v_mfma_f32_16x16x32_bf16 v[84:87], v[24:27], v[36:39], v[84:87]
  v_mfma_f32_16x16x32_bf16 v[88:91], v[20:23], v[40:43], v[88:91]
  v_mfma_f32_16x16x32_bf16 v[92:95], v[24:27], v[40:43], v[92:95]
  ds_read_b128 v[20:23], v16 offset:22464
  ds_read_b128 v[24:27], v16 offset:22752
  ds_read_b128 v[36:39], v17 offset:5280
  ds_read_b128 v[40:43], v17 offset:3744
  s_waitcnt lgkmcnt(8)
  v_mfma_f32_16x16x32_bf16 v[164:167], v[140:143], v[156:159], v[164:167]
  v_mfma_f32_16x16x32_bf16 v[168:171], v[144:147], v[156:159], v[168:171]
  v_mfma_f32_16x16x32_bf16 v[172:175], v[140:143], v[160:163], v[172:175]
  v_mfma_f32_16x16x32_bf16 v[176:179], v[144:147], v[160:163], v[176:179]
  ds_read_b128 v[140:143], v16 offset:23040
  ds_read_b128 v[144:147], v16 offset:23328
  ds_read_b128 v[156:159], v17 offset:5376
  ds_read_b128 v[160:163], v17 offset:3840
  s_waitcnt lgkmcnt(8)
  v_mfma_f32_16x16x32_bf16 v[80:83], v[96:99], v[112:115], v[80:83]
  v_mfma_f32_16x16x32_bf16 v[84:87], v[100:103], v[112:115], v[84:87]
  v_mfma_f32_16x16x32_bf16 v[88:91], v[96:99], v[116:119], v[88:91]
  v_mfma_f32_16x16x32_bf16 v[92:95], v[100:103], v[116:119], v[92:95]
  ds_read_b128 v[96:99], v16 offset:23616
  ds_read_b128 v[100:103], v16 offset:23904
  ds_read_b128 v[112:115], v17 offset:5472
  ds_read_b128 v[116:119], v17 offset:3936
  s_waitcnt lgkmcnt(8)
  v_mfma_f32_16x16x32_bf16 v[164:167], v[20:23], v[36:39], v[164:167]
  v_mfma_f32_16x16x32_bf16 v[168:171], v[24:27], v[36:39], v[168:171]
  v_mfma_f32_16x16x32_bf16 v[172:175], v[20:23], v[40:43], v[172:175]
  v_mfma_f32_16x16x32_bf16 v[176:179], v[24:27], v[40:43], v[176:179]
  ds_read_b128 v[20:23], v16 offset:24192
  ds_read_b128 v[24:27], v16 offset:24480
  ds_read_b128 v[36:39], v17 offset:5568
  ds_read_b128 v[40:43], v17 offset:4032
  s_waitcnt lgkmcnt(8)
  v_mfma_f32_16x16x32_bf16 v[80:83], v[140:143], v[156:159], v[80:83]
  v_mfma_f32_16x16x32_bf16 v[84:87], v[144:147], v[156:159], v[84:87]
  v_mfma_f32_16x16x32_bf16 v[88:91], v[140:143], v[160:163], v[88:91]
  v_mfma_f32_16x16x32_bf16 v[92:95], v[144:147], v[160:163], v[92:95]
  ds_read_b128 v[140:143], v16 offset:24768
  ds_read_b128 v[144:147], v16 offset:25056
  ds_read_b128 v[156:159], v17 offset:5664
  ds_read_b128 v[160:163], v17 offset:4128
  s_waitcnt lgkmcnt(8)
  v_mfma_f32_16x16x32_bf16 v[164:167], v[96:99], v[112:115], v[164:167]
  v_mfma_f32_16x16x32_bf16 v[168:171], v[100:103], v[112:115], v[168:171]
  v_mfma_f32_16x16x32_bf16 v[172:175], v[96:99], v[116:119], v[172:175]
  v_mfma_f32_16x16x32_bf16 v[176:179], v[100:103], v[116:119], v[176:179]
  ds_read_b128 v[96:99], v16 offset:25344
  ds_read_b128 v[100:103], v16 offset:25632
  ds_read_b128 v[112:115], v17 offset:5760
  ds_read_b128 v[116:119], v17 offset:4224
  s_waitcnt lgkmcnt(8)
  v_mfma_f32_16x16x32_bf16 v[80:83], v[20:23], v[36:39], v[80:83]
  v_mfma_f32_16x16x32_bf16 v[84:87], v[24:27], v[36:39], v[84:87]
  v_mfma_f32_16x16x32_bf16 v[88:91], v[20:23], v[40:43], v[88:91]
  v_mfma_f32_16x16x32_bf16 v[92:95], v[24:27], v[40:43], v[92:95]
  ds_read_b128 v[20:23], v16 offset:25920
  ds_read_b128 v[24:27], v16 offset:26208
  ds_read_b128 v[36:39], v17 offset:5856
  ds_read_b128 v[40:43], v17 offset:4320
  s_waitcnt lgkmcnt(8)
  v_mfma_f32_16x16x32_bf16 v[164:167], v[140:143], v[156:159], v[164:167]
  v_mfma_f32_16x16x32_bf16 v[168:171], v[144:147], v[156:159], v[168:171]
  v_mfma_f32_16x16x32_bf16 v[172:175], v[140:143], v[160:163], v[172:175]
  v_mfma_f32_16x16x32_bf16 v[176:179], v[144:147], v[160:163], v[176:179]
  ds_read_b128 v[140:143], v16 offset:26496
  ds_read_b128 v[144:147], v16 offset:26784
  ds_read_b128 v[156:159], v17 offset:5952
  ds_read_b128 v[160:163], v17 offset:4416
  s_waitcnt lgkmcnt(8)
  v_mfma_f32_16x16x32_bf16 v[80:83], v[96:99], v[112:115], v[80:83]
  v_mfma_f32_16x16x32_bf16 v[84:87], v[100:103], v[112:115], v[84:87]
  v_mfma_f32_16x16x32_bf16 v[88:91], v[96:99], v[116:119], v[88:91]
  v_mfma_f32_16x16x32_bf16 v[92:95], v[100:103], v[116:119], v[92:95]
  ds_read_b128 v[96:99], v16 offset:27072
  ds_read_b128 v[100:103], v16 offset:27360
  ds_read_b128 v[112:115], v17 offset:6048
  ds_read_b128 v[116:119], v17 offset:4512
  s_waitcnt lgkmcnt(8)
  v_mfma_f32_16x16x32_bf16 v[164:167], v[20:23], v[36:39], v[164:167]
  v_mfma_f32_16x16x32_bf16 v[168:171], v[24:27], v[36:39], v[168:171]
  v_mfma_f32_16x16x32_bf16 v[172:175], v[20:23], v[40:43], v[172:175]
  v_mfma_f32_16x16x32_bf16 v[176:179], v[24:27], v[40:43], v[176:179]
  ds_read_b128 v[20:23], v16 offset:27648
  ds_read_b128 v[24:27], v16 offset:27936
  ds_read_b128 v[40:43], v17 offset:4608
  s_waitcnt lgkmcnt(7)
  v_mfma_f32_16x16x32_bf16 v[80:83], v[140:143], v[156:159], v[80:83]
  v_mfma_f32_16x16x32_bf16 v[84:87], v[144:147], v[156:159], v[84:87]
  v_mfma_f32_16x16x32_bf16 v[88:91], v[140:143], v[160:163], v[88:91]
  v_mfma_f32_16x16x32_bf16 v[92:95], v[144:147], v[160:163], v[92:95]
  ds_read_b128 v[140:143], v16 offset:28224
  ds_read_b128 v[144:147], v16 offset:28512
  ds_read_b128 v[160:163], v17 offset:4704
  s_waitcnt lgkmcnt(6)
  v_mfma_f32_16x16x32_bf16 v[164:167], v[96:99], v[112:115], v[164:167]
  v_mfma_f32_16x16x32_bf16 v[168:171], v[100:103], v[112:115], v[168:171]
  v_mfma_f32_16x16x32_bf16 v[172:175], v[96:99], v[116:119], v[172:175]
  v_mfma_f32_16x16x32_bf16 v[176:179], v[100:103], v[116:119], v[176:179]
  ds_read_b128 v[96:99], v16 offset:28800
  ds_read_b128 v[100:103], v16 offset:29088
  ds_read_b128 v[116:119], v17 offset:4800
  s_waitcnt lgkmcnt(6)
  v_mfma_f32_16x16x32_bf16 v[88:91], v[20:23], v[40:43], v[88:91]
  v_mfma_f32_16x16x32_bf16 v[92:95], v[24:27], v[40:43], v[92:95]
  ds_read_b128 v[20:23], v16 offset:29376
  ds_read_b128 v[24:27], v16 offset:29664
  ds_read_b128 v[40:43], v17 offset:4896
  s_waitcnt lgkmcnt(6)
  v_mfma_f32_16x16x32_bf16 v[172:175], v[140:143], v[160:163], v[172:175]
  v_mfma_f32_16x16x32_bf16 v[176:179], v[144:147], v[160:163], v[176:179]
  ds_read_b128 v[140:143], v16 offset:29952
  ds_read_b128 v[144:147], v16 offset:30240
  ds_read_b128 v[160:163], v17 offset:4992
  s_waitcnt lgkmcnt(6)
  v_mfma_f32_16x16x32_bf16 v[88:91], v[96:99], v[116:119], v[88:91]
  v_mfma_f32_16x16x32_bf16 v[92:95], v[100:103], v[116:119], v[92:95]
  ds_read_b128 v[96:99], v16 offset:30528
  ds_read_b128 v[100:103], v16 offset:30816
  ds_read_b128 v[116:119], v17 offset:5088
  s_waitcnt lgkmcnt(6)
  v_mfma_f32_16x16x32_bf16 v[172:175], v[20:23], v[40:43], v[172:175]
  v_mfma_f32_16x16x32_bf16 v[176:179], v[24:27], v[40:43], v[176:179]
  ds_read_b128 v[20:23], v16 offset:31104
  ds_read_b128 v[24:27], v16 offset:31392
  ds_read_b128 v[40:43], v17 offset:5184
  s_waitcnt lgkmcnt(6)
  v_mfma_f32_16x16x32_bf16 v[88:91], v[140:143], v[160:163], v[88:91]
  v_mfma_f32_16x16x32_bf16 v[92:95], v[144:147], v[160:163], v[92:95]
  ds_read_b128 v[140:143], v16 offset:31680
  ds_read_b128 v[144:147], v16 offset:31968
  ds_read_b128 v[160:163], v17 offset:5280
  s_waitcnt lgkmcnt(6)
  v_mfma_f32_16x16x32_bf16 v[172:175], v[96:99], v[116:119], v[172:175]
  v_mfma_f32_16x16x32_bf16 v[176:179], v[100:103], v[116:119], v[176:179]
  ds_read_b128 v[96:99], v16 offset:32256
  ds_read_b128 v[100:103], v16 offset:32544
  ds_read_b128 v[116:119], v17 offset:5376
  s_waitcnt lgkmcnt(6)
  v_mfma_f32_16x16x32_bf16 v[88:91], v[20:23], v[40:43], v[88:91]
  v_mfma_f32_16x16x32_bf16 v[92:95], v[24:27], v[40:43], v[92:95]
  ds_read_b128 v[20:23], v16 offset:32832
  ds_read_b128 v[24:27], v16 offset:33120
  ds_read_b128 v[40:43], v17 offset:5472
  s_waitcnt lgkmcnt(6)
  v_mfma_f32_16x16x32_bf16 v[172:175], v[140:143], v[160:163], v[172:175]
  v_mfma_f32_16x16x32_bf16 v[176:179], v[144:147], v[160:163], v[176:179]
  ds_read_b128 v[140:143], v16 offset:33408
  ds_read_b128 v[144:147], v16 offset:33696
  ds_read_b128 v[160:163], v17 offset:5568
  s_waitcnt lgkmcnt(6)
  v_mfma_f32_16x16x32_bf16 v[88:91], v[96:99], v[116:119], v[88:91]
  v_mfma_f32_16x16x32_bf16 v[92:95], v[100:103], v[116:119], v[92:95]
  ds_read_b128 v[96:99], v16 offset:33984
  ds_read_b128 v[100:103], v16 offset:34272
  ds_read_b128 v[116:119], v17 offset:5664
  s_waitcnt lgkmcnt(6)
  v_mfma_f32_16x16x32_bf16 v[172:175], v[20:23], v[40:43], v[172:175]
  v_mfma_f32_16x16x32_bf16 v[176:179], v[24:27], v[40:43], v[176:179]
  ds_read_b128 v[20:23], v16 offset:34560
  ds_read_b128 v[24:27], v16 offset:34848
  ds_read_b128 v[40:43], v17 offset:5760
  s_waitcnt lgkmcnt(6)
  v_mfma_f32_16x16x32_bf16 v[88:91], v[140:143], v[160:163], v[88:91]
  v_mfma_f32_16x16x32_bf16 v[92:95], v[144:147], v[160:163], v[92:95]
  ds_read_b128 v[140:143], v16 offset:35136
  ds_read_b128 v[144:147], v16 offset:35424
  ds_read_b128 v[160:163], v17 offset:5856
  s_waitcnt lgkmcnt(6)
  v_mfma_f32_16x16x32_bf16 v[172:175], v[96:99], v[116:119], v[172:175]
  v_mfma_f32_16x16x32_bf16 v[176:179], v[100:103], v[116:119], v[176:179]
  ds_read_b128 v[96:99], v16 offset:35712
  ds_read_b128 v[100:103], v16 offset:36000
  ds_read_b128 v[116:119], v17 offset:5952
  s_waitcnt lgkmcnt(6)
  v_mfma_f32_16x16x32_bf16 v[88:91], v[20:23], v[40:43], v[88:91]
  v_mfma_f32_16x16x32_bf16 v[92:95], v[24:27], v[40:43], v[92:95]
  ds_read_b128 v[20:23], v16 offset:36288
  ds_read_b128 v[24:27], v16 offset:36576
  ds_read_b128 v[40:43], v17 offset:6048
  s_waitcnt lgkmcnt(6)
  v_mfma_f32_16x16x32_bf16 v[172:175], v[140:143], v[160:163], v[172:175]
  v_mfma_f32_16x16x32_bf16 v[176:179], v[144:147], v[160:163], v[176:179]
  s_waitcnt lgkmcnt(3)
  v_mfma_f32_16x16x32_bf16 v[88:91], v[96:99], v[116:119], v[88:91]
  v_mfma_f32_16x16x32_bf16 v[92:95], v[100:103], v[116:119], v[92:95]
  s_waitcnt lgkmcnt(0)
  v_mfma_f32_16x16x32_bf16 v[172:175], v[20:23], v[40:43], v[172:175]
  v_mfma_f32_16x16x32_bf16 v[176:179], v[24:27], v[40:43], v[176:179]
  s_nop 7
  s_nop 1
  v_add_f32 v80, v80, v164
  v_add_f32 v81, v81, v165
  v_add_f32 v82, v82, v166
  v_add_f32 v83, v83, v167
  v_add_f32 v84, v84, v168
  v_add_f32 v85, v85, v169
  v_add_f32 v86, v86, v170
  v_add_f32 v87, v87, v171
  v_add_f32 v88, v88, v172
  v_add_f32 v89, v89, v173
  v_add_f32 v90, v90, v174
  v_add_f32 v91, v91, v175
  v_add_f32 v92, v92, v176
  v_add_f32 v93, v93, v177
  v_add_f32 v94, v94, v178
  v_add_f32 v95, v95, v179
  ds_read_b64 v[120:121], v18 offset:4640
  ds_read_b64 v[122:123], v18 offset:4608
  ds_read_b64 v[124:125], v18 offset:3104
  ds_read_b64 v[126:127], v18 offset:3072
  ds_read_b64 v[128:129], v18 offset:1568
  ds_read_b64 v[130:131], v18 offset:1536
  ds_read_b64 v[132:133], v18 offset:32
  ds_read_b64 v[134:135], v18 offset:0
  v_lshlrev_b32 v7, 16, v7
  s_nop 7
  s_waitcnt lgkmcnt(0)
  v_cvt_pk_bf16_f32 v18, v64, v65
  v_lshlrev_b32 v64, 16, v18
  v_and_b32 v65, 0xffff0000, v18
  v_cvt_pk_bf16_f32 v19, v66, v67
  v_lshlrev_b32 v66, 16, v19
  v_and_b32 v67, 0xffff0000, v19
  v_lshlrev_b32 v23, 16, v120
  v_and_b32 v22, 0xffff0000, v120
  v_lshlrev_b32 v21, 16, v121
  v_and_b32 v20, 0xffff0000, v121
  v_mul_f32 v20, v20, v7
  v_mul_f32 v21, v21, v7
  v_mul_f32 v22, v22, v7
  v_mul_f32 v23, v23, v7
  v_cvt_pk_bf16_f32 v18, v20, v21
  v_lshlrev_b32 v20, 16, v18
  v_and_b32 v21, 0xffff0000, v18
  v_cvt_pk_bf16_f32 v19, v22, v23
  v_lshlrev_b32 v22, 16, v19
  v_and_b32 v23, 0xffff0000, v19
  v_add_f32 v64, v64, v20
  v_add_f32 v65, v65, v21
  v_add_f32 v66, v66, v22
  v_add_f32 v67, v67, v23
  v_cvt_pk_bf16_f32 v120, v64, v65
  v_cvt_pk_bf16_f32 v121, v66, v67
  ds_write_b64 v10, v[120:121] offset:0
  v_cvt_pk_bf16_f32 v18, v68, v69
  v_lshlrev_b32 v68, 16, v18
  v_and_b32 v69, 0xffff0000, v18
  v_cvt_pk_bf16_f32 v19, v70, v71
  v_lshlrev_b32 v70, 16, v19
  v_and_b32 v71, 0xffff0000, v19
  v_lshlrev_b32 v23, 16, v122
  v_and_b32 v22, 0xffff0000, v122
  v_lshlrev_b32 v21, 16, v123
  v_and_b32 v20, 0xffff0000, v123
  v_mul_f32 v20, v20, v7
  v_mul_f32 v21, v21, v7
  v_mul_f32 v22, v22, v7
  v_mul_f32 v23, v23, v7
  v_cvt_pk_bf16_f32 v18, v20, v21
  v_lshlrev_b32 v20, 16, v18
  v_and_b32 v21, 0xffff0000, v18
  v_cvt_pk_bf16_f32 v19, v22, v23
  v_lshlrev_b32 v22, 16, v19
  v_and_b32 v23, 0xffff0000, v19
  v_add_f32 v68, v68, v20
  v_add_f32 v69, v69, v21
  v_add_f32 v70, v70, v22
  v_add_f32 v71, v71, v23
  v_cvt_pk_bf16_f32 v122, v68, v69
  v_cvt_pk_bf16_f32 v123, v70, v71
  ds_write_b64 v10, v[122:123] offset:32
  v_cvt_pk_bf16_f32 v18, v72, v73
  v_lshlrev_b32 v72, 16, v18
  v_and_b32 v73, 0xffff0000, v18
  v_cvt_pk_bf16_f32 v19, v74, v75
  v_lshlrev_b32 v74, 16, v19
  v_and_b32 v75, 0xffff0000, v19
  v_lshlrev_b32 v23, 16, v124
  v_and_b32 v22, 0xffff0000, v124
  v_lshlrev_b32 v21, 16, v125
  v_and_b32 v20, 0xffff0000, v125
  v_mul_f32 v20, v20, v7
  v_mul_f32 v21, v21, v7
  v_mul_f32 v22, v22, v7
  v_mul_f32 v23, v23, v7
  v_cvt_pk_bf16_f32 v18, v20, v21
  v_lshlrev_b32 v20, 16, v18
  v_and_b32 v21, 0xffff0000, v18
  v_cvt_pk_bf16_f32 v19, v22, v23
  v_lshlrev_b32 v22, 16, v19
  v_and_b32 v23, 0xffff0000, v19
  v_add_f32 v72, v72, v20
  v_add_f32 v73, v73, v21
  v_add_f32 v74, v74, v22
  v_add_f32 v75, v75, v23
  v_cvt_pk_bf16_f32 v124, v72, v73
  v_cvt_pk_bf16_f32 v125, v74, v75
  ds_write_b64 v10, v[124:125] offset:1024
  v_cvt_pk_bf16_f32 v18, v76, v77
  v_lshlrev_b32 v76, 16, v18
  v_and_b32 v77, 0xffff0000, v18
  v_cvt_pk_bf16_f32 v19, v78, v79
  v_lshlrev_b32 v78, 16, v19
  v_and_b32 v79, 0xffff0000, v19
  v_lshlrev_b32 v23, 16, v126
  v_and_b32 v22, 0xffff0000, v126
  v_lshlrev_b32 v21, 16, v127
  v_and_b32 v20, 0xffff0000, v127
  v_mul_f32 v20, v20, v7
  v_mul_f32 v21, v21, v7
  v_mul_f32 v22, v22, v7
  v_mul_f32 v23, v23, v7
  v_cvt_pk_bf16_f32 v18, v20, v21
  v_lshlrev_b32 v20, 16, v18
  v_and_b32 v21, 0xffff0000, v18
  v_cvt_pk_bf16_f32 v19, v22, v23
  v_lshlrev_b32 v22, 16, v19
  v_and_b32 v23, 0xffff0000, v19
  v_add_f32 v76, v76, v20
  v_add_f32 v77, v77, v21
  v_add_f32 v78, v78, v22
  v_add_f32 v79, v79, v23
  v_cvt_pk_bf16_f32 v126, v76, v77
  v_cvt_pk_bf16_f32 v127, v78, v79
  ds_write_b64 v10, v[126:127] offset:1056
  v_cvt_pk_bf16_f32 v18, v80, v81
  v_lshlrev_b32 v80, 16, v18
  v_and_b32 v81, 0xffff0000, v18
  v_cvt_pk_bf16_f32 v19, v82, v83
  v_lshlrev_b32 v82, 16, v19
  v_and_b32 v83, 0xffff0000, v19
  v_lshlrev_b32 v23, 16, v128
  v_and_b32 v22, 0xffff0000, v128
  v_lshlrev_b32 v21, 16, v129
  v_and_b32 v20, 0xffff0000, v129
  v_mul_f32 v20, v20, v7
  v_mul_f32 v21, v21, v7
  v_mul_f32 v22, v22, v7
  v_mul_f32 v23, v23, v7
  v_cvt_pk_bf16_f32 v18, v20, v21
  v_lshlrev_b32 v20, 16, v18
  v_and_b32 v21, 0xffff0000, v18
  v_cvt_pk_bf16_f32 v19, v22, v23
  v_lshlrev_b32 v22, 16, v19
  v_and_b32 v23, 0xffff0000, v19
  v_add_f32 v80, v80, v20
  v_add_f32 v81, v81, v21
  v_add_f32 v82, v82, v22
  v_add_f32 v83, v83, v23
  v_cvt_pk_bf16_f32 v128, v80, v81
  v_cvt_pk_bf16_f32 v129, v82, v83
  ds_write_b64 v10, v[128:129] offset:2048
  v_cvt_pk_bf16_f32 v18, v84, v85
  v_lshlrev_b32 v84, 16, v18
  v_and_b32 v85, 0xffff0000, v18
  v_cvt_pk_bf16_f32 v19, v86, v87
  v_lshlrev_b32 v86, 16, v19
  v_and_b32 v87, 0xffff0000, v19
  v_lshlrev_b32 v23, 16, v130
  v_and_b32 v22, 0xffff0000, v130
  v_lshlrev_b32 v21, 16, v131
  v_and_b32 v20, 0xffff0000, v131
  v_mul_f32 v20, v20, v7
  v_mul_f32 v21, v21, v7
  v_mul_f32 v22, v22, v7
  v_mul_f32 v23, v23, v7
  v_cvt_pk_bf16_f32 v18, v20, v21
  v_lshlrev_b32 v20, 16, v18
  v_and_b32 v21, 0xffff0000, v18
  v_cvt_pk_bf16_f32 v19, v22, v23
  v_lshlrev_b32 v22, 16, v19
  v_and_b32 v23, 0xffff0000, v19
  v_add_f32 v84, v84, v20
  v_add_f32 v85, v85, v21
  v_add_f32 v86, v86, v22
  v_add_f32 v87, v87, v23
  v_cvt_pk_bf16_f32 v130, v84, v85
  v_cvt_pk_bf16_f32 v131, v86, v87
  ds_write_b64 v10, v[130:131] offset:2080
  v_cvt_pk_bf16_f32 v18, v88, v89
  v_lshlrev_b32 v88, 16, v18
  v_and_b32 v89, 0xffff0000, v18
  v_cvt_pk_bf16_f32 v19, v90, v91
  v_lshlrev_b32 v90, 16, v19
  v_and_b32 v91, 0xffff0000, v19
  v_lshlrev_b32 v23, 16, v132
  v_and_b32 v22, 0xffff0000, v132
  v_lshlrev_b32 v21, 16, v133
  v_and_b32 v20, 0xffff0000, v133
  v_mul_f32 v20, v20, v7
  v_mul_f32 v21, v21, v7
  v_mul_f32 v22, v22, v7
  v_mul_f32 v23, v23, v7
  v_cvt_pk_bf16_f32 v18, v20, v21
  v_lshlrev_b32 v20, 16, v18
  v_and_b32 v21, 0xffff0000, v18
  v_cvt_pk_bf16_f32 v19, v22, v23
  v_lshlrev_b32 v22, 16, v19
  v_and_b32 v23, 0xffff0000, v19
  v_add_f32 v88, v88, v20
  v_add_f32 v89, v89, v21
  v_add_f32 v90, v90, v22
  v_add_f32 v91, v91, v23
  v_cvt_pk_bf16_f32 v132, v88, v89
  v_cvt_pk_bf16_f32 v133, v90, v91
  ds_write_b64 v10, v[132:133] offset:3072
  v_cvt_pk_bf16_f32 v18, v92, v93
  v_lshlrev_b32 v92, 16, v18
  v_and_b32 v93, 0xffff0000, v18
  v_cvt_pk_bf16_f32 v19, v94, v95
  v_lshlrev_b32 v94, 16, v19
  v_and_b32 v95, 0xffff0000, v19
  v_lshlrev_b32 v23, 16, v134
  v_and_b32 v22, 0xffff0000, v134
  v_lshlrev_b32 v21, 16, v135
  v_and_b32 v20, 0xffff0000, v135
  v_mul_f32 v20, v20, v7
  v_mul_f32 v21, v21, v7
  v_mul_f32 v22, v22, v7
  v_mul_f32 v23, v23, v7
  v_cvt_pk_bf16_f32 v18, v20, v21
  v_lshlrev_b32 v20, 16, v18
  v_and_b32 v21, 0xffff0000, v18
  v_cvt_pk_bf16_f32 v19, v22, v23
  v_lshlrev_b32 v22, 16, v19
  v_and_b32 v23, 0xffff0000, v19
  v_add_f32 v92, v92, v20
  v_add_f32 v93, v93, v21
  v_add_f32 v94, v94, v22
  v_add_f32 v95, v95, v23
  v_cvt_pk_bf16_f32 v134, v92, v93
  v_cvt_pk_bf16_f32 v135, v94, v95
  ds_write_b64 v10, v[134:135] offset:3104
  v_add_u32 v16, s5, v2
  s_waitcnt lgkmcnt(0)
  ds_read_b128 v[20:23], v16 offset:0
  ds_read_b128 v[24:27], v16 offset:1024
  ds_read_b128 v[28:31], v16 offset:2048
  ds_read_b128 v[32:35], v16 offset:3072
  s_waitcnt lgkmcnt(3)
  buffer_store_dwordx4 v[20:23], v2, s[52:55], s13 offen offset:0
  s_waitcnt lgkmcnt(2)
  buffer_store_dwordx4 v[24:27], v2, s[52:55], s13 offen offset:1024
  s_waitcnt lgkmcnt(1)
  buffer_store_dwordx4 v[28:31], v2, s[52:55], s13 offen offset:2048
  s_waitcnt lgkmcnt(0)
  buffer_store_dwordx4 v[32:35], v2, s[52:55], s13 offen offset:3072
  s_branch Lend_7
Lwarm_8:
  s_waitcnt lgkmcnt(0)
  s_barrier
  s_mov_b32 s44, s32
  s_mov_b32 s45, s33
  s_mov_b32 s46, 8388608
  s_mov_b32 s47, 0x20000
  s_mov_b32 s48, s16
  s_mov_b32 s49, s17
  s_mov_b32 s50, 2621440
  s_mov_b32 s51, 0x20000
  s_mul_i32 s4, s2, 40960
  s_mul_i32 s5, s2, 13312
  v_lshlrev_b32 v1, 4, v0
  s_getpc_b64 s[60:61]
  s_lshr_b32 s6, s2, 3
  s_mul_i32 s6, s6, 3072
  s_add_u32 s60, s60, s6
  s_addc_u32 s61, s61, 0
  s_cmp_ge_u32 s6, 33000
  s_cbranch_scc1 Lcw_9
  global_load_dwordx4 v[170:173], v1, s[60:61] offset:0
  global_load_dwordx4 v[174:177], v1, s[60:61] offset:1024
  global_load_dwordx4 v[178:181], v1, s[60:61] offset:2048
Lcw_9:
  buffer_load_dwordx4 v[8:11], v1, s[48:51], s5 offen
  s_add_u32 s5, s5, 1024
  buffer_load_dwordx4 v[12:15], v1, s[48:51], s5 offen
  s_add_u32 s5, s5, 1024
  buffer_load_dwordx4 v[16:19], v1, s[48:51], s5 offen
  s_add_u32 s5, s5, 1024
  buffer_load_dwordx4 v[20:23], v1, s[48:51], s5 offen
  s_add_u32 s5, s5, 1024
  buffer_load_dwordx4 v[24:27], v1, s[48:51], s5 offen
  s_add_u32 s5, s5, 1024
  buffer_load_dwordx4 v[28:31], v1, s[48:51], s5 offen
  s_add_u32 s5, s5, 1024
  buffer_load_dwordx4 v[32:35], v1, s[48:51], s5 offen
  s_add_u32 s5, s5, 1024
  buffer_load_dwordx4 v[36:39], v1, s[48:51], s5 offen
  s_add_u32 s5, s5, 1024
  buffer_load_dwordx4 v[40:43], v1, s[48:51], s5 offen
  s_add_u32 s5, s5, 1024
  buffer_load_dwordx4 v[44:47], v1, s[48:51], s5 offen
  s_add_u32 s5, s5, 1024
  buffer_load_dwordx4 v[48:51], v1, s[48:51], s5 offen
  s_add_u32 s5, s5, 1024
  buffer_load_dwordx4 v[52:55], v1, s[48:51], s5 offen
  s_add_u32 s5, s5, 1024
  buffer_load_dwordx4 v[56:59], v1, s[48:51], s5 offen
  s_add_u32 s5, s5, 1024
  buffer_load_dwordx4 v[8:11], v1, s[44:47], s4 offen
  s_add_u32 s4, s4, 1024
  buffer_load_dwordx4 v[12:15], v1, s[44:47], s4 offen
  s_add_u32 s4, s4, 1024
  buffer_load_dwordx4 v[16:19], v1, s[44:47], s4 offen
  s_add_u32 s4, s4, 1024
  buffer_load_dwordx4 v[20:23], v1, s[44:47], s4 offen
  s_add_u32 s4, s4, 1024
  buffer_load_dwordx4 v[24:27], v1, s[44:47], s4 offen
  s_add_u32 s4, s4, 1024
  buffer_load_dwordx4 v[28:31], v1, s[44:47], s4 offen
  s_add_u32 s4, s4, 1024
  buffer_load_dwordx4 v[32:35], v1, s[44:47], s4 offen
  s_add_u32 s4, s4, 1024
  buffer_load_dwordx4 v[36:39], v1, s[44:47], s4 offen
  s_add_u32 s4, s4, 1024
  buffer_load_dwordx4 v[40:43], v1, s[44:47], s4 offen
  s_add_u32 s4, s4, 1024
  buffer_load_dwordx4 v[44:47], v1, s[44:47], s4 offen
  s_add_u32 s4, s4, 1024
  buffer_load_dwordx4 v[48:51], v1, s[44:47], s4 offen
  s_add_u32 s4, s4, 1024
  buffer_load_dwordx4 v[52:55], v1, s[44:47], s4 offen
  s_add_u32 s4, s4, 1024
  buffer_load_dwordx4 v[56:59], v1, s[44:47], s4 offen
  s_add_u32 s4, s4, 1024
  buffer_load_dwordx4 v[60:63], v1, s[44:47], s4 offen
  s_add_u32 s4, s4, 1024
  buffer_load_dwordx4 v[64:67], v1, s[44:47], s4 offen
  s_add_u32 s4, s4, 1024
  buffer_load_dwordx4 v[68:71], v1, s[44:47], s4 offen
  s_add_u32 s4, s4, 1024
  buffer_load_dwordx4 v[72:75], v1, s[44:47], s4 offen
  s_add_u32 s4, s4, 1024
  buffer_load_dwordx4 v[76:79], v1, s[44:47], s4 offen
  s_add_u32 s4, s4, 1024
  buffer_load_dwordx4 v[80:83], v1, s[44:47], s4 offen
  s_add_u32 s4, s4, 1024
  buffer_load_dwordx4 v[84:87], v1, s[44:47], s4 offen
  s_add_u32 s4, s4, 1024
  buffer_load_dwordx4 v[88:91], v1, s[44:47], s4 offen
  s_add_u32 s4, s4, 1024
  buffer_load_dwordx4 v[92:95], v1, s[44:47], s4 offen
  s_add_u32 s4, s4, 1024
  buffer_load_dwordx4 v[96:99], v1, s[44:47], s4 offen
  s_add_u32 s4, s4, 1024
  buffer_load_dwordx4 v[100:103], v1, s[44:47], s4 offen
  s_add_u32 s4, s4, 1024
  buffer_load_dwordx4 v[104:107], v1, s[44:47], s4 offen
  s_add_u32 s4, s4, 1024
  buffer_load_dwordx4 v[108:111], v1, s[44:47], s4 offen
  s_add_u32 s4, s4, 1024
  buffer_load_dwordx4 v[112:115], v1, s[44:47], s4 offen
  s_add_u32 s4, s4, 1024
  buffer_load_dwordx4 v[116:119], v1, s[44:47], s4 offen
  s_add_u32 s4, s4, 1024
  buffer_load_dwordx4 v[120:123], v1, s[44:47], s4 offen
  s_add_u32 s4, s4, 1024
  buffer_load_dwordx4 v[124:127], v1, s[44:47], s4 offen
  s_add_u32 s4, s4, 1024
  buffer_load_dwordx4 v[128:131], v1, s[44:47], s4 offen
  s_add_u32 s4, s4, 1024
  buffer_load_dwordx4 v[132:135], v1, s[44:47], s4 offen
  s_add_u32 s4, s4, 1024
  buffer_load_dwordx4 v[136:139], v1, s[44:47], s4 offen
  s_add_u32 s4, s4, 1024
  buffer_load_dwordx4 v[140:143], v1, s[44:47], s4 offen
  s_add_u32 s4, s4, 1024
  buffer_load_dwordx4 v[144:147], v1, s[44:47], s4 offen
  s_add_u32 s4, s4, 1024
  buffer_load_dwordx4 v[148:151], v1, s[44:47], s4 offen
  s_add_u32 s4, s4, 1024
  buffer_load_dwordx4 v[152:155], v1, s[44:47], s4 offen
  s_add_u32 s4, s4, 1024
  buffer_load_dwordx4 v[156:159], v1, s[44:47], s4 offen
  s_add_u32 s4, s4, 1024
  buffer_load_dwordx4 v[160:163], v1, s[44:47], s4 offen
  s_add_u32 s4, s4, 1024
  buffer_load_dwordx4 v[164:167], v1, s[44:47], s4 offen
  s_add_u32 s4, s4, 1024
  s_waitcnt vmcnt(0)
Lend_7:
  s_endpgm
.globl g1f0_kernel
.p2align 8
.type g1f0_kernel,@function
g1f0_kernel:
  s_cmp_ge_u32 s2, 256
  s_cbranch_scc1 Lx_10
  s_load_dwordx16 s[16:31], s[0:1], 0
  s_load_dwordx8 s[32:39], s[0:1], 64
  s_load_dwordx4 s[40:43], s[0:1], 96
  v_mov_b32 v23, v0
  v_lshrrev_b32 v1, 6, v0
  v_and_b32 v0, 63, v0
  s_nop 0
  v_readfirstlane_b32 s3, v1
  v_lshrrev_b32 v2, 3, v0
  v_lshrrev_b32 v3, 4, v0
  v_and_b32 v4, 7, v0
  v_and_b32 v5, 15, v0
  s_lshr_b32 s75, s3, 2
  s_and_b32 s10, s2, 7
  s_lshr_b32 s11, s2, 3
  s_and_b32 s4, s11, 7
  s_lshr_b32 s5, s11, 3
  s_lshl_b32 s10, s10, 2
  s_add_u32 s5, s5, s10
  s_mov_b32 s101, 0
  s_waitcnt lgkmcnt(0)
  s_add_u32 s84, s42, 35651584
  s_addc_u32 s85, s43, 0
  s_mov_b32 s86, 65536
  s_mov_b32 s87, 0x20000
  s_branch Lbody_e1
Lx_10:
  s_endpgm
.globl mid_kernel
.p2align 8
.type mid_kernel,@function
mid_kernel:
  s_cmp_ge_u32 s2, 256
  s_cbranch_scc1 Lx_11
  s_load_dwordx16 s[16:31], s[0:1], 0
  s_load_dwordx8 s[32:39], s[0:1], 64
  s_load_dwordx4 s[40:43], s[0:1], 96
  v_mov_b32 v23, v0
  v_lshrrev_b32 v1, 6, v0
  v_and_b32 v0, 63, v0
  s_nop 0
  v_readfirstlane_b32 s3, v1
  v_lshrrev_b32 v2, 3, v0
  v_lshrrev_b32 v3, 4, v0
  v_and_b32 v4, 7, v0
  v_and_b32 v5, 15, v0
  s_lshr_b32 s75, s3, 2
  s_and_b32 s10, s2, 7
  s_lshr_b32 s11, s2, 3
  s_and_b32 s4, s11, 7
  s_lshr_b32 s5, s11, 3
  s_lshl_b32 s10, s10, 2
  s_add_u32 s5, s5, s10
  s_mov_b32 s101, 0
  s_waitcnt lgkmcnt(0)
  s_add_u32 s84, s42, 35651584
  s_addc_u32 s85, s43, 0
  s_mov_b32 s86, 65536
  s_mov_b32 s87, 0x20000
  s_branch Lbody_g2
Lx_11:
  s_endpgm
.globl last_kernel
.p2align 8
.type last_kernel,@function
last_kernel:
  s_cmp_ge_u32 s2, 256
  s_cbranch_scc1 Lx_12
  s_load_dwordx16 s[16:31], s[0:1], 0
  s_load_dwordx8 s[32:39], s[0:1], 64
  s_load_dwordx4 s[40:43], s[0:1], 96
  v_mov_b32 v23, v0
  v_lshrrev_b32 v1, 6, v0
  v_and_b32 v0, 63, v0
  s_nop 0
  v_readfirstlane_b32 s3, v1
  v_lshrrev_b32 v2, 3, v0
  v_lshrrev_b32 v3, 4, v0
  v_and_b32 v4, 7, v0
  v_and_b32 v5, 15, v0
  s_lshr_b32 s75, s3, 2
  s_and_b32 s10, s2, 7
  s_lshr_b32 s11, s2, 3
  s_and_b32 s4, s11, 7
  s_lshr_b32 s5, s11, 3
  s_lshl_b32 s10, s10, 2
  s_add_u32 s5, s5, s10
  s_mov_b32 s101, 1
  s_waitcnt lgkmcnt(0)
  s_add_u32 s84, s42, 35651584
  s_addc_u32 s85, s43, 0
  s_mov_b32 s86, 65536
  s_mov_b32 s87, 0x20000
  s_branch Lbody_g2
Lx_12:
  s_endpgm
.p2align 6
Lbody_e1:
  s_add_u32 s91, s5, 192
  s_lshl_b32 s91, s91, 7
  s_mov_b32 s44, s16
  s_mov_b32 s45, s17
  s_mov_b32 s46, 2621440
  s_mov_b32 s47, 0x20000
  s_add_u32 s48, s42, 6291456
  s_addc_u32 s49, s43, 0
  s_mov_b32 s50, 2703360
  s_mov_b32 s51, 0x20000
  s_add_u32 s56, s42, 9437184
  s_addc_u32 s57, s43, 0
  s_mov_b32 s58, 2621440
  s_mov_b32 s59, 0x20000
  s_add_u32 s60, s42, 12582912
  s_addc_u32 s61, s43, 0
  s_mov_b32 s62, 2621440
  s_mov_b32 s63, 0x20000
  s_add_u32 s52, s42, 15728640
  s_addc_u32 s53, s43, 0
  s_mov_b32 s54, 2621440
  s_mov_b32 s55, 0x20000
  s_lshl_b32 s10, s5, 3
  s_add_u32 s10, s10, s4
  s_lshl_b32 s11, s10, 3
  s_add_u32 s11, s11, s3
  s_mul_i32 s15, s11, 1280
  v_lshlrev_b32 v21, 2, v0
  s_lshl_b32 s12, s10, 4
  v_mul_u32_u24 v6, 4224, v23
  v_add_u32 v6, s12, v6
  v_add_u32 v7, 2162688, v6
  buffer_load_dwordx4 v[36:39], v6, s[48:51], 0 offen
  buffer_load_dwordx4 v[40:43], v7, s[48:51], 0 offen
  buffer_load_dword v24, v21, s[44:47], s15 offen offset:0
  buffer_load_dword v25, v21, s[44:47], s15 offen offset:256
  buffer_load_dword v26, v21, s[44:47], s15 offen offset:512
  buffer_load_dword v27, v21, s[44:47], s15 offen offset:768
  buffer_load_dword v28, v21, s[44:47], s15 offen offset:1024
  v_lshlrev_b32 v6, 4, v23
  s_waitcnt vmcnt(5)
  ds_write_b128 v6, v[36:39]
  ds_write_b128 v6, v[40:43] offset:8192
  v_lshlrev_b32 v7, 5, v0
  s_lshl_b32 s12, s3, 1
  v_add_u32 v7, s12, v7
  s_waitcnt lgkmcnt(0)
  s_barrier
  ds_read_u16 v30, v7 offset:0
  ds_read_u16 v36, v7 offset:16
  ds_read_u16 v31, v7 offset:2048
  ds_read_u16 v37, v7 offset:2064
  ds_read_u16 v32, v7 offset:4096
  ds_read_u16 v38, v7 offset:4112
  ds_read_u16 v33, v7 offset:6144
  ds_read_u16 v39, v7 offset:6160
  ds_read_u16 v34, v7 offset:8192
  ds_read_u16 v40, v7 offset:8208
  s_waitcnt vmcnt(0) lgkmcnt(0)
  v_lshl_or_b32 v30, v36, 16, v30
  buffer_store_dword v30, v21, s[56:59], s15 offen offset:0
  v_lshl_or_b32 v31, v37, 16, v31
  buffer_store_dword v31, v21, s[56:59], s15 offen offset:256
  v_lshl_or_b32 v32, v38, 16, v32
  buffer_store_dword v32, v21, s[56:59], s15 offen offset:512
  v_lshl_or_b32 v33, v39, 16, v33
  buffer_store_dword v33, v21, s[56:59], s15 offen offset:768
  v_lshl_or_b32 v34, v40, 16, v34
  buffer_store_dword v34, v21, s[56:59], s15 offen offset:1024
  s_nop 1
  v_lshlrev_b32 v48, 16, v24
  v_and_b32 v49, 0xffff0000, v24
  v_lshlrev_b32 v50, 16, v25
  v_and_b32 v51, 0xffff0000, v25
  v_lshlrev_b32 v52, 16, v26
  v_and_b32 v53, 0xffff0000, v26
  v_lshlrev_b32 v54, 16, v27
  v_and_b32 v55, 0xffff0000, v27
  v_lshlrev_b32 v56, 16, v28
  v_and_b32 v57, 0xffff0000, v28
  s_nop 0
  v_readfirstlane_b32 s72, v48
  s_nop 1
  v_subrev_f32 v80, s72, v48
  v_subrev_f32 v81, s72, v49
  v_subrev_f32 v82, s72, v50
  v_subrev_f32 v83, s72, v51
  v_subrev_f32 v84, s72, v52
  v_subrev_f32 v85, s72, v53
  v_subrev_f32 v86, s72, v54
  v_subrev_f32 v87, s72, v55
  v_subrev_f32 v88, s72, v56
  v_subrev_f32 v89, s72, v57
  v_add_f32 v72, v80, v81
  v_mul_f32 v73, v80, v80
  v_fmac_f32 v73, v81, v81
  v_add_f32 v72, v72, v82
  v_fmac_f32 v73, v82, v82
  v_add_f32 v72, v72, v83
  v_fmac_f32 v73, v83, v83
  v_add_f32 v72, v72, v84
  v_fmac_f32 v73, v84, v84
  v_add_f32 v72, v72, v85
  v_fmac_f32 v73, v85, v85
  v_add_f32 v72, v72, v86
  v_fmac_f32 v73, v86, v86
  v_add_f32 v72, v72, v87
  v_fmac_f32 v73, v87, v87
  v_add_f32 v72, v72, v88
  v_fmac_f32 v73, v88, v88
  v_add_f32 v72, v72, v89
  v_fmac_f32 v73, v89, v89
  s_nop 1
  v_add_f32_dpp v72, v72, v72 row_ror:8 row_mask:0xf bank_mask:0xf
  v_add_f32_dpp v73, v73, v73 row_ror:8 row_mask:0xf bank_mask:0xf
  s_nop 1
  v_add_f32_dpp v72, v72, v72 row_ror:4 row_mask:0xf bank_mask:0xf
  v_add_f32_dpp v73, v73, v73 row_ror:4 row_mask:0xf bank_mask:0xf
  s_nop 1
  v_add_f32_dpp v72, v72, v72 row_ror:2 row_mask:0xf bank_mask:0xf
  v_add_f32_dpp v73, v73, v73 row_ror:2 row_mask:0xf bank_mask:0xf
  s_nop 1
  v_add_f32_dpp v72, v72, v72 row_ror:1 row_mask:0xf bank_mask:0xf
  v_add_f32_dpp v73, v73, v73 row_ror:1 row_mask:0xf bank_mask:0xf
  s_nop 0
  v_readlane_b32 s64, v72, 0
  v_readlane_b32 s65, v72, 16
  v_readlane_b32 s66, v72, 32
  v_readlane_b32 s67, v72, 48
  v_readlane_b32 s68, v73, 0
  v_readlane_b32 s69, v73, 16
  v_readlane_b32 s70, v73, 32
  v_readlane_b32 s71, v73, 48
  v_mov_b32 v72, s64
  v_add_f32 v72, s65, v72
  v_add_f32 v72, s66, v72
  v_add_f32 v72, s67, v72
  v_mov_b32 v73, s68
  v_add_f32 v73, s69, v73
  v_add_f32 v73, s70, v73
  v_add_f32 v73, s71, v73
  v_mul_f32 v72, 0x3acccccd, v72
  v_mul_f32 v73, 0x3acccccd, v73
  v_fma_f32 v73, -v72, v72, v73
  v_max_f32 v73, 0, v73
  v_add_f32 v74, s72, v72
  v_cvt_pk_bf16_f32 v76, v74, v73
  v_lshlrev_b32 v74, 16, v76
  v_and_b32 v73, 0xffff0000, v76
  v_add_f32 v73, 0x3727c5ac, v73
  v_cvt_pk_bf16_f32 v76, v73, v73
  v_lshlrev_b32 v73, 16, v76
  v_sqrt_f32 v73, v73
  s_nop 0
  v_cvt_pk_bf16_f32 v76, v73, v73
  v_lshlrev_b32 v73, 16, v76
  v_rcp_f32 v75, v73
  v_sub_f32 v60, v48, v74
  v_sub_f32 v61, v49, v74
  v_sub_f32 v62, v50, v74
  v_sub_f32 v63, v51, v74
  v_sub_f32 v64, v52, v74
  v_sub_f32 v65, v53, v74
  v_sub_f32 v66, v54, v74
  v_sub_f32 v67, v55, v74
  v_sub_f32 v68, v56, v74
  v_sub_f32 v69, v57, v74
  v_cvt_pk_bf16_f32 v76, v60, v61
  v_lshlrev_b32 v60, 16, v76
  v_and_b32 v61, 0xffff0000, v76
  v_cvt_pk_bf16_f32 v77, v62, v63
  v_lshlrev_b32 v62, 16, v77
  v_and_b32 v63, 0xffff0000, v77
  v_cvt_pk_bf16_f32 v76, v64, v65
  v_lshlrev_b32 v64, 16, v76
  v_and_b32 v65, 0xffff0000, v76
  v_cvt_pk_bf16_f32 v77, v66, v67
  v_lshlrev_b32 v66, 16, v77
  v_and_b32 v67, 0xffff0000, v77
  v_cvt_pk_bf16_f32 v76, v68, v69
  v_lshlrev_b32 v68, 16, v76
  v_and_b32 v69, 0xffff0000, v76
  v_mul_f32 v60, v60, v75
  v_mul_f32 v61, v61, v75
  v_mul_f32 v62, v62, v75
  v_mul_f32 v63, v63, v75
  v_mul_f32 v64, v64, v75
  v_mul_f32 v65, v65, v75
  v_mul_f32 v66, v66, v75
  v_mul_f32 v67, v67, v75
  v_mul_f32 v68, v68, v75
  v_mul_f32 v69, v69, v75
  v_cvt_pk_bf16_f32 v76, v60, v61
  v_lshlrev_b32 v60, 16, v76
  v_and_b32 v61, 0xffff0000, v76
  v_cvt_pk_bf16_f32 v77, v62, v63
  v_lshlrev_b32 v62, 16, v77
  v_and_b32 v63, 0xffff0000, v77
  v_cvt_pk_bf16_f32 v76, v64, v65
  v_lshlrev_b32 v64, 16, v76
  v_and_b32 v65, 0xffff0000, v76
  v_cvt_pk_bf16_f32 v77, v66, v67
  v_lshlrev_b32 v66, 16, v77
  v_and_b32 v67, 0xffff0000, v77
  v_cvt_pk_bf16_f32 v76, v68, v69
  v_lshlrev_b32 v68, 16, v76
  v_and_b32 v69, 0xffff0000, v76
  v_lshlrev_b32 v72, 16, v30
  v_and_b32 v73, 0xffff0000, v30
  v_lshlrev_b32 v74, 16, v31
  v_and_b32 v75, 0xffff0000, v31
  v_lshlrev_b32 v76, 16, v32
  v_and_b32 v77, 0xffff0000, v32
  v_lshlrev_b32 v78, 16, v33
  v_and_b32 v79, 0xffff0000, v33
  v_lshlrev_b32 v80, 16, v34
  v_and_b32 v81, 0xffff0000, v34
  v_pk_mul_f32 v[60:61], v[60:61], v[72:73]
  v_pk_mul_f32 v[62:63], v[62:63], v[74:75]
  v_pk_mul_f32 v[64:65], v[64:65], v[76:77]
  v_pk_mul_f32 v[66:67], v[66:67], v[78:79]
  v_pk_mul_f32 v[68:69], v[68:69], v[80:81]
  v_cvt_pk_bf16_f32 v82, v60, v61
  v_lshlrev_b32 v60, 16, v82
  v_and_b32 v61, 0xffff0000, v82
  v_cvt_pk_bf16_f32 v83, v62, v63
  v_lshlrev_b32 v62, 16, v83
  v_and_b32 v63, 0xffff0000, v83
  v_cvt_pk_bf16_f32 v82, v64, v65
  v_lshlrev_b32 v64, 16, v82
  v_and_b32 v65, 0xffff0000, v82
  v_cvt_pk_bf16_f32 v83, v66, v67
  v_lshlrev_b32 v66, 16, v83
  v_and_b32 v67, 0xffff0000, v83
  v_cvt_pk_bf16_f32 v82, v68, v69
  v_lshlrev_b32 v68, 16, v82
  v_and_b32 v69, 0xffff0000, v82
  v_pk_add_f32 v[48:49], v[48:49], v[60:61]
  v_pk_add_f32 v[50:51], v[50:51], v[62:63]
  v_pk_add_f32 v[52:53], v[52:53], v[64:65]
  v_pk_add_f32 v[54:55], v[54:55], v[66:67]
  v_pk_add_f32 v[56:57], v[56:57], v[68:69]
  v_cvt_pk_bf16_f32 v24, v48, v49
  v_lshlrev_b32 v48, 16, v24
  v_and_b32 v49, 0xffff0000, v24
  buffer_store_dword v24, v21, s[60:63], s15 offen offset:0
  v_cvt_pk_bf16_f32 v25, v50, v51
  v_lshlrev_b32 v50, 16, v25
  v_and_b32 v51, 0xffff0000, v25
  buffer_store_dword v25, v21, s[60:63], s15 offen offset:256
  v_cvt_pk_bf16_f32 v26, v52, v53
  v_lshlrev_b32 v52, 16, v26
  v_and_b32 v53, 0xffff0000, v26
  buffer_store_dword v26, v21, s[60:63], s15 offen offset:512
  v_cvt_pk_bf16_f32 v27, v54, v55
  v_lshlrev_b32 v54, 16, v27
  v_and_b32 v55, 0xffff0000, v27
  buffer_store_dword v27, v21, s[60:63], s15 offen offset:768
  v_cvt_pk_bf16_f32 v28, v56, v57
  v_lshlrev_b32 v56, 16, v28
  v_and_b32 v57, 0xffff0000, v28
  buffer_store_dword v28, v21, s[60:63], s15 offen offset:1024
  s_nop 0
  v_readfirstlane_b32 s72, v48
  s_nop 1
  v_subrev_f32 v80, s72, v48
  v_subrev_f32 v81, s72, v49
  v_subrev_f32 v82, s72, v50
  v_subrev_f32 v83, s72, v51
  v_subrev_f32 v84, s72, v52
  v_subrev_f32 v85, s72, v53
  v_subrev_f32 v86, s72, v54
  v_subrev_f32 v87, s72, v55
  v_subrev_f32 v88, s72, v56
  v_subrev_f32 v89, s72, v57
  v_add_f32 v72, v80, v81
  v_mul_f32 v73, v80, v80
  v_fmac_f32 v73, v81, v81
  v_add_f32 v72, v72, v82
  v_fmac_f32 v73, v82, v82
  v_add_f32 v72, v72, v83
  v_fmac_f32 v73, v83, v83
  v_add_f32 v72, v72, v84
  v_fmac_f32 v73, v84, v84
  v_add_f32 v72, v72, v85
  v_fmac_f32 v73, v85, v85
  v_add_f32 v72, v72, v86
  v_fmac_f32 v73, v86, v86
  v_add_f32 v72, v72, v87
  v_fmac_f32 v73, v87, v87
  v_add_f32 v72, v72, v88
  v_fmac_f32 v73, v88, v88
  v_add_f32 v72, v72, v89
  v_fmac_f32 v73, v89, v89
  s_nop 1
  v_add_f32_dpp v72, v72, v72 row_ror:8 row_mask:0xf bank_mask:0xf
  v_add_f32_dpp v73, v73, v73 row_ror:8 row_mask:0xf bank_mask:0xf
  s_nop 1
  v_add_f32_dpp v72, v72, v72 row_ror:4 row_mask:0xf bank_mask:0xf
  v_add_f32_dpp v73, v73, v73 row_ror:4 row_mask:0xf bank_mask:0xf
  s_nop 1
  v_add_f32_dpp v72, v72, v72 row_ror:2 row_mask:0xf bank_mask:0xf
  v_add_f32_dpp v73, v73, v73 row_ror:2 row_mask:0xf bank_mask:0xf
  s_nop 1
  v_add_f32_dpp v72, v72, v72 row_ror:1 row_mask:0xf bank_mask:0xf
  v_add_f32_dpp v73, v73, v73 row_ror:1 row_mask:0xf bank_mask:0xf
  s_nop 0
  v_readlane_b32 s64, v72, 0
  v_readlane_b32 s65, v72, 16
  v_readlane_b32 s66, v72, 32
  v_readlane_b32 s67, v72, 48
  v_readlane_b32 s68, v73, 0
  v_readlane_b32 s69, v73, 16
  v_readlane_b32 s70, v73, 32
  v_readlane_b32 s71, v73, 48
  v_mov_b32 v72, s64
  v_add_f32 v72, s65, v72
  v_add_f32 v72, s66, v72
  v_add_f32 v72, s67, v72
  v_mov_b32 v73, s68
  v_add_f32 v73, s69, v73
  v_add_f32 v73, s70, v73
  v_add_f32 v73, s71, v73
  v_mul_f32 v72, 0x3acccccd, v72
  v_mul_f32 v73, 0x3acccccd, v73
  v_fma_f32 v73, -v72, v72, v73
  v_max_f32 v73, 0, v73
  v_add_f32 v74, s72, v72
  v_cvt_pk_bf16_f32 v76, v74, v73
  v_lshlrev_b32 v74, 16, v76
  v_and_b32 v73, 0xffff0000, v76
  v_add_f32 v73, 0x3727c5ac, v73
  v_cvt_pk_bf16_f32 v76, v73, v73
  v_lshlrev_b32 v73, 16, v76
  v_sqrt_f32 v73, v73
  s_nop 0
  v_cvt_pk_bf16_f32 v76, v73, v73
  v_lshlrev_b32 v73, 16, v76
  v_rcp_f32 v75, v73
  v_sub_f32 v60, v48, v74
  v_sub_f32 v61, v49, v74
  v_sub_f32 v62, v50, v74
  v_sub_f32 v63, v51, v74
  v_sub_f32 v64, v52, v74
  v_sub_f32 v65, v53, v74
  v_sub_f32 v66, v54, v74
  v_sub_f32 v67, v55, v74
  v_sub_f32 v68, v56, v74
  v_sub_f32 v69, v57, v74
  v_cvt_pk_bf16_f32 v76, v60, v61
  v_lshlrev_b32 v60, 16, v76
  v_and_b32 v61, 0xffff0000, v76
  v_cvt_pk_bf16_f32 v77, v62, v63
  v_lshlrev_b32 v62, 16, v77
  v_and_b32 v63, 0xffff0000, v77
  v_cvt_pk_bf16_f32 v76, v64, v65
  v_lshlrev_b32 v64, 16, v76
  v_and_b32 v65, 0xffff0000, v76
  v_cvt_pk_bf16_f32 v77, v66, v67
  v_lshlrev_b32 v66, 16, v77
  v_and_b32 v67, 0xffff0000, v77
  v_cvt_pk_bf16_f32 v76, v68, v69
  v_lshlrev_b32 v68, 16, v76
  v_and_b32 v69, 0xffff0000, v76
  v_mul_f32 v60, v60, v75
  v_mul_f32 v61, v61, v75
  v_mul_f32 v62, v62, v75
  v_mul_f32 v63, v63, v75
  v_mul_f32 v64, v64, v75
  v_mul_f32 v65, v65, v75
  v_mul_f32 v66, v66, v75
  v_mul_f32 v67, v67, v75
  v_mul_f32 v68, v68, v75
  v_mul_f32 v69, v69, v75
  v_cvt_pk_bf16_f32 v76, v60, v61
  v_lshlrev_b32 v60, 16, v76
  v_and_b32 v61, 0xffff0000, v76
  v_cvt_pk_bf16_f32 v77, v62, v63
  v_lshlrev_b32 v62, 16, v77
  v_and_b32 v63, 0xffff0000, v77
  v_cvt_pk_bf16_f32 v76, v64, v65
  v_lshlrev_b32 v64, 16, v76
  v_and_b32 v65, 0xffff0000, v76
  v_cvt_pk_bf16_f32 v77, v66, v67
  v_lshlrev_b32 v66, 16, v77
  v_and_b32 v67, 0xffff0000, v77
  v_cvt_pk_bf16_f32 v76, v68, v69
  v_lshlrev_b32 v68, 16, v76
  v_and_b32 v69, 0xffff0000, v76
  v_cvt_pk_bf16_f32 v30, v60, v61
  buffer_store_dword v30, v21, s[52:55], s15 offen offset:0 sc1
  v_cvt_pk_bf16_f32 v31, v62, v63
  buffer_store_dword v31, v21, s[52:55], s15 offen offset:256 sc1
  v_cvt_pk_bf16_f32 v32, v64, v65
  buffer_store_dword v32, v21, s[52:55], s15 offen offset:512 sc1
  v_cvt_pk_bf16_f32 v33, v66, v67
  buffer_store_dword v33, v21, s[52:55], s15 offen offset:768 sc1
  v_cvt_pk_bf16_f32 v34, v68, v69
  buffer_store_dword v34, v21, s[52:55], s15 offen offset:1024 sc1
  s_waitcnt vmcnt(0)
  s_barrier
  s_cmp_lg_u32 s3, 0
  s_cbranch_scc1 Lsg_13
  v_mov_b32 v6, 0
  v_mov_b32 v7, 1
  s_mov_b64 s[88:89], exec
  s_mov_b64 exec, 1
  buffer_atomic_add v7, v6, s[84:87], s91 offen sc1
  s_mov_b64 exec, s[88:89]
Lsg_13:
Lbody_g1:
  s_mov_b32 s44, s42
  s_mov_b32 s45, s43
  s_mov_b32 s46, 1966080
  s_mov_b32 s47, 0x20000
  s_add_u32 s48, s42, 15728640
  s_addc_u32 s49, s43, 0
  s_mov_b32 s50, 2621440
  s_mov_b32 s51, 0x20000
  s_mul_i32 s6, s4, 96
  s_lshl_b32 s7, s5, 6
  s_and_b32 s74, s3, 3
  s_add_u32 s10, s6, 768
  s_mul_i32 s8, s10, 1280
  s_mul_i32 s9, s7, 1280
  s_add_u32 s10, s74, 0
  s_lshl_b32 s11, s10, 2
  v_add_u32 v6, s11, v3
  v_and_b32 v6, 7, v6
  v_xor_b32 v6, v6, v4
  s_lshl_b32 s11, s10, 3
  v_add_u32 v7, s11, v2
  v_mul_u32_u24 v7, 1280, v7
  v_lshl_add_u32 v24, v6, 4, v7
  s_lshl_b32 s64, s10, 10
  s_add_u32 s10, s74, 4
  s_lshl_b32 s11, s10, 2
  v_add_u32 v6, s11, v3
  v_and_b32 v6, 7, v6
  v_xor_b32 v6, v6, v4
  s_lshl_b32 s11, s10, 3
  v_add_u32 v7, s11, v2
  v_mul_u32_u24 v7, 1280, v7
  v_lshl_add_u32 v25, v6, 4, v7
  s_lshl_b32 s65, s10, 10
  s_add_u32 s10, s74, 8
  s_lshl_b32 s11, s10, 2
  v_add_u32 v6, s11, v3
  v_and_b32 v6, 7, v6
  v_xor_b32 v6, v6, v4
  s_lshl_b32 s11, s10, 3
  v_add_u32 v7, s11, v2
  v_mul_u32_u24 v7, 1280, v7
  v_lshl_add_u32 v26, v6, 4, v7
  s_lshl_b32 s66, s10, 10
  s_add_u32 s10, s74, 0
  s_lshl_b32 s11, s10, 2
  v_add_u32 v6, s11, v3
  v_and_b32 v6, 7, v6
  v_xor_b32 v6, v6, v4
  s_lshl_b32 s11, s10, 3
  v_add_u32 v7, s11, v2
  v_mul_u32_u24 v7, 1280, v7
  v_lshl_add_u32 v27, v6, 4, v7
  s_lshl_b32 s67, s10, 10
  s_add_u32 s10, s74, 4
  s_lshl_b32 s11, s10, 2
  v_add_u32 v6, s11, v3
  v_and_b32 v6, 7, v6
  v_xor_b32 v6, v6, v4
  s_lshl_b32 s11, s10, 3
  v_add_u32 v7, s11, v2
  v_mul_u32_u24 v7, 1280, v7
  v_lshl_add_u32 v28, v6, 4, v7
  s_lshl_b32 s68, s10, 10
  s_lshr_b32 s13, s74, 1
  s_and_b32 s14, s74, 1
  v_lshrrev_b32 v6, 1, v5
  v_xor_b32 v6, v6, v3
  v_lshlrev_b32 v6, 4, v6
  v_lshl_add_u32 v6, v5, 7, v6
  v_xor_b32 v7, 64, v6
  s_mul_i32 s10, s13, 6144
  s_add_u32 s10, s10, 81920
  s_mul_i32 s11, s14, 4096
  v_add_u32 v8, s10, v6
  v_add_u32 v10, s11, v6
  v_add_u32 v12, 65536, v10
  v_add_u32 v9, s10, v7
  v_add_u32 v11, s11, v7
  v_add_u32 v13, 65536, v11
  s_cmp_lg_u32 s3, 0
  s_cbranch_scc1 Lsw_14
  v_mov_b32 v6, 0
  s_setprio 3
Lsp_15:
  buffer_load_dword v7, v6, s[84:87], s91 offen sc1
  s_waitcnt vmcnt(0)
  v_cmp_gt_u32 vcc, 8, v7
  s_cbranch_vccnz Lsp_15
  s_setprio 0
Lsw_14:
  s_cmp_eq_u32 s75, 0
  s_cbranch_scc1 Lol_16
  s_add_u32 m0, s64, 81920
  s_nop 0
  buffer_load_dwordx4 v24, s[44:47], s8 offen lds
  s_add_u32 m0, s65, 81920
  s_nop 0
  buffer_load_dwordx4 v25, s[44:47], s8 offen lds
  s_add_u32 m0, s66, 81920
  s_nop 0
  buffer_load_dwordx4 v26, s[44:47], s8 offen lds
  s_add_u32 s8, s8, 128
  s_add_u32 m0, s64, 94208
  s_nop 0
  buffer_load_dwordx4 v24, s[44:47], s8 offen lds
  s_add_u32 m0, s65, 94208
  s_nop 0
  buffer_load_dwordx4 v25, s[44:47], s8 offen lds
  s_add_u32 m0, s66, 94208
  s_nop 0
  buffer_load_dwordx4 v26, s[44:47], s8 offen lds
  s_add_u32 s8, s8, 128
  s_add_u32 m0, s64, 106496
  s_nop 0
  buffer_load_dwordx4 v24, s[44:47], s8 offen lds
  s_add_u32 m0, s65, 106496
  s_nop 0
  buffer_load_dwordx4 v25, s[44:47], s8 offen lds
  s_add_u32 m0, s66, 106496
  s_nop 0
  buffer_load_dwordx4 v26, s[44:47], s8 offen lds
  s_add_u32 s8, s8, 128
  s_add_u32 m0, s64, 118784
  s_nop 0
  buffer_load_dwordx4 v24, s[44:47], s8 offen lds
  s_add_u32 m0, s65, 118784
  s_nop 0
  buffer_load_dwordx4 v25, s[44:47], s8 offen lds
  s_add_u32 m0, s66, 118784
  s_nop 0
  buffer_load_dwordx4 v26, s[44:47], s8 offen lds
  s_add_u32 s8, s8, 128
Lol_16:
  s_barrier
  s_cmp_eq_u32 s75, 0
  s_cbranch_scc1 Lol_17
  s_add_u32 m0, s67, 0
  s_nop 0
  buffer_load_dwordx4 v27, s[48:51], s9 offen sc1 lds
  s_add_u32 m0, s68, 0
  s_nop 0
  buffer_load_dwordx4 v28, s[48:51], s9 offen sc1 lds
  s_add_u32 s9, s9, 128
  s_add_u32 m0, s67, 8192
  s_nop 0
  buffer_load_dwordx4 v27, s[48:51], s9 offen sc1 lds
  s_add_u32 m0, s68, 8192
  s_nop 0
  buffer_load_dwordx4 v28, s[48:51], s9 offen sc1 lds
  s_add_u32 s9, s9, 128
  s_add_u32 m0, s67, 16384
  s_nop 0
  buffer_load_dwordx4 v27, s[48:51], s9 offen sc1 lds
  s_add_u32 m0, s68, 16384
  s_nop 0
  buffer_load_dwordx4 v28, s[48:51], s9 offen sc1 lds
  s_add_u32 s9, s9, 128
  s_add_u32 m0, s67, 24576
  s_nop 0
  buffer_load_dwordx4 v27, s[48:51], s9 offen sc1 lds
  s_add_u32 m0, s68, 24576
  s_nop 0
  buffer_load_dwordx4 v28, s[48:51], s9 offen sc1 lds
  s_add_u32 s9, s9, 128
  s_add_u32 m0, s67, 32768
  s_nop 0
  buffer_load_dwordx4 v27, s[48:51], s9 offen sc1 lds
  s_add_u32 m0, s68, 32768
  s_nop 0
  buffer_load_dwordx4 v28, s[48:51], s9 offen sc1 lds
  s_add_u32 s9, s9, 128
  s_add_u32 m0, s67, 40960
  s_nop 0
  buffer_load_dwordx4 v27, s[48:51], s9 offen sc1 lds
  s_add_u32 m0, s68, 40960
  s_nop 0
  buffer_load_dwordx4 v28, s[48:51], s9 offen sc1 lds
  s_add_u32 s9, s9, 128
  s_add_u32 m0, s67, 49152
  s_nop 0
  buffer_load_dwordx4 v27, s[48:51], s9 offen sc1 lds
  s_add_u32 m0, s68, 49152
  s_nop 0
  buffer_load_dwordx4 v28, s[48:51], s9 offen sc1 lds
  s_add_u32 s9, s9, 128
  s_add_u32 m0, s67, 57344
  s_nop 0
  buffer_load_dwordx4 v27, s[48:51], s9 offen sc1 lds
  s_add_u32 m0, s68, 57344
  s_nop 0
  buffer_load_dwordx4 v28, s[48:51], s9 offen sc1 lds
  s_add_u32 s9, s9, 128
  s_add_u32 m0, s67, 65536
  s_nop 0
  buffer_load_dwordx4 v27, s[48:51], s9 offen sc1 lds
  s_add_u32 m0, s68, 65536
  s_nop 0
  buffer_load_dwordx4 v28, s[48:51], s9 offen sc1 lds
  s_add_u32 s9, s9, 128
  s_add_u32 m0, s67, 73728
  s_nop 0
  buffer_load_dwordx4 v27, s[48:51], s9 offen sc1 lds
  s_add_u32 m0, s68, 73728
  s_nop 0
  buffer_load_dwordx4 v28, s[48:51], s9 offen sc1 lds
  s_add_u32 s9, s9, 128
Lol_17:
  s_add_u32 s52, s42, 18874368
  s_addc_u32 s53, s43, 0
  s_mov_b32 s54, 6291456
  s_mov_b32 s55, 0x20000
  s_mul_i32 s10, s101, 13631488
  s_add_u32 s10, s10, 25165824
  s_add_u32 s60, s42, s10
  s_addc_u32 s61, s43, 0
  s_mov_b32 s62, 3244032
  s_mov_b32 s63, 0x20000
  s_mul_i32 s10, s101, 524288
  s_add_u32 s10, s10, 35717120
  s_add_u32 s56, s42, s10
  s_addc_u32 s57, s43, 0
  s_mov_b32 s58, 524288
  s_mov_b32 s59, 0x20000
  v_add_u32 v6, 0, v23
  v_mul_u32_u24 v7, 43691, v6
  v_lshrrev_b32 v7, 19, v7
  v_mul_u32_u24 v20, 12, v7
  v_sub_u32 v20, v6, v20
  v_mul_u32_u24 v168, 208, v7
  v_lshl_add_u32 v168, v20, 4, v168
  v_add_u32 v168, 0, v168
  v_mul_u32_u24 v170, 3072, v7
  v_lshl_add_u32 v170, v20, 4, v170
  v_add_u32 v6, 512, v23
  v_mul_u32_u24 v7, 43691, v6
  v_lshrrev_b32 v7, 19, v7
  v_mul_u32_u24 v20, 12, v7
  v_sub_u32 v20, v6, v20
  v_mul_u32_u24 v169, 208, v7
  v_lshl_add_u32 v169, v20, 4, v169
  v_add_u32 v169, 0, v169
  v_mul_u32_u24 v171, 3072, v7
  v_lshl_add_u32 v171, v20, 4, v171
  v_cmp_gt_u32 vcc, 768, v6
  v_mov_b32 v22, 0x7ffffff0
  s_nop 0
  v_cndmask_b32 v171, v22, v171, vcc
  v_mov_b32 v22, 0
  v_cndmask_b32 v169, v22, v169, vcc
  v_add_u32 v6, 0, v23
  v_lshrrev_b32 v7, 3, v6
  v_and_b32 v20, 7, v6
  v_mul_u32_u24 v172, 144, v7
  v_lshl_add_u32 v172, v20, 4, v172
  v_add_u32 v172, 16384, v172
  v_mul_u32_u24 v174, 4224, v7
  v_lshl_add_u32 v174, v20, 4, v174
  v_add_u32 v6, 512, v23
  v_lshrrev_b32 v7, 3, v6
  v_and_b32 v20, 7, v6
  v_mul_u32_u24 v173, 144, v7
  v_lshl_add_u32 v173, v20, 4, v173
  v_add_u32 v173, 16384, v173
  v_mul_u32_u24 v175, 4224, v7
  v_lshl_add_u32 v175, v20, 4, v175
  v_cmp_gt_u32 vcc, 768, v6
  v_mov_b32 v22, 0x7ffffff0
  s_nop 0
  v_cndmask_b32 v175, v22, v175, vcc
  v_mov_b32 v22, 16384
  v_cndmask_b32 v173, v22, v173, vcc
  s_mul_i32 s15, s7, 3072
  s_lshl_b32 s11, s6, 1
  s_add_u32 s15, s15, s11
  s_mul_i32 s72, s6, 4224
  s_lshl_b32 s11, s7, 1
  s_add_u32 s72, s72, s11
  s_mul_i32 s10, s14, 6656
  s_mul_i32 s11, s13, 96
  s_add_u32 s10, s10, s11
  s_add_u32 s10, s10, 0
  v_mul_u32_u24 v20, 208, v5
  v_lshl_add_u32 v20, v3, 3, v20
  v_add_u32 v20, s10, v20
  s_mul_i32 s10, s13, 6912
  s_mul_i32 s11, s14, 64
  s_add_u32 s10, s10, s11
  s_add_u32 s10, s10, 16384
  v_mul_u32_u24 v21, 144, v5
  v_lshl_add_u32 v21, v3, 3, v21
  v_add_u32 v21, s10, v21
  s_mul_i32 s92, s101, 32
  s_add_u32 s92, s92, s5
  s_add_u32 s92, s92, 96
  s_lshl_b32 s92, s92, 7
  s_cmp_lg_u32 s75, 0
  s_cbranch_scc1 Lld_18
  v_mov_b32 v120, 0
  v_mov_b32 v121, 0
  v_mov_b32 v122, 0
  v_mov_b32 v123, 0
  v_mov_b32 v124, 0
  v_mov_b32 v125, 0
  v_mov_b32 v126, 0
  v_mov_b32 v127, 0
  v_mov_b32 v128, 0
  v_mov_b32 v129, 0
  v_mov_b32 v130, 0
  v_mov_b32 v131, 0
  v_mov_b32 v132, 0
  v_mov_b32 v133, 0
  v_mov_b32 v134, 0
  v_mov_b32 v135, 0
  v_mov_b32 v136, 0
  v_mov_b32 v137, 0
  v_mov_b32 v138, 0
  v_mov_b32 v139, 0
  v_mov_b32 v140, 0
  v_mov_b32 v141, 0
  v_mov_b32 v142, 0
  v_mov_b32 v143, 0
  v_mov_b32 v144, 0
  v_mov_b32 v145, 0
  v_mov_b32 v146, 0
  v_mov_b32 v147, 0
  v_mov_b32 v148, 0
  v_mov_b32 v149, 0
  v_mov_b32 v150, 0
  v_mov_b32 v151, 0
  v_mov_b32 v152, 0
  v_mov_b32 v153, 0
  v_mov_b32 v154, 0
  v_mov_b32 v155, 0
  v_mov_b32 v156, 0
  v_mov_b32 v157, 0
  v_mov_b32 v158, 0
  v_mov_b32 v159, 0
  v_mov_b32 v160, 0
  v_mov_b32 v161, 0
  v_mov_b32 v162, 0
  v_mov_b32 v163, 0
  v_mov_b32 v164, 0
  v_mov_b32 v165, 0
  v_mov_b32 v166, 0
  v_mov_b32 v167, 0
  s_barrier
  ds_read_b128 v[40:43], v8 offset:0
  ds_read_b128 v[44:47], v8 offset:2048
  ds_read_b128 v[48:51], v8 offset:4096
  ds_read_b128 v[52:55], v10 offset:0
  ds_read_b128 v[56:59], v10 offset:2048
  ds_read_b128 v[60:63], v9 offset:0
  ds_read_b128 v[64:67], v9 offset:2048
  ds_read_b128 v[68:71], v9 offset:4096
  ds_read_b128 v[72:75], v11 offset:0
  ds_read_b128 v[76:79], v11 offset:2048
  s_waitcnt lgkmcnt(0)
  s_barrier
  ds_read_b128 v[80:83], v8 offset:12288
  ds_read_b128 v[84:87], v8 offset:14336
  ds_read_b128 v[88:91], v8 offset:16384
  ds_read_b128 v[92:95], v10 offset:8192
  ds_read_b128 v[96:99], v10 offset:10240
  ds_read_b128 v[100:103], v9 offset:12288
  ds_read_b128 v[104:107], v9 offset:14336
  ds_read_b128 v[108:111], v9 offset:16384
  ds_read_b128 v[112:115], v11 offset:8192
  ds_read_b128 v[116:119], v11 offset:10240
  v_mfma_f32_16x16x32_bf16 v[120:123], v[52:55], v[40:43], v[120:123]
  v_mfma_f32_16x16x32_bf16 v[124:127], v[56:59], v[40:43], v[124:127]
  v_mfma_f32_16x16x32_bf16 v[128:131], v[52:55], v[44:47], v[128:131]
  v_mfma_f32_16x16x32_bf16 v[132:135], v[56:59], v[44:47], v[132:135]
  v_mfma_f32_16x16x32_bf16 v[136:139], v[52:55], v[48:51], v[136:139]
  v_mfma_f32_16x16x32_bf16 v[140:143], v[56:59], v[48:51], v[140:143]
  v_mfma_f32_16x16x32_bf16 v[120:123], v[72:75], v[60:63], v[120:123]
  v_mfma_f32_16x16x32_bf16 v[124:127], v[76:79], v[60:63], v[124:127]
  v_mfma_f32_16x16x32_bf16 v[128:131], v[72:75], v[64:67], v[128:131]
  v_mfma_f32_16x16x32_bf16 v[132:135], v[76:79], v[64:67], v[132:135]
  v_mfma_f32_16x16x32_bf16 v[136:139], v[72:75], v[68:71], v[136:139]
  v_mfma_f32_16x16x32_bf16 v[140:143], v[76:79], v[68:71], v[140:143]
  s_waitcnt lgkmcnt(0)
  s_barrier
  ds_read_b128 v[40:43], v8 offset:24576
  ds_read_b128 v[44:47], v8 offset:26624
  ds_read_b128 v[48:51], v8 offset:28672
  ds_read_b128 v[52:55], v10 offset:16384
  ds_read_b128 v[56:59], v10 offset:18432
  ds_read_b128 v[60:63], v9 offset:24576
  ds_read_b128 v[64:67], v9 offset:26624
  ds_read_b128 v[68:71], v9 offset:28672
  ds_read_b128 v[72:75], v11 offset:16384
  ds_read_b128 v[76:79], v11 offset:18432
  v_mfma_f32_16x16x32_bf16 v[120:123], v[92:95], v[80:83], v[120:123]
  v_mfma_f32_16x16x32_bf16 v[124:127], v[96:99], v[80:83], v[124:127]
  v_mfma_f32_16x16x32_bf16 v[128:131], v[92:95], v[84:87], v[128:131]
  v_mfma_f32_16x16x32_bf16 v[132:135], v[96:99], v[84:87], v[132:135]
  v_mfma_f32_16x16x32_bf16 v[136:139], v[92:95], v[88:91], v[136:139]
  v_mfma_f32_16x16x32_bf16 v[140:143], v[96:99], v[88:91], v[140:143]
  v_mfma_f32_16x16x32_bf16 v[120:123], v[112:115], v[100:103], v[120:123]
  v_mfma_f32_16x16x32_bf16 v[124:127], v[116:119], v[100:103], v[124:127]
  v_mfma_f32_16x16x32_bf16 v[128:131], v[112:115], v[104:107], v[128:131]
  v_mfma_f32_16x16x32_bf16 v[132:135], v[116:119], v[104:107], v[132:135]
  v_mfma_f32_16x16x32_bf16 v[136:139], v[112:115], v[108:111], v[136:139]
  v_mfma_f32_16x16x32_bf16 v[140:143], v[116:119], v[108:111], v[140:143]
  s_waitcnt lgkmcnt(0)
  s_barrier
  ds_read_b128 v[80:83], v8 offset:36864
  ds_read_b128 v[84:87], v8 offset:38912
  ds_read_b128 v[88:91], v8 offset:40960
  ds_read_b128 v[92:95], v10 offset:24576
  ds_read_b128 v[96:99], v10 offset:26624
  ds_read_b128 v[100:103], v9 offset:36864
  ds_read_b128 v[104:107], v9 offset:38912
  ds_read_b128 v[108:111], v9 offset:40960
  ds_read_b128 v[112:115], v11 offset:24576
  ds_read_b128 v[116:119], v11 offset:26624
  v_mfma_f32_16x16x32_bf16 v[120:123], v[52:55], v[40:43], v[120:123]
  v_mfma_f32_16x16x32_bf16 v[124:127], v[56:59], v[40:43], v[124:127]
  v_mfma_f32_16x16x32_bf16 v[128:131], v[52:55], v[44:47], v[128:131]
  v_mfma_f32_16x16x32_bf16 v[132:135], v[56:59], v[44:47], v[132:135]
  v_mfma_f32_16x16x32_bf16 v[136:139], v[52:55], v[48:51], v[136:139]
  v_mfma_f32_16x16x32_bf16 v[140:143], v[56:59], v[48:51], v[140:143]
  v_mfma_f32_16x16x32_bf16 v[120:123], v[72:75], v[60:63], v[120:123]
  v_mfma_f32_16x16x32_bf16 v[124:127], v[76:79], v[60:63], v[124:127]
  v_mfma_f32_16x16x32_bf16 v[128:131], v[72:75], v[64:67], v[128:131]
  v_mfma_f32_16x16x32_bf16 v[132:135], v[76:79], v[64:67], v[132:135]
  v_mfma_f32_16x16x32_bf16 v[136:139], v[72:75], v[68:71], v[136:139]
  v_mfma_f32_16x16x32_bf16 v[140:143], v[76:79], v[68:71], v[140:143]
  s_waitcnt lgkmcnt(0)
  s_barrier
  ds_read_b128 v[40:43], v8 offset:49152
  ds_read_b128 v[44:47], v8 offset:51200
  ds_read_b128 v[48:51], v8 offset:53248
  ds_read_b128 v[52:55], v10 offset:32768
  ds_read_b128 v[56:59], v10 offset:34816
  ds_read_b128 v[60:63], v9 offset:49152
  ds_read_b128 v[64:67], v9 offset:51200
  ds_read_b128 v[68:71], v9 offset:53248
  ds_read_b128 v[72:75], v11 offset:32768
  ds_read_b128 v[76:79], v11 offset:34816
  v_mfma_f32_16x16x32_bf16 v[120:123], v[92:95], v[80:83], v[120:123]
  v_mfma_f32_16x16x32_bf16 v[124:127], v[96:99], v[80:83], v[124:127]
  v_mfma_f32_16x16x32_bf16 v[128:131], v[92:95], v[84:87], v[128:131]
  v_mfma_f32_16x16x32_bf16 v[132:135], v[96:99], v[84:87], v[132:135]
  v_mfma_f32_16x16x32_bf16 v[136:139], v[92:95], v[88:91], v[136:139]
  v_mfma_f32_16x16x32_bf16 v[140:143], v[96:99], v[88:91], v[140:143]
  v_mfma_f32_16x16x32_bf16 v[120:123], v[112:115], v[100:103], v[120:123]
  v_mfma_f32_16x16x32_bf16 v[124:127], v[116:119], v[100:103], v[124:127]
  v_mfma_f32_16x16x32_bf16 v[128:131], v[112:115], v[104:107], v[128:131]
  v_mfma_f32_16x16x32_bf16 v[132:135], v[116:119], v[104:107], v[132:135]
  v_mfma_f32_16x16x32_bf16 v[136:139], v[112:115], v[108:111], v[136:139]
  v_mfma_f32_16x16x32_bf16 v[140:143], v[116:119], v[108:111], v[140:143]
  s_waitcnt lgkmcnt(0)
  s_barrier
  ds_read_b128 v[80:83], v8 offset:0
  ds_read_b128 v[84:87], v8 offset:2048
  ds_read_b128 v[88:91], v8 offset:4096
  ds_read_b128 v[92:95], v10 offset:40960
  ds_read_b128 v[96:99], v10 offset:43008
  ds_read_b128 v[100:103], v9 offset:0
  ds_read_b128 v[104:107], v9 offset:2048
  ds_read_b128 v[108:111], v9 offset:4096
  ds_read_b128 v[112:115], v11 offset:40960
  ds_read_b128 v[116:119], v11 offset:43008
  v_mfma_f32_16x16x32_bf16 v[120:123], v[52:55], v[40:43], v[120:123]
  v_mfma_f32_16x16x32_bf16 v[124:127], v[56:59], v[40:43], v[124:127]
  v_mfma_f32_16x16x32_bf16 v[128:131], v[52:55], v[44:47], v[128:131]
  v_mfma_f32_16x16x32_bf16 v[132:135], v[56:59], v[44:47], v[132:135]
  v_mfma_f32_16x16x32_bf16 v[136:139], v[52:55], v[48:51], v[136:139]
  v_mfma_f32_16x16x32_bf16 v[140:143], v[56:59], v[48:51], v[140:143]
  v_mfma_f32_16x16x32_bf16 v[120:123], v[72:75], v[60:63], v[120:123]
  v_mfma_f32_16x16x32_bf16 v[124:127], v[76:79], v[60:63], v[124:127]
  v_mfma_f32_16x16x32_bf16 v[128:131], v[72:75], v[64:67], v[128:131]
  v_mfma_f32_16x16x32_bf16 v[132:135], v[76:79], v[64:67], v[132:135]
  v_mfma_f32_16x16x32_bf16 v[136:139], v[72:75], v[68:71], v[136:139]
  v_mfma_f32_16x16x32_bf16 v[140:143], v[76:79], v[68:71], v[140:143]
  s_waitcnt lgkmcnt(0)
  s_barrier
  ds_read_b128 v[40:43], v8 offset:12288
  ds_read_b128 v[44:47], v8 offset:14336
  ds_read_b128 v[48:51], v8 offset:16384
  ds_read_b128 v[52:55], v10 offset:49152
  ds_read_b128 v[56:59], v10 offset:51200
  ds_read_b128 v[60:63], v9 offset:12288
  ds_read_b128 v[64:67], v9 offset:14336
  ds_read_b128 v[68:71], v9 offset:16384
  ds_read_b128 v[72:75], v11 offset:49152
  ds_read_b128 v[76:79], v11 offset:51200
  v_mfma_f32_16x16x32_bf16 v[120:123], v[92:95], v[80:83], v[120:123]
  v_mfma_f32_16x16x32_bf16 v[124:127], v[96:99], v[80:83], v[124:127]
  v_mfma_f32_16x16x32_bf16 v[128:131], v[92:95], v[84:87], v[128:131]
  v_mfma_f32_16x16x32_bf16 v[132:135], v[96:99], v[84:87], v[132:135]
  v_mfma_f32_16x16x32_bf16 v[136:139], v[92:95], v[88:91], v[136:139]
  v_mfma_f32_16x16x32_bf16 v[140:143], v[96:99], v[88:91], v[140:143]
  v_mfma_f32_16x16x32_bf16 v[120:123], v[112:115], v[100:103], v[120:123]
  v_mfma_f32_16x16x32_bf16 v[124:127], v[116:119], v[100:103], v[124:127]
  v_mfma_f32_16x16x32_bf16 v[128:131], v[112:115], v[104:107], v[128:131]
  v_mfma_f32_16x16x32_bf16 v[132:135], v[116:119], v[104:107], v[132:135]
  v_mfma_f32_16x16x32_bf16 v[136:139], v[112:115], v[108:111], v[136:139]
  v_mfma_f32_16x16x32_bf16 v[140:143], v[116:119], v[108:111], v[140:143]
  s_waitcnt lgkmcnt(0)
  s_barrier
  ds_read_b128 v[80:83], v8 offset:24576
  ds_read_b128 v[84:87], v8 offset:26624
  ds_read_b128 v[88:91], v8 offset:28672
  ds_read_b128 v[92:95], v10 offset:57344
  ds_read_b128 v[96:99], v10 offset:59392
  ds_read_b128 v[100:103], v9 offset:24576
  ds_read_b128 v[104:107], v9 offset:26624
  ds_read_b128 v[108:111], v9 offset:28672
  ds_read_b128 v[112:115], v11 offset:57344
  ds_read_b128 v[116:119], v11 offset:59392
  v_mfma_f32_16x16x32_bf16 v[120:123], v[52:55], v[40:43], v[120:123]
  v_mfma_f32_16x16x32_bf16 v[124:127], v[56:59], v[40:43], v[124:127]
  v_mfma_f32_16x16x32_bf16 v[128:131], v[52:55], v[44:47], v[128:131]
  v_mfma_f32_16x16x32_bf16 v[132:135], v[56:59], v[44:47], v[132:135]
  v_mfma_f32_16x16x32_bf16 v[136:139], v[52:55], v[48:51], v[136:139]
  v_mfma_f32_16x16x32_bf16 v[140:143], v[56:59], v[48:51], v[140:143]
  v_mfma_f32_16x16x32_bf16 v[120:123], v[72:75], v[60:63], v[120:123]
  v_mfma_f32_16x16x32_bf16 v[124:127], v[76:79], v[60:63], v[124:127]
  v_mfma_f32_16x16x32_bf16 v[128:131], v[72:75], v[64:67], v[128:131]
  v_mfma_f32_16x16x32_bf16 v[132:135], v[76:79], v[64:67], v[132:135]
  v_mfma_f32_16x16x32_bf16 v[136:139], v[72:75], v[68:71], v[136:139]
  v_mfma_f32_16x16x32_bf16 v[140:143], v[76:79], v[68:71], v[140:143]
  s_waitcnt lgkmcnt(0)
  s_barrier
  ds_read_b128 v[40:43], v8 offset:36864
  ds_read_b128 v[44:47], v8 offset:38912
  ds_read_b128 v[48:51], v8 offset:40960
  ds_read_b128 v[52:55], v12 offset:0
  ds_read_b128 v[56:59], v12 offset:2048
  ds_read_b128 v[60:63], v9 offset:36864
  ds_read_b128 v[64:67], v9 offset:38912
  ds_read_b128 v[68:71], v9 offset:40960
  ds_read_b128 v[72:75], v13 offset:0
  ds_read_b128 v[76:79], v13 offset:2048
  v_mfma_f32_16x16x32_bf16 v[120:123], v[92:95], v[80:83], v[120:123]
  v_mfma_f32_16x16x32_bf16 v[124:127], v[96:99], v[80:83], v[124:127]
  v_mfma_f32_16x16x32_bf16 v[128:131], v[92:95], v[84:87], v[128:131]
  v_mfma_f32_16x16x32_bf16 v[132:135], v[96:99], v[84:87], v[132:135]
  v_mfma_f32_16x16x32_bf16 v[136:139], v[92:95], v[88:91], v[136:139]
  v_mfma_f32_16x16x32_bf16 v[140:143], v[96:99], v[88:91], v[140:143]
  v_mfma_f32_16x16x32_bf16 v[120:123], v[112:115], v[100:103], v[120:123]
  v_mfma_f32_16x16x32_bf16 v[124:127], v[116:119], v[100:103], v[124:127]
  v_mfma_f32_16x16x32_bf16 v[128:131], v[112:115], v[104:107], v[128:131]
  v_mfma_f32_16x16x32_bf16 v[132:135], v[116:119], v[104:107], v[132:135]
  v_mfma_f32_16x16x32_bf16 v[136:139], v[112:115], v[108:111], v[136:139]
  v_mfma_f32_16x16x32_bf16 v[140:143], v[116:119], v[108:111], v[140:143]
  s_waitcnt lgkmcnt(0)
  s_barrier
  ds_read_b128 v[80:83], v8 offset:49152
  ds_read_b128 v[84:87], v8 offset:51200
  ds_read_b128 v[88:91], v8 offset:53248
  ds_read_b128 v[92:95], v12 offset:8192
  ds_read_b128 v[96:99], v12 offset:10240
  ds_read_b128 v[100:103], v9 offset:49152
  ds_read_b128 v[104:107], v9 offset:51200
  ds_read_b128 v[108:111], v9 offset:53248
  ds_read_b128 v[112:115], v13 offset:8192
  ds_read_b128 v[116:119], v13 offset:10240
  v_mfma_f32_16x16x32_bf16 v[120:123], v[52:55], v[40:43], v[120:123]
  v_mfma_f32_16x16x32_bf16 v[124:127], v[56:59], v[40:43], v[124:127]
  v_mfma_f32_16x16x32_bf16 v[128:131], v[52:55], v[44:47], v[128:131]
  v_mfma_f32_16x16x32_bf16 v[132:135], v[56:59], v[44:47], v[132:135]
  v_mfma_f32_16x16x32_bf16 v[136:139], v[52:55], v[48:51], v[136:139]
  v_mfma_f32_16x16x32_bf16 v[140:143], v[56:59], v[48:51], v[140:143]
  v_mfma_f32_16x16x32_bf16 v[120:123], v[72:75], v[60:63], v[120:123]
  v_mfma_f32_16x16x32_bf16 v[124:127], v[76:79], v[60:63], v[124:127]
  v_mfma_f32_16x16x32_bf16 v[128:131], v[72:75], v[64:67], v[128:131]
  v_mfma_f32_16x16x32_bf16 v[132:135], v[76:79], v[64:67], v[132:135]
  v_mfma_f32_16x16x32_bf16 v[136:139], v[72:75], v[68:71], v[136:139]
  v_mfma_f32_16x16x32_bf16 v[140:143], v[76:79], v[68:71], v[140:143]
  s_waitcnt lgkmcnt(0)
  v_mfma_f32_16x16x32_bf16 v[120:123], v[92:95], v[80:83], v[120:123]
  v_mfma_f32_16x16x32_bf16 v[124:127], v[96:99], v[80:83], v[124:127]
  v_mfma_f32_16x16x32_bf16 v[128:131], v[92:95], v[84:87], v[128:131]
  v_mfma_f32_16x16x32_bf16 v[132:135], v[96:99], v[84:87], v[132:135]
  v_mfma_f32_16x16x32_bf16 v[136:139], v[92:95], v[88:91], v[136:139]
  v_mfma_f32_16x16x32_bf16 v[140:143], v[96:99], v[88:91], v[140:143]
  v_mfma_f32_16x16x32_bf16 v[120:123], v[112:115], v[100:103], v[120:123]
  v_mfma_f32_16x16x32_bf16 v[124:127], v[116:119], v[100:103], v[124:127]
  v_mfma_f32_16x16x32_bf16 v[128:131], v[112:115], v[104:107], v[128:131]
  v_mfma_f32_16x16x32_bf16 v[132:135], v[116:119], v[104:107], v[132:135]
  v_mfma_f32_16x16x32_bf16 v[136:139], v[112:115], v[108:111], v[136:139]
  v_mfma_f32_16x16x32_bf16 v[140:143], v[116:119], v[108:111], v[140:143]
  s_mov_b32 s78, 0xbdd2d3e8
  s_mov_b32 s79, 0xbdd2d3e8
  v_mov_b32 v42, 0xc0135761
  v_mov_b32 v43, 0xc0135761
  s_nop 6
  v_cvt_pk_bf16_f32 v72, v120, v121
  v_cvt_pk_bf16_f32 v73, v122, v123
  v_cvt_pk_bf16_f32 v74, v124, v125
  v_cvt_pk_bf16_f32 v75, v126, v127
  v_cvt_pk_bf16_f32 v76, v128, v129
  v_cvt_pk_bf16_f32 v77, v130, v131
  v_cvt_pk_bf16_f32 v78, v132, v133
  v_cvt_pk_bf16_f32 v79, v134, v135
  v_cvt_pk_bf16_f32 v80, v136, v137
  v_cvt_pk_bf16_f32 v81, v138, v139
  v_cvt_pk_bf16_f32 v82, v140, v141
  v_cvt_pk_bf16_f32 v83, v142, v143
  v_lshlrev_b32 v120, 16, v72
  v_and_b32 v121, 0xffff0000, v72
  v_lshlrev_b32 v122, 16, v73
  v_and_b32 v123, 0xffff0000, v73
  v_lshlrev_b32 v124, 16, v74
  v_and_b32 v125, 0xffff0000, v74
  v_lshlrev_b32 v126, 16, v75
  v_and_b32 v127, 0xffff0000, v75
  v_lshlrev_b32 v128, 16, v76
  v_and_b32 v129, 0xffff0000, v76
  v_lshlrev_b32 v130, 16, v77
  v_and_b32 v131, 0xffff0000, v77
  v_lshlrev_b32 v132, 16, v78
  v_and_b32 v133, 0xffff0000, v78
  v_lshlrev_b32 v134, 16, v79
  v_and_b32 v135, 0xffff0000, v79
  v_lshlrev_b32 v136, 16, v80
  v_and_b32 v137, 0xffff0000, v80
  v_lshlrev_b32 v138, 16, v81
  v_and_b32 v139, 0xffff0000, v81
  v_lshlrev_b32 v140, 16, v82
  v_and_b32 v141, 0xffff0000, v82
  v_lshlrev_b32 v142, 16, v83
  v_and_b32 v143, 0xffff0000, v83
  v_pk_mul_f32 v[72:73], v[120:121], v[120:121]
  v_pk_mul_f32 v[74:75], v[122:123], v[122:123]
  v_pk_mul_f32 v[76:77], v[124:125], v[124:125]
  v_pk_mul_f32 v[78:79], v[126:127], v[126:127]
  v_pk_mul_f32 v[80:81], v[128:129], v[128:129]
  v_pk_mul_f32 v[82:83], v[130:131], v[130:131]
  v_pk_mul_f32 v[84:85], v[132:133], v[132:133]
  v_pk_mul_f32 v[86:87], v[134:135], v[134:135]
  v_pk_mul_f32 v[88:89], v[136:137], v[136:137]
  v_pk_mul_f32 v[90:91], v[138:139], v[138:139]
  v_pk_mul_f32 v[92:93], v[140:141], v[140:141]
  v_pk_mul_f32 v[94:95], v[142:143], v[142:143]
  v_pk_fma_f32 v[72:73], v[72:73], s[78:79], v[42:43]
  v_pk_fma_f32 v[74:75], v[74:75], s[78:79], v[42:43]
  v_pk_fma_f32 v[76:77], v[76:77], s[78:79], v[42:43]
  v_pk_fma_f32 v[78:79], v[78:79], s[78:79], v[42:43]
  v_pk_fma_f32 v[80:81], v[80:81], s[78:79], v[42:43]
  v_pk_fma_f32 v[82:83], v[82:83], s[78:79], v[42:43]
  v_pk_fma_f32 v[84:85], v[84:85], s[78:79], v[42:43]
  v_pk_fma_f32 v[86:87], v[86:87], s[78:79], v[42:43]
  v_pk_fma_f32 v[88:89], v[88:89], s[78:79], v[42:43]
  v_pk_fma_f32 v[90:91], v[90:91], s[78:79], v[42:43]
  v_pk_fma_f32 v[92:93], v[92:93], s[78:79], v[42:43]
  v_pk_fma_f32 v[94:95], v[94:95], s[78:79], v[42:43]
  v_pk_mul_f32 v[72:73], v[72:73], v[120:121]
  v_pk_mul_f32 v[74:75], v[74:75], v[122:123]
  v_pk_mul_f32 v[76:77], v[76:77], v[124:125]
  v_pk_mul_f32 v[78:79], v[78:79], v[126:127]
  v_pk_mul_f32 v[80:81], v[80:81], v[128:129]
  v_pk_mul_f32 v[82:83], v[82:83], v[130:131]
  v_pk_mul_f32 v[84:85], v[84:85], v[132:133]
  v_pk_mul_f32 v[86:87], v[86:87], v[134:135]
  v_pk_mul_f32 v[88:89], v[88:89], v[136:137]
  v_pk_mul_f32 v[90:91], v[90:91], v[138:139]
  v_pk_mul_f32 v[92:93], v[92:93], v[140:141]
  v_pk_mul_f32 v[94:95], v[94:95], v[142:143]
  v_exp_f32 v72, v72
  v_exp_f32 v73, v73
  v_exp_f32 v74, v74
  v_exp_f32 v75, v75
  v_exp_f32 v76, v76
  v_exp_f32 v77, v77
  v_exp_f32 v78, v78
  v_exp_f32 v79, v79
  v_exp_f32 v80, v80
  v_exp_f32 v81, v81
  v_exp_f32 v82, v82
  v_exp_f32 v83, v83
  v_exp_f32 v84, v84
  v_exp_f32 v85, v85
  v_exp_f32 v86, v86
  v_exp_f32 v87, v87
  v_exp_f32 v88, v88
  v_exp_f32 v89, v89
  v_exp_f32 v90, v90
  v_exp_f32 v91, v91
  v_exp_f32 v92, v92
  v_exp_f32 v93, v93
  v_exp_f32 v94, v94
  v_exp_f32 v95, v95
  s_nop 0
  v_pk_add_f32 v[72:73], v[72:73], 1.0 op_sel_hi:[1,0]
  v_pk_add_f32 v[74:75], v[74:75], 1.0 op_sel_hi:[1,0]
  v_pk_add_f32 v[76:77], v[76:77], 1.0 op_sel_hi:[1,0]
  v_pk_add_f32 v[78:79], v[78:79], 1.0 op_sel_hi:[1,0]
  v_pk_add_f32 v[80:81], v[80:81], 1.0 op_sel_hi:[1,0]
  v_pk_add_f32 v[82:83], v[82:83], 1.0 op_sel_hi:[1,0]
  v_pk_add_f32 v[84:85], v[84:85], 1.0 op_sel_hi:[1,0]
  v_pk_add_f32 v[86:87], v[86:87], 1.0 op_sel_hi:[1,0]
  v_pk_add_f32 v[88:89], v[88:89], 1.0 op_sel_hi:[1,0]
  v_pk_add_f32 v[90:91], v[90:91], 1.0 op_sel_hi:[1,0]
  v_pk_add_f32 v[92:93], v[92:93], 1.0 op_sel_hi:[1,0]
  v_pk_add_f32 v[94:95], v[94:95], 1.0 op_sel_hi:[1,0]
  v_rcp_f32 v72, v72
  v_rcp_f32 v73, v73
  v_rcp_f32 v74, v74
  v_rcp_f32 v75, v75
  v_rcp_f32 v76, v76
  v_rcp_f32 v77, v77
  v_rcp_f32 v78, v78
  v_rcp_f32 v79, v79
  v_rcp_f32 v80, v80
  v_rcp_f32 v81, v81
  v_rcp_f32 v82, v82
  v_rcp_f32 v83, v83
  v_rcp_f32 v84, v84
  v_rcp_f32 v85, v85
  v_rcp_f32 v86, v86
  v_rcp_f32 v87, v87
  v_rcp_f32 v88, v88
  v_rcp_f32 v89, v89
  v_rcp_f32 v90, v90
  v_rcp_f32 v91, v91
  v_rcp_f32 v92, v92
  v_rcp_f32 v93, v93
  v_rcp_f32 v94, v94
  v_rcp_f32 v95, v95
  s_nop 0
  v_pk_mul_f32 v[120:121], v[120:121], v[72:73]
  v_pk_mul_f32 v[122:123], v[122:123], v[74:75]
  v_pk_mul_f32 v[124:125], v[124:125], v[76:77]
  v_pk_mul_f32 v[126:127], v[126:127], v[78:79]
  v_pk_mul_f32 v[128:129], v[128:129], v[80:81]
  v_pk_mul_f32 v[130:131], v[130:131], v[82:83]
  v_pk_mul_f32 v[132:133], v[132:133], v[84:85]
  v_pk_mul_f32 v[134:135], v[134:135], v[86:87]
  v_pk_mul_f32 v[136:137], v[136:137], v[88:89]
  v_pk_mul_f32 v[138:139], v[138:139], v[90:91]
  v_pk_mul_f32 v[140:141], v[140:141], v[92:93]
  v_pk_mul_f32 v[142:143], v[142:143], v[94:95]
  v_cvt_pk_bf16_f32 v72, v120, v121
  v_cvt_pk_bf16_f32 v73, v122, v123
  v_cvt_pk_bf16_f32 v74, v124, v125
  v_cvt_pk_bf16_f32 v75, v126, v127
  v_cvt_pk_bf16_f32 v76, v128, v129
  v_cvt_pk_bf16_f32 v77, v130, v131
  v_cvt_pk_bf16_f32 v78, v132, v133
  v_cvt_pk_bf16_f32 v79, v134, v135
  v_cvt_pk_bf16_f32 v80, v136, v137
  v_cvt_pk_bf16_f32 v81, v138, v139
  v_cvt_pk_bf16_f32 v82, v140, v141
  v_cvt_pk_bf16_f32 v83, v142, v143
  v_lshlrev_b32 v120, 16, v72
  v_and_b32 v121, 0xffff0000, v72
  v_lshlrev_b32 v122, 16, v73
  v_and_b32 v123, 0xffff0000, v73
  v_lshlrev_b32 v124, 16, v74
  v_and_b32 v125, 0xffff0000, v74
  v_lshlrev_b32 v126, 16, v75
  v_and_b32 v127, 0xffff0000, v75
  v_lshlrev_b32 v128, 16, v76
  v_and_b32 v129, 0xffff0000, v76
  v_lshlrev_b32 v130, 16, v77
  v_and_b32 v131, 0xffff0000, v77
  v_lshlrev_b32 v132, 16, v78
  v_and_b32 v133, 0xffff0000, v78
  v_lshlrev_b32 v134, 16, v79
  v_and_b32 v135, 0xffff0000, v79
  v_lshlrev_b32 v136, 16, v80
  v_and_b32 v137, 0xffff0000, v80
  v_lshlrev_b32 v138, 16, v81
  v_and_b32 v139, 0xffff0000, v81
  v_lshlrev_b32 v140, 16, v82
  v_and_b32 v141, 0xffff0000, v82
  v_lshlrev_b32 v142, 16, v83
  v_and_b32 v143, 0xffff0000, v83
  v_pk_add_f32 v[48:49], v[120:121], v[128:129]
  v_pk_add_f32 v[48:49], v[48:49], v[136:137]
  v_pk_add_f32 v[50:51], v[122:123], v[130:131]
  v_pk_add_f32 v[50:51], v[50:51], v[138:139]
  v_pk_add_f32 v[52:53], v[124:125], v[132:133]
  v_pk_add_f32 v[52:53], v[52:53], v[140:141]
  v_pk_add_f32 v[54:55], v[126:127], v[134:135]
  v_pk_add_f32 v[54:55], v[54:55], v[142:143]
  s_nop 1
  v_add_f32_dpp v48, v48, v48 row_ror:8 row_mask:0xf bank_mask:0xf
  v_add_f32_dpp v49, v49, v49 row_ror:8 row_mask:0xf bank_mask:0xf
  v_add_f32_dpp v50, v50, v50 row_ror:8 row_mask:0xf bank_mask:0xf
  v_add_f32_dpp v51, v51, v51 row_ror:8 row_mask:0xf bank_mask:0xf
  v_add_f32_dpp v52, v52, v52 row_ror:8 row_mask:0xf bank_mask:0xf
  v_add_f32_dpp v53, v53, v53 row_ror:8 row_mask:0xf bank_mask:0xf
  v_add_f32_dpp v54, v54, v54 row_ror:8 row_mask:0xf bank_mask:0xf
  v_add_f32_dpp v55, v55, v55 row_ror:8 row_mask:0xf bank_mask:0xf
  v_add_f32_dpp v48, v48, v48 row_ror:4 row_mask:0xf bank_mask:0xf
  v_add_f32_dpp v49, v49, v49 row_ror:4 row_mask:0xf bank_mask:0xf
  v_add_f32_dpp v50, v50, v50 row_ror:4 row_mask:0xf bank_mask:0xf
  v_add_f32_dpp v51, v51, v51 row_ror:4 row_mask:0xf bank_mask:0xf
  v_add_f32_dpp v52, v52, v52 row_ror:4 row_mask:0xf bank_mask:0xf
  v_add_f32_dpp v53, v53, v53 row_ror:4 row_mask:0xf bank_mask:0xf
  v_add_f32_dpp v54, v54, v54 row_ror:4 row_mask:0xf bank_mask:0xf
  v_add_f32_dpp v55, v55, v55 row_ror:4 row_mask:0xf bank_mask:0xf
  v_add_f32_dpp v48, v48, v48 row_ror:2 row_mask:0xf bank_mask:0xf
  v_add_f32_dpp v49, v49, v49 row_ror:2 row_mask:0xf bank_mask:0xf
  v_add_f32_dpp v50, v50, v50 row_ror:2 row_mask:0xf bank_mask:0xf
  v_add_f32_dpp v51, v51, v51 row_ror:2 row_mask:0xf bank_mask:0xf
  v_add_f32_dpp v52, v52, v52 row_ror:2 row_mask:0xf bank_mask:0xf
  v_add_f32_dpp v53, v53, v53 row_ror:2 row_mask:0xf bank_mask:0xf
  v_add_f32_dpp v54, v54, v54 row_ror:2 row_mask:0xf bank_mask:0xf
  v_add_f32_dpp v55, v55, v55 row_ror:2 row_mask:0xf bank_mask:0xf
  v_add_f32_dpp v48, v48, v48 row_ror:1 row_mask:0xf bank_mask:0xf
  v_add_f32_dpp v49, v49, v49 row_ror:1 row_mask:0xf bank_mask:0xf
  v_add_f32_dpp v50, v50, v50 row_ror:1 row_mask:0xf bank_mask:0xf
  v_add_f32_dpp v51, v51, v51 row_ror:1 row_mask:0xf bank_mask:0xf
  v_add_f32_dpp v52, v52, v52 row_ror:1 row_mask:0xf bank_mask:0xf
  v_add_f32_dpp v53, v53, v53 row_ror:1 row_mask:0xf bank_mask:0xf
  v_add_f32_dpp v54, v54, v54 row_ror:1 row_mask:0xf bank_mask:0xf
  v_add_f32_dpp v55, v55, v55 row_ror:1 row_mask:0xf bank_mask:0xf
  v_mul_f32 v48, 0x3caaaaab, v48
  v_mul_f32 v49, 0x3caaaaab, v49
  v_mul_f32 v50, 0x3caaaaab, v50
  v_mul_f32 v51, 0x3caaaaab, v51
  v_mul_f32 v52, 0x3caaaaab, v52
  v_mul_f32 v53, 0x3caaaaab, v53
  v_mul_f32 v54, 0x3caaaaab, v54
  v_mul_f32 v55, 0x3caaaaab, v55
  v_pk_add_f32 v[72:73], v[120:121], v[48:49] neg_lo:[0,1] neg_hi:[0,1]
  v_pk_add_f32 v[74:75], v[122:123], v[50:51] neg_lo:[0,1] neg_hi:[0,1]
  v_pk_add_f32 v[76:77], v[124:125], v[52:53] neg_lo:[0,1] neg_hi:[0,1]
  v_pk_add_f32 v[78:79], v[126:127], v[54:55] neg_lo:[0,1] neg_hi:[0,1]
  v_pk_add_f32 v[80:81], v[128:129], v[48:49] neg_lo:[0,1] neg_hi:[0,1]
  v_pk_add_f32 v[82:83], v[130:131], v[50:51] neg_lo:[0,1] neg_hi:[0,1]
  v_pk_add_f32 v[84:85], v[132:133], v[52:53] neg_lo:[0,1] neg_hi:[0,1]
  v_pk_add_f32 v[86:87], v[134:135], v[54:55] neg_lo:[0,1] neg_hi:[0,1]
  v_pk_add_f32 v[88:89], v[136:137], v[48:49] neg_lo:[0,1] neg_hi:[0,1]
  v_pk_add_f32 v[90:91], v[138:139], v[50:51] neg_lo:[0,1] neg_hi:[0,1]
  v_pk_add_f32 v[92:93], v[140:141], v[52:53] neg_lo:[0,1] neg_hi:[0,1]
  v_pk_add_f32 v[94:95], v[142:143], v[54:55] neg_lo:[0,1] neg_hi:[0,1]
  v_pk_mul_f32 v[56:57], v[72:73], v[72:73]
  v_pk_mul_f32 v[58:59], v[74:75], v[74:75]
  v_pk_mul_f32 v[60:61], v[76:77], v[76:77]
  v_pk_mul_f32 v[62:63], v[78:79], v[78:79]
  v_pk_fma_f32 v[56:57], v[80:81], v[80:81], v[56:57]
  v_pk_fma_f32 v[58:59], v[82:83], v[82:83], v[58:59]
  v_pk_fma_f32 v[60:61], v[84:85], v[84:85], v[60:61]
  v_pk_fma_f32 v[62:63], v[86:87], v[86:87], v[62:63]
  v_pk_fma_f32 v[56:57], v[88:89], v[88:89], v[56:57]
  v_pk_fma_f32 v[58:59], v[90:91], v[90:91], v[58:59]
  v_pk_fma_f32 v[60:61], v[92:93], v[92:93], v[60:61]
  v_pk_fma_f32 v[62:63], v[94:95], v[94:95], v[62:63]
  s_nop 1
  v_add_f32_dpp v56, v56, v56 row_ror:8 row_mask:0xf bank_mask:0xf
  v_add_f32_dpp v57, v57, v57 row_ror:8 row_mask:0xf bank_mask:0xf
  v_add_f32_dpp v58, v58, v58 row_ror:8 row_mask:0xf bank_mask:0xf
  v_add_f32_dpp v59, v59, v59 row_ror:8 row_mask:0xf bank_mask:0xf
  v_add_f32_dpp v60, v60, v60 row_ror:8 row_mask:0xf bank_mask:0xf
  v_add_f32_dpp v61, v61, v61 row_ror:8 row_mask:0xf bank_mask:0xf
  v_add_f32_dpp v62, v62, v62 row_ror:8 row_mask:0xf bank_mask:0xf
  v_add_f32_dpp v63, v63, v63 row_ror:8 row_mask:0xf bank_mask:0xf
  v_add_f32_dpp v56, v56, v56 row_ror:4 row_mask:0xf bank_mask:0xf
  v_add_f32_dpp v57, v57, v57 row_ror:4 row_mask:0xf bank_mask:0xf
  v_add_f32_dpp v58, v58, v58 row_ror:4 row_mask:0xf bank_mask:0xf
  v_add_f32_dpp v59, v59, v59 row_ror:4 row_mask:0xf bank_mask:0xf
  v_add_f32_dpp v60, v60, v60 row_ror:4 row_mask:0xf bank_mask:0xf
  v_add_f32_dpp v61, v61, v61 row_ror:4 row_mask:0xf bank_mask:0xf
  v_add_f32_dpp v62, v62, v62 row_ror:4 row_mask:0xf bank_mask:0xf
  v_add_f32_dpp v63, v63, v63 row_ror:4 row_mask:0xf bank_mask:0xf
  v_add_f32_dpp v56, v56, v56 row_ror:2 row_mask:0xf bank_mask:0xf
  v_add_f32_dpp v57, v57, v57 row_ror:2 row_mask:0xf bank_mask:0xf
  v_add_f32_dpp v58, v58, v58 row_ror:2 row_mask:0xf bank_mask:0xf
  v_add_f32_dpp v59, v59, v59 row_ror:2 row_mask:0xf bank_mask:0xf
  v_add_f32_dpp v60, v60, v60 row_ror:2 row_mask:0xf bank_mask:0xf
  v_add_f32_dpp v61, v61, v61 row_ror:2 row_mask:0xf bank_mask:0xf
  v_add_f32_dpp v62, v62, v62 row_ror:2 row_mask:0xf bank_mask:0xf
  v_add_f32_dpp v63, v63, v63 row_ror:2 row_mask:0xf bank_mask:0xf
  v_add_f32_dpp v56, v56, v56 row_ror:1 row_mask:0xf bank_mask:0xf
  v_add_f32_dpp v57, v57, v57 row_ror:1 row_mask:0xf bank_mask:0xf
  v_add_f32_dpp v58, v58, v58 row_ror:1 row_mask:0xf bank_mask:0xf
  v_add_f32_dpp v59, v59, v59 row_ror:1 row_mask:0xf bank_mask:0xf
  v_add_f32_dpp v60, v60, v60 row_ror:1 row_mask:0xf bank_mask:0xf
  v_add_f32_dpp v61, v61, v61 row_ror:1 row_mask:0xf bank_mask:0xf
  v_add_f32_dpp v62, v62, v62 row_ror:1 row_mask:0xf bank_mask:0xf
  v_add_f32_dpp v63, v63, v63 row_ror:1 row_mask:0xf bank_mask:0xf
  v_mov_b32 v176, v48
  v_mov_b32 v177, v56
  v_mov_b32 v178, v49
  v_mov_b32 v179, v57
  v_mov_b32 v180, v50
  v_mov_b32 v181, v58
  v_mov_b32 v182, v51
  v_mov_b32 v183, v59
  v_mov_b32 v184, v52
  v_mov_b32 v185, v60
  v_mov_b32 v186, v53
  v_mov_b32 v187, v61
  v_mov_b32 v188, v54
  v_mov_b32 v189, v62
  v_mov_b32 v190, v55
  v_mov_b32 v191, v63
  s_lshl_b32 s10, s4, 1
  s_add_u32 s10, s10, s13
  s_lshl_b32 s10, s10, 9
  s_lshl_b32 s11, s5, 14
  s_add_u32 s10, s10, s11
  s_lshl_b32 s11, s14, 8
  s_add_u32 s10, s10, s11
  v_lshlrev_b32 v6, 5, v3
  v_cmp_eq_u32 vcc, 0, v5
  s_and_saveexec_b64 s[88:89], vcc
  buffer_store_dwordx4 v[176:179], v6, s[56:59], s10 offen offset:0 sc1
  buffer_store_dwordx4 v[180:183], v6, s[56:59], s10 offen offset:16 sc1
  buffer_store_dwordx4 v[184:187], v6, s[56:59], s10 offen offset:128 sc1
  buffer_store_dwordx4 v[188:191], v6, s[56:59], s10 offen offset:144 sc1
  s_mov_b64 exec, s[88:89]
  s_barrier
  ds_read_b128 v[40:43], v8 offset:0
  ds_read_b128 v[44:47], v8 offset:2048
  ds_read_b128 v[48:51], v8 offset:4096
  ds_read_b128 v[52:55], v10 offset:0
  ds_read_b128 v[56:59], v10 offset:2048
  ds_read_b128 v[60:63], v9 offset:0
  ds_read_b128 v[64:67], v9 offset:2048
  ds_read_b128 v[68:71], v9 offset:4096
  ds_read_b128 v[72:75], v11 offset:0
  ds_read_b128 v[76:79], v11 offset:2048
  s_waitcnt lgkmcnt(0)
  s_barrier
  ds_read_b128 v[80:83], v8 offset:12288
  ds_read_b128 v[84:87], v8 offset:14336
  ds_read_b128 v[88:91], v8 offset:16384
  ds_read_b128 v[92:95], v10 offset:8192
  ds_read_b128 v[96:99], v10 offset:10240
  ds_read_b128 v[100:103], v9 offset:12288
  ds_read_b128 v[104:107], v9 offset:14336
  ds_read_b128 v[108:111], v9 offset:16384
  ds_read_b128 v[112:115], v11 offset:8192
  ds_read_b128 v[116:119], v11 offset:10240
  v_mfma_f32_16x16x32_bf16 v[144:147], v[40:43], v[52:55], v[144:147]
  v_mfma_f32_16x16x32_bf16 v[148:151], v[40:43], v[56:59], v[148:151]
  v_mfma_f32_16x16x32_bf16 v[152:155], v[44:47], v[52:55], v[152:155]
  v_mfma_f32_16x16x32_bf16 v[156:159], v[44:47], v[56:59], v[156:159]
  v_mfma_f32_16x16x32_bf16 v[160:163], v[48:51], v[52:55], v[160:163]
  v_mfma_f32_16x16x32_bf16 v[164:167], v[48:51], v[56:59], v[164:167]
  v_mfma_f32_16x16x32_bf16 v[144:147], v[60:63], v[72:75], v[144:147]
  v_mfma_f32_16x16x32_bf16 v[148:151], v[60:63], v[76:79], v[148:151]
  v_mfma_f32_16x16x32_bf16 v[152:155], v[64:67], v[72:75], v[152:155]
  v_mfma_f32_16x16x32_bf16 v[156:159], v[64:67], v[76:79], v[156:159]
  v_mfma_f32_16x16x32_bf16 v[160:163], v[68:71], v[72:75], v[160:163]
  v_mfma_f32_16x16x32_bf16 v[164:167], v[68:71], v[76:79], v[164:167]
  s_waitcnt lgkmcnt(0)
  s_waitcnt vmcnt(0)
  s_barrier
  s_cmp_lg_u32 s3, 0
  s_cbranch_scc1 Lsg_20
  v_mov_b32 v6, 0
  v_mov_b32 v7, 1
  s_mov_b64 s[88:89], exec
  s_mov_b64 exec, 1
  buffer_atomic_add v7, v6, s[84:87], s92 offen sc1
  s_mov_b64 exec, s[88:89]
Lsg_20:
  ds_read_b128 v[40:43], v8 offset:24576
  ds_read_b128 v[44:47], v8 offset:26624
  ds_read_b128 v[48:51], v8 offset:28672
  ds_read_b128 v[52:55], v10 offset:16384
  ds_read_b128 v[56:59], v10 offset:18432
  ds_read_b128 v[60:63], v9 offset:24576
  ds_read_b128 v[64:67], v9 offset:26624
  ds_read_b128 v[68:71], v9 offset:28672
  ds_read_b128 v[72:75], v11 offset:16384
  ds_read_b128 v[76:79], v11 offset:18432
  v_mfma_f32_16x16x32_bf16 v[144:147], v[80:83], v[92:95], v[144:147]
  v_mfma_f32_16x16x32_bf16 v[148:151], v[80:83], v[96:99], v[148:151]
  v_mfma_f32_16x16x32_bf16 v[152:155], v[84:87], v[92:95], v[152:155]
  v_mfma_f32_16x16x32_bf16 v[156:159], v[84:87], v[96:99], v[156:159]
  v_mfma_f32_16x16x32_bf16 v[160:163], v[88:91], v[92:95], v[160:163]
  v_mfma_f32_16x16x32_bf16 v[164:167], v[88:91], v[96:99], v[164:167]
  v_mfma_f32_16x16x32_bf16 v[144:147], v[100:103], v[112:115], v[144:147]
  v_mfma_f32_16x16x32_bf16 v[148:151], v[100:103], v[116:119], v[148:151]
  v_mfma_f32_16x16x32_bf16 v[152:155], v[104:107], v[112:115], v[152:155]
  v_mfma_f32_16x16x32_bf16 v[156:159], v[104:107], v[116:119], v[156:159]
  v_mfma_f32_16x16x32_bf16 v[160:163], v[108:111], v[112:115], v[160:163]
  v_mfma_f32_16x16x32_bf16 v[164:167], v[108:111], v[116:119], v[164:167]
  s_waitcnt lgkmcnt(0)
  s_barrier
  ds_read_b128 v[80:83], v8 offset:36864
  ds_read_b128 v[84:87], v8 offset:38912
  ds_read_b128 v[88:91], v8 offset:40960
  ds_read_b128 v[92:95], v10 offset:24576
  ds_read_b128 v[96:99], v10 offset:26624
  ds_read_b128 v[100:103], v9 offset:36864
  ds_read_b128 v[104:107], v9 offset:38912
  ds_read_b128 v[108:111], v9 offset:40960
  ds_read_b128 v[112:115], v11 offset:24576
  ds_read_b128 v[116:119], v11 offset:26624
  v_mfma_f32_16x16x32_bf16 v[144:147], v[40:43], v[52:55], v[144:147]
  v_mfma_f32_16x16x32_bf16 v[148:151], v[40:43], v[56:59], v[148:151]
  v_mfma_f32_16x16x32_bf16 v[152:155], v[44:47], v[52:55], v[152:155]
  v_mfma_f32_16x16x32_bf16 v[156:159], v[44:47], v[56:59], v[156:159]
  v_mfma_f32_16x16x32_bf16 v[160:163], v[48:51], v[52:55], v[160:163]
  v_mfma_f32_16x16x32_bf16 v[164:167], v[48:51], v[56:59], v[164:167]
  v_mfma_f32_16x16x32_bf16 v[144:147], v[60:63], v[72:75], v[144:147]
  v_mfma_f32_16x16x32_bf16 v[148:151], v[60:63], v[76:79], v[148:151]
  v_mfma_f32_16x16x32_bf16 v[152:155], v[64:67], v[72:75], v[152:155]
  v_mfma_f32_16x16x32_bf16 v[156:159], v[64:67], v[76:79], v[156:159]
  v_mfma_f32_16x16x32_bf16 v[160:163], v[68:71], v[72:75], v[160:163]
  v_mfma_f32_16x16x32_bf16 v[164:167], v[68:71], v[76:79], v[164:167]
  s_waitcnt lgkmcnt(0)
  s_barrier
  ds_read_b128 v[40:43], v8 offset:49152
  ds_read_b128 v[44:47], v8 offset:51200
  ds_read_b128 v[48:51], v8 offset:53248
  ds_read_b128 v[52:55], v10 offset:32768
  ds_read_b128 v[56:59], v10 offset:34816
  ds_read_b128 v[60:63], v9 offset:49152
  ds_read_b128 v[64:67], v9 offset:51200
  ds_read_b128 v[68:71], v9 offset:53248
  ds_read_b128 v[72:75], v11 offset:32768
  ds_read_b128 v[76:79], v11 offset:34816
  v_mfma_f32_16x16x32_bf16 v[144:147], v[80:83], v[92:95], v[144:147]
  v_mfma_f32_16x16x32_bf16 v[148:151], v[80:83], v[96:99], v[148:151]
  v_mfma_f32_16x16x32_bf16 v[152:155], v[84:87], v[92:95], v[152:155]
  v_mfma_f32_16x16x32_bf16 v[156:159], v[84:87], v[96:99], v[156:159]
  v_mfma_f32_16x16x32_bf16 v[160:163], v[88:91], v[92:95], v[160:163]
  v_mfma_f32_16x16x32_bf16 v[164:167], v[88:91], v[96:99], v[164:167]
  v_mfma_f32_16x16x32_bf16 v[144:147], v[100:103], v[112:115], v[144:147]
  v_mfma_f32_16x16x32_bf16 v[148:151], v[100:103], v[116:119], v[148:151]
  v_mfma_f32_16x16x32_bf16 v[152:155], v[104:107], v[112:115], v[152:155]
  v_mfma_f32_16x16x32_bf16 v[156:159], v[104:107], v[116:119], v[156:159]
  v_mfma_f32_16x16x32_bf16 v[160:163], v[108:111], v[112:115], v[160:163]
  v_mfma_f32_16x16x32_bf16 v[164:167], v[108:111], v[116:119], v[164:167]
  s_waitcnt lgkmcnt(0)
  s_barrier
  ds_read_b128 v[80:83], v8 offset:0
  ds_read_b128 v[84:87], v8 offset:2048
  ds_read_b128 v[88:91], v8 offset:4096
  ds_read_b128 v[92:95], v10 offset:40960
  ds_read_b128 v[96:99], v10 offset:43008
  ds_read_b128 v[100:103], v9 offset:0
  ds_read_b128 v[104:107], v9 offset:2048
  ds_read_b128 v[108:111], v9 offset:4096
  ds_read_b128 v[112:115], v11 offset:40960
  ds_read_b128 v[116:119], v11 offset:43008
  v_mfma_f32_16x16x32_bf16 v[144:147], v[40:43], v[52:55], v[144:147]
  v_mfma_f32_16x16x32_bf16 v[148:151], v[40:43], v[56:59], v[148:151]
  v_mfma_f32_16x16x32_bf16 v[152:155], v[44:47], v[52:55], v[152:155]
  v_mfma_f32_16x16x32_bf16 v[156:159], v[44:47], v[56:59], v[156:159]
  v_mfma_f32_16x16x32_bf16 v[160:163], v[48:51], v[52:55], v[160:163]
  v_mfma_f32_16x16x32_bf16 v[164:167], v[48:51], v[56:59], v[164:167]
  v_mfma_f32_16x16x32_bf16 v[144:147], v[60:63], v[72:75], v[144:147]
  v_mfma_f32_16x16x32_bf16 v[148:151], v[60:63], v[76:79], v[148:151]
  v_mfma_f32_16x16x32_bf16 v[152:155], v[64:67], v[72:75], v[152:155]
  v_mfma_f32_16x16x32_bf16 v[156:159], v[64:67], v[76:79], v[156:159]
  v_mfma_f32_16x16x32_bf16 v[160:163], v[68:71], v[72:75], v[160:163]
  v_mfma_f32_16x16x32_bf16 v[164:167], v[68:71], v[76:79], v[164:167]
  s_waitcnt lgkmcnt(0)
  s_barrier
  ds_read_b128 v[40:43], v8 offset:12288
  ds_read_b128 v[44:47], v8 offset:14336
  ds_read_b128 v[48:51], v8 offset:16384
  ds_read_b128 v[52:55], v10 offset:49152
  ds_read_b128 v[56:59], v10 offset:51200
  ds_read_b128 v[60:63], v9 offset:12288
  ds_read_b128 v[64:67], v9 offset:14336
  ds_read_b128 v[68:71], v9 offset:16384
  ds_read_b128 v[72:75], v11 offset:49152
  ds_read_b128 v[76:79], v11 offset:51200
  v_mfma_f32_16x16x32_bf16 v[144:147], v[80:83], v[92:95], v[144:147]
  v_mfma_f32_16x16x32_bf16 v[148:151], v[80:83], v[96:99], v[148:151]
  v_mfma_f32_16x16x32_bf16 v[152:155], v[84:87], v[92:95], v[152:155]
  v_mfma_f32_16x16x32_bf16 v[156:159], v[84:87], v[96:99], v[156:159]
  v_mfma_f32_16x16x32_bf16 v[160:163], v[88:91], v[92:95], v[160:163]
  v_mfma_f32_16x16x32_bf16 v[164:167], v[88:91], v[96:99], v[164:167]
  v_mfma_f32_16x16x32_bf16 v[144:147], v[100:103], v[112:115], v[144:147]
  v_mfma_f32_16x16x32_bf16 v[148:151], v[100:103], v[116:119], v[148:151]
  v_mfma_f32_16x16x32_bf16 v[152:155], v[104:107], v[112:115], v[152:155]
  v_mfma_f32_16x16x32_bf16 v[156:159], v[104:107], v[116:119], v[156:159]
  v_mfma_f32_16x16x32_bf16 v[160:163], v[108:111], v[112:115], v[160:163]
  v_mfma_f32_16x16x32_bf16 v[164:167], v[108:111], v[116:119], v[164:167]
  s_waitcnt lgkmcnt(0)
  s_barrier
  ds_read_b128 v[80:83], v8 offset:24576
  ds_read_b128 v[84:87], v8 offset:26624
  ds_read_b128 v[88:91], v8 offset:28672
  ds_read_b128 v[92:95], v10 offset:57344
  ds_read_b128 v[96:99], v10 offset:59392
  ds_read_b128 v[100:103], v9 offset:24576
  ds_read_b128 v[104:107], v9 offset:26624
  ds_read_b128 v[108:111], v9 offset:28672
  ds_read_b128 v[112:115], v11 offset:57344
  ds_read_b128 v[116:119], v11 offset:59392
  v_mfma_f32_16x16x32_bf16 v[144:147], v[40:43], v[52:55], v[144:147]
  v_mfma_f32_16x16x32_bf16 v[148:151], v[40:43], v[56:59], v[148:151]
  v_mfma_f32_16x16x32_bf16 v[152:155], v[44:47], v[52:55], v[152:155]
  v_mfma_f32_16x16x32_bf16 v[156:159], v[44:47], v[56:59], v[156:159]
  v_mfma_f32_16x16x32_bf16 v[160:163], v[48:51], v[52:55], v[160:163]
  v_mfma_f32_16x16x32_bf16 v[164:167], v[48:51], v[56:59], v[164:167]
  v_mfma_f32_16x16x32_bf16 v[144:147], v[60:63], v[72:75], v[144:147]
  v_mfma_f32_16x16x32_bf16 v[148:151], v[60:63], v[76:79], v[148:151]
  v_mfma_f32_16x16x32_bf16 v[152:155], v[64:67], v[72:75], v[152:155]
  v_mfma_f32_16x16x32_bf16 v[156:159], v[64:67], v[76:79], v[156:159]
  v_mfma_f32_16x16x32_bf16 v[160:163], v[68:71], v[72:75], v[160:163]
  v_mfma_f32_16x16x32_bf16 v[164:167], v[68:71], v[76:79], v[164:167]
  s_waitcnt lgkmcnt(0)
  s_barrier
  ds_read_b128 v[40:43], v8 offset:36864
  ds_read_b128 v[44:47], v8 offset:38912
  ds_read_b128 v[48:51], v8 offset:40960
  ds_read_b128 v[52:55], v12 offset:0
  ds_read_b128 v[56:59], v12 offset:2048
  ds_read_b128 v[60:63], v9 offset:36864
  ds_read_b128 v[64:67], v9 offset:38912
  ds_read_b128 v[68:71], v9 offset:40960
  ds_read_b128 v[72:75], v13 offset:0
  ds_read_b128 v[76:79], v13 offset:2048
  v_mfma_f32_16x16x32_bf16 v[144:147], v[80:83], v[92:95], v[144:147]
  v_mfma_f32_16x16x32_bf16 v[148:151], v[80:83], v[96:99], v[148:151]
  v_mfma_f32_16x16x32_bf16 v[152:155], v[84:87], v[92:95], v[152:155]
  v_mfma_f32_16x16x32_bf16 v[156:159], v[84:87], v[96:99], v[156:159]
  v_mfma_f32_16x16x32_bf16 v[160:163], v[88:91], v[92:95], v[160:163]
  v_mfma_f32_16x16x32_bf16 v[164:167], v[88:91], v[96:99], v[164:167]
  v_mfma_f32_16x16x32_bf16 v[144:147], v[100:103], v[112:115], v[144:147]
  v_mfma_f32_16x16x32_bf16 v[148:151], v[100:103], v[116:119], v[148:151]
  v_mfma_f32_16x16x32_bf16 v[152:155], v[104:107], v[112:115], v[152:155]
  v_mfma_f32_16x16x32_bf16 v[156:159], v[104:107], v[116:119], v[156:159]
  v_mfma_f32_16x16x32_bf16 v[160:163], v[108:111], v[112:115], v[160:163]
  v_mfma_f32_16x16x32_bf16 v[164:167], v[108:111], v[116:119], v[164:167]
  s_waitcnt lgkmcnt(0)
  s_barrier
  ds_read_b128 v[80:83], v8 offset:49152
  ds_read_b128 v[84:87], v8 offset:51200
  ds_read_b128 v[88:91], v8 offset:53248
  ds_read_b128 v[92:95], v12 offset:8192
  ds_read_b128 v[96:99], v12 offset:10240
  ds_read_b128 v[100:103], v9 offset:49152
  ds_read_b128 v[104:107], v9 offset:51200
  ds_read_b128 v[108:111], v9 offset:53248
  ds_read_b128 v[112:115], v13 offset:8192
  ds_read_b128 v[116:119], v13 offset:10240
  v_mfma_f32_16x16x32_bf16 v[144:147], v[40:43], v[52:55], v[144:147]
  v_mfma_f32_16x16x32_bf16 v[148:151], v[40:43], v[56:59], v[148:151]
  v_mfma_f32_16x16x32_bf16 v[152:155], v[44:47], v[52:55], v[152:155]
  v_mfma_f32_16x16x32_bf16 v[156:159], v[44:47], v[56:59], v[156:159]
  v_mfma_f32_16x16x32_bf16 v[160:163], v[48:51], v[52:55], v[160:163]
  v_mfma_f32_16x16x32_bf16 v[164:167], v[48:51], v[56:59], v[164:167]
  v_mfma_f32_16x16x32_bf16 v[144:147], v[60:63], v[72:75], v[144:147]
  v_mfma_f32_16x16x32_bf16 v[148:151], v[60:63], v[76:79], v[148:151]
  v_mfma_f32_16x16x32_bf16 v[152:155], v[64:67], v[72:75], v[152:155]
  v_mfma_f32_16x16x32_bf16 v[156:159], v[64:67], v[76:79], v[156:159]
  v_mfma_f32_16x16x32_bf16 v[160:163], v[68:71], v[72:75], v[160:163]
  v_mfma_f32_16x16x32_bf16 v[164:167], v[68:71], v[76:79], v[164:167]
  s_waitcnt lgkmcnt(0)
  v_mfma_f32_16x16x32_bf16 v[144:147], v[80:83], v[92:95], v[144:147]
  v_mfma_f32_16x16x32_bf16 v[148:151], v[80:83], v[96:99], v[148:151]
  v_mfma_f32_16x16x32_bf16 v[152:155], v[84:87], v[92:95], v[152:155]
  v_mfma_f32_16x16x32_bf16 v[156:159], v[84:87], v[96:99], v[156:159]
  v_mfma_f32_16x16x32_bf16 v[160:163], v[88:91], v[92:95], v[160:163]
  v_mfma_f32_16x16x32_bf16 v[164:167], v[88:91], v[96:99], v[164:167]
  v_mfma_f32_16x16x32_bf16 v[144:147], v[100:103], v[112:115], v[144:147]
  v_mfma_f32_16x16x32_bf16 v[148:151], v[100:103], v[116:119], v[148:151]
  v_mfma_f32_16x16x32_bf16 v[152:155], v[104:107], v[112:115], v[152:155]
  v_mfma_f32_16x16x32_bf16 v[156:159], v[104:107], v[116:119], v[156:159]
  v_mfma_f32_16x16x32_bf16 v[160:163], v[108:111], v[112:115], v[160:163]
  v_mfma_f32_16x16x32_bf16 v[164:167], v[108:111], v[116:119], v[164:167]
  s_mov_b32 s78, 0xbdd2d3e8
  s_mov_b32 s79, 0xbdd2d3e8
  v_mov_b32 v42, 0xc0135761
  v_mov_b32 v43, 0xc0135761
  s_nop 6
  v_cvt_pk_bf16_f32 v72, v144, v145
  v_cvt_pk_bf16_f32 v73, v146, v147
  v_cvt_pk_bf16_f32 v74, v148, v149
  v_cvt_pk_bf16_f32 v75, v150, v151
  v_cvt_pk_bf16_f32 v76, v152, v153
  v_cvt_pk_bf16_f32 v77, v154, v155
  v_cvt_pk_bf16_f32 v78, v156, v157
  v_cvt_pk_bf16_f32 v79, v158, v159
  v_cvt_pk_bf16_f32 v80, v160, v161
  v_cvt_pk_bf16_f32 v81, v162, v163
  v_cvt_pk_bf16_f32 v82, v164, v165
  v_cvt_pk_bf16_f32 v83, v166, v167
  v_lshlrev_b32 v144, 16, v72
  v_and_b32 v145, 0xffff0000, v72
  v_lshlrev_b32 v146, 16, v73
  v_and_b32 v147, 0xffff0000, v73
  v_lshlrev_b32 v148, 16, v74
  v_and_b32 v149, 0xffff0000, v74
  v_lshlrev_b32 v150, 16, v75
  v_and_b32 v151, 0xffff0000, v75
  v_lshlrev_b32 v152, 16, v76
  v_and_b32 v153, 0xffff0000, v76
  v_lshlrev_b32 v154, 16, v77
  v_and_b32 v155, 0xffff0000, v77
  v_lshlrev_b32 v156, 16, v78
  v_and_b32 v157, 0xffff0000, v78
  v_lshlrev_b32 v158, 16, v79
  v_and_b32 v159, 0xffff0000, v79
  v_lshlrev_b32 v160, 16, v80
  v_and_b32 v161, 0xffff0000, v80
  v_lshlrev_b32 v162, 16, v81
  v_and_b32 v163, 0xffff0000, v81
  v_lshlrev_b32 v164, 16, v82
  v_and_b32 v165, 0xffff0000, v82
  v_lshlrev_b32 v166, 16, v83
  v_and_b32 v167, 0xffff0000, v83
  v_pk_mul_f32 v[72:73], v[144:145], v[144:145]
  v_pk_mul_f32 v[74:75], v[146:147], v[146:147]
  v_pk_mul_f32 v[76:77], v[148:149], v[148:149]
  v_pk_mul_f32 v[78:79], v[150:151], v[150:151]
  v_pk_mul_f32 v[80:81], v[152:153], v[152:153]
  v_pk_mul_f32 v[82:83], v[154:155], v[154:155]
  v_pk_mul_f32 v[84:85], v[156:157], v[156:157]
  v_pk_mul_f32 v[86:87], v[158:159], v[158:159]
  v_pk_mul_f32 v[88:89], v[160:161], v[160:161]
  v_pk_mul_f32 v[90:91], v[162:163], v[162:163]
  v_pk_mul_f32 v[92:93], v[164:165], v[164:165]
  v_pk_mul_f32 v[94:95], v[166:167], v[166:167]
  v_pk_fma_f32 v[72:73], v[72:73], s[78:79], v[42:43]
  v_pk_fma_f32 v[74:75], v[74:75], s[78:79], v[42:43]
  v_pk_fma_f32 v[76:77], v[76:77], s[78:79], v[42:43]
  v_pk_fma_f32 v[78:79], v[78:79], s[78:79], v[42:43]
  v_pk_fma_f32 v[80:81], v[80:81], s[78:79], v[42:43]
  v_pk_fma_f32 v[82:83], v[82:83], s[78:79], v[42:43]
  v_pk_fma_f32 v[84:85], v[84:85], s[78:79], v[42:43]
  v_pk_fma_f32 v[86:87], v[86:87], s[78:79], v[42:43]
  v_pk_fma_f32 v[88:89], v[88:89], s[78:79], v[42:43]
  v_pk_fma_f32 v[90:91], v[90:91], s[78:79], v[42:43]
  v_pk_fma_f32 v[92:93], v[92:93], s[78:79], v[42:43]
  v_pk_fma_f32 v[94:95], v[94:95], s[78:79], v[42:43]
  v_pk_mul_f32 v[72:73], v[72:73], v[144:145]
  v_pk_mul_f32 v[74:75], v[74:75], v[146:147]
  v_pk_mul_f32 v[76:77], v[76:77], v[148:149]
  v_pk_mul_f32 v[78:79], v[78:79], v[150:151]
  v_pk_mul_f32 v[80:81], v[80:81], v[152:153]
  v_pk_mul_f32 v[82:83], v[82:83], v[154:155]
  v_pk_mul_f32 v[84:85], v[84:85], v[156:157]
  v_pk_mul_f32 v[86:87], v[86:87], v[158:159]
  v_pk_mul_f32 v[88:89], v[88:89], v[160:161]
  v_pk_mul_f32 v[90:91], v[90:91], v[162:163]
  v_pk_mul_f32 v[92:93], v[92:93], v[164:165]
  v_pk_mul_f32 v[94:95], v[94:95], v[166:167]
  v_exp_f32 v72, v72
  v_exp_f32 v73, v73
  v_exp_f32 v74, v74
  v_exp_f32 v75, v75
  v_exp_f32 v76, v76
  v_exp_f32 v77, v77
  v_exp_f32 v78, v78
  v_exp_f32 v79, v79
  v_exp_f32 v80, v80
  v_exp_f32 v81, v81
  v_exp_f32 v82, v82
  v_exp_f32 v83, v83
  v_exp_f32 v84, v84
  v_exp_f32 v85, v85
  v_exp_f32 v86, v86
  v_exp_f32 v87, v87
  v_exp_f32 v88, v88
  v_exp_f32 v89, v89
  v_exp_f32 v90, v90
  v_exp_f32 v91, v91
  v_exp_f32 v92, v92
  v_exp_f32 v93, v93
  v_exp_f32 v94, v94
  v_exp_f32 v95, v95
  s_nop 0
  v_pk_add_f32 v[72:73], v[72:73], 1.0 op_sel_hi:[1,0]
  v_pk_add_f32 v[74:75], v[74:75], 1.0 op_sel_hi:[1,0]
  v_pk_add_f32 v[76:77], v[76:77], 1.0 op_sel_hi:[1,0]
  v_pk_add_f32 v[78:79], v[78:79], 1.0 op_sel_hi:[1,0]
  v_pk_add_f32 v[80:81], v[80:81], 1.0 op_sel_hi:[1,0]
  v_pk_add_f32 v[82:83], v[82:83], 1.0 op_sel_hi:[1,0]
  v_pk_add_f32 v[84:85], v[84:85], 1.0 op_sel_hi:[1,0]
  v_pk_add_f32 v[86:87], v[86:87], 1.0 op_sel_hi:[1,0]
  v_pk_add_f32 v[88:89], v[88:89], 1.0 op_sel_hi:[1,0]
  v_pk_add_f32 v[90:91], v[90:91], 1.0 op_sel_hi:[1,0]
  v_pk_add_f32 v[92:93], v[92:93], 1.0 op_sel_hi:[1,0]
  v_pk_add_f32 v[94:95], v[94:95], 1.0 op_sel_hi:[1,0]
  v_rcp_f32 v72, v72
  v_rcp_f32 v73, v73
  v_rcp_f32 v74, v74
  v_rcp_f32 v75, v75
  v_rcp_f32 v76, v76
  v_rcp_f32 v77, v77
  v_rcp_f32 v78, v78
  v_rcp_f32 v79, v79
  v_rcp_f32 v80, v80
  v_rcp_f32 v81, v81
  v_rcp_f32 v82, v82
  v_rcp_f32 v83, v83
  v_rcp_f32 v84, v84
  v_rcp_f32 v85, v85
  v_rcp_f32 v86, v86
  v_rcp_f32 v87, v87
  v_rcp_f32 v88, v88
  v_rcp_f32 v89, v89
  v_rcp_f32 v90, v90
  v_rcp_f32 v91, v91
  v_rcp_f32 v92, v92
  v_rcp_f32 v93, v93
  v_rcp_f32 v94, v94
  v_rcp_f32 v95, v95
  s_nop 0
  v_pk_mul_f32 v[144:145], v[144:145], v[72:73]
  v_pk_mul_f32 v[146:147], v[146:147], v[74:75]
  v_pk_mul_f32 v[148:149], v[148:149], v[76:77]
  v_pk_mul_f32 v[150:151], v[150:151], v[78:79]
  v_pk_mul_f32 v[152:153], v[152:153], v[80:81]
  v_pk_mul_f32 v[154:155], v[154:155], v[82:83]
  v_pk_mul_f32 v[156:157], v[156:157], v[84:85]
  v_pk_mul_f32 v[158:159], v[158:159], v[86:87]
  v_pk_mul_f32 v[160:161], v[160:161], v[88:89]
  v_pk_mul_f32 v[162:163], v[162:163], v[90:91]
  v_pk_mul_f32 v[164:165], v[164:165], v[92:93]
  v_pk_mul_f32 v[166:167], v[166:167], v[94:95]
  v_cvt_pk_bf16_f32 v144, v144, v145
  v_cvt_pk_bf16_f32 v145, v146, v147
  v_cvt_pk_bf16_f32 v148, v148, v149
  v_cvt_pk_bf16_f32 v149, v150, v151
  v_cvt_pk_bf16_f32 v152, v152, v153
  v_cvt_pk_bf16_f32 v153, v154, v155
  v_cvt_pk_bf16_f32 v156, v156, v157
  v_cvt_pk_bf16_f32 v157, v158, v159
  v_cvt_pk_bf16_f32 v160, v160, v161
  v_cvt_pk_bf16_f32 v161, v162, v163
  v_cvt_pk_bf16_f32 v164, v164, v165
  v_cvt_pk_bf16_f32 v165, v166, v167
  s_barrier
  ds_write_b64 v20, v[144:145] offset:0
  ds_write_b64 v20, v[148:149] offset:3328
  ds_write_b64 v20, v[152:153] offset:32
  ds_write_b64 v20, v[156:157] offset:3360
  ds_write_b64 v20, v[160:161] offset:64
  ds_write_b64 v20, v[164:165] offset:3392
  s_waitcnt lgkmcnt(0)
  s_branch Ljn_19
Lld_18:
  s_waitcnt vmcnt(18)
  s_barrier
  s_add_u32 m0, s64, 131072
  s_nop 0
  buffer_load_dwordx4 v24, s[44:47], s8 offen lds
  s_add_u32 m0, s65, 131072
  s_nop 0
  buffer_load_dwordx4 v25, s[44:47], s8 offen lds
  s_add_u32 m0, s66, 131072
  s_nop 0
  buffer_load_dwordx4 v26, s[44:47], s8 offen lds
  s_add_u32 s8, s8, 128
  s_waitcnt vmcnt(19)
  s_barrier
  s_add_u32 m0, s64, 81920
  s_nop 0
  buffer_load_dwordx4 v24, s[44:47], s8 offen lds
  s_add_u32 m0, s65, 81920
  s_nop 0
  buffer_load_dwordx4 v25, s[44:47], s8 offen lds
  s_add_u32 m0, s66, 81920
  s_nop 0
  buffer_load_dwordx4 v26, s[44:47], s8 offen lds
  s_add_u32 s8, s8, 128
  s_waitcnt vmcnt(20)
  s_barrier
  s_add_u32 m0, s64, 94208
  s_nop 0
  buffer_load_dwordx4 v24, s[44:47], s8 offen lds
  s_add_u32 m0, s65, 94208
  s_nop 0
  buffer_load_dwordx4 v25, s[44:47], s8 offen lds
  s_add_u32 m0, s66, 94208
  s_nop 0
  buffer_load_dwordx4 v26, s[44:47], s8 offen lds
  s_add_u32 s8, s8, 128
  s_waitcnt vmcnt(21)
  s_barrier
  s_add_u32 m0, s64, 106496
  s_nop 0
  buffer_load_dwordx4 v24, s[44:47], s8 offen lds
  s_add_u32 m0, s65, 106496
  s_nop 0
  buffer_load_dwordx4 v25, s[44:47], s8 offen lds
  s_add_u32 m0, s66, 106496
  s_nop 0
  buffer_load_dwordx4 v26, s[44:47], s8 offen lds
  s_add_u32 s8, s8, 128
  s_waitcnt vmcnt(9)
  s_barrier
  s_add_u32 m0, s64, 118784
  s_nop 0
  buffer_load_dwordx4 v24, s[44:47], s8 offen lds
  s_add_u32 m0, s65, 118784
  s_nop 0
  buffer_load_dwordx4 v25, s[44:47], s8 offen lds
  s_add_u32 m0, s66, 118784
  s_nop 0
  buffer_load_dwordx4 v26, s[44:47], s8 offen lds
  s_add_u32 s8, s8, 128
  s_waitcnt vmcnt(9)
  s_barrier
  s_add_u32 m0, s64, 131072
  s_nop 0
  buffer_load_dwordx4 v24, s[44:47], s8 offen lds
  s_add_u32 m0, s65, 131072
  s_nop 0
  buffer_load_dwordx4 v25, s[44:47], s8 offen lds
  s_add_u32 m0, s66, 131072
  s_nop 0
  buffer_load_dwordx4 v26, s[44:47], s8 offen lds
  s_sub_u32 s8, s8, 984192
  s_waitcnt vmcnt(9)
  s_barrier
  s_add_u32 m0, s64, 81920
  s_nop 0
  buffer_load_dwordx4 v24, s[44:47], s8 offen lds
  s_add_u32 m0, s65, 81920
  s_nop 0
  buffer_load_dwordx4 v25, s[44:47], s8 offen lds
  s_add_u32 m0, s66, 81920
  s_nop 0
  buffer_load_dwordx4 v26, s[44:47], s8 offen lds
  s_add_u32 s8, s8, 128
  s_waitcnt vmcnt(9)
  s_barrier
  s_add_u32 m0, s64, 94208
  s_nop 0
  buffer_load_dwordx4 v24, s[44:47], s8 offen lds
  s_add_u32 m0, s65, 94208
  s_nop 0
  buffer_load_dwordx4 v25, s[44:47], s8 offen lds
  s_add_u32 m0, s66, 94208
  s_nop 0
  buffer_load_dwordx4 v26, s[44:47], s8 offen lds
  s_add_u32 s8, s8, 128
  s_waitcnt vmcnt(9)
  s_barrier
  s_add_u32 m0, s64, 106496
  s_nop 0
  buffer_load_dwordx4 v24, s[44:47], s8 offen lds
  s_add_u32 m0, s65, 106496
  s_nop 0
  buffer_load_dwordx4 v25, s[44:47], s8 offen lds
  s_add_u32 m0, s66, 106496
  s_nop 0
  buffer_load_dwordx4 v26, s[44:47], s8 offen lds
  s_add_u32 s8, s8, 128
  s_waitcnt vmcnt(9)
  s_barrier
  s_add_u32 m0, s64, 118784
  s_nop 0
  buffer_load_dwordx4 v24, s[44:47], s8 offen lds
  s_add_u32 m0, s65, 118784
  s_nop 0
  buffer_load_dwordx4 v25, s[44:47], s8 offen lds
  s_add_u32 m0, s66, 118784
  s_nop 0
  buffer_load_dwordx4 v26, s[44:47], s8 offen lds
  s_add_u32 s8, s8, 128
  s_waitcnt vmcnt(9)
  s_barrier
  s_add_u32 m0, s64, 131072
  s_nop 0
  buffer_load_dwordx4 v24, s[44:47], s8 offen lds
  s_add_u32 m0, s65, 131072
  s_nop 0
  buffer_load_dwordx4 v25, s[44:47], s8 offen lds
  s_add_u32 m0, s66, 131072
  s_nop 0
  buffer_load_dwordx4 v26, s[44:47], s8 offen lds
  s_add_u32 s8, s8, 128
  s_waitcnt vmcnt(9)
  s_barrier
  s_add_u32 m0, s64, 81920
  s_nop 0
  buffer_load_dwordx4 v24, s[44:47], s8 offen lds
  s_add_u32 m0, s65, 81920
  s_nop 0
  buffer_load_dwordx4 v25, s[44:47], s8 offen lds
  s_add_u32 m0, s66, 81920
  s_nop 0
  buffer_load_dwordx4 v26, s[44:47], s8 offen lds
  s_add_u32 s8, s8, 128
  s_waitcnt vmcnt(9)
  s_barrier
  s_add_u32 m0, s64, 94208
  s_nop 0
  buffer_load_dwordx4 v24, s[44:47], s8 offen lds
  s_add_u32 m0, s65, 94208
  s_nop 0
  buffer_load_dwordx4 v25, s[44:47], s8 offen lds
  s_add_u32 m0, s66, 94208
  s_nop 0
  buffer_load_dwordx4 v26, s[44:47], s8 offen lds
  s_add_u32 s8, s8, 128
  s_waitcnt vmcnt(9)
  s_barrier
  s_add_u32 m0, s64, 106496
  s_nop 0
  buffer_load_dwordx4 v24, s[44:47], s8 offen lds
  s_add_u32 m0, s65, 106496
  s_nop 0
  buffer_load_dwordx4 v25, s[44:47], s8 offen lds
  s_add_u32 m0, s66, 106496
  s_nop 0
  buffer_load_dwordx4 v26, s[44:47], s8 offen lds
  s_add_u32 s8, s8, 128
  s_waitcnt vmcnt(9)
  s_barrier
  s_add_u32 m0, s64, 118784
  s_nop 0
  buffer_load_dwordx4 v24, s[44:47], s8 offen lds
  s_add_u32 m0, s65, 118784
  s_nop 0
  buffer_load_dwordx4 v25, s[44:47], s8 offen lds
  s_add_u32 m0, s66, 118784
  s_nop 0
  buffer_load_dwordx4 v26, s[44:47], s8 offen lds
  s_add_u32 s8, s8, 128
  s_waitcnt vmcnt(9)
  s_barrier
  s_add_u32 m0, s64, 131072
  s_nop 0
  buffer_load_dwordx4 v24, s[44:47], s8 offen lds
  s_add_u32 m0, s65, 131072
  s_nop 0
  buffer_load_dwordx4 v25, s[44:47], s8 offen lds
  s_add_u32 m0, s66, 131072
  s_nop 0
  buffer_load_dwordx4 v26, s[44:47], s8 offen lds
  s_add_u32 s8, s8, 128
  s_waitcnt vmcnt(9)
  s_barrier
  s_waitcnt vmcnt(6)
  s_barrier
  s_waitcnt vmcnt(3)
  s_barrier
  s_waitcnt vmcnt(0)
  s_barrier
  s_barrier
Ljn_19:
  s_cmp_lg_u32 s3, 4
  s_cbranch_scc1 Lsw_21
  v_mov_b32 v6, 0
  s_setprio 3
Lsp_22:
  buffer_load_dword v7, v6, s[84:87], s92 offen sc1
  s_waitcnt vmcnt(0)
  v_cmp_gt_u32 vcc, 8, v7
  s_cbranch_vccnz Lsp_22
  s_setprio 0
Lsw_21:
  s_barrier
  v_lshrrev_b32 v6, 4, v23
  v_lshlrev_b32 v6, 3, v6
  v_lshl_add_u32 v6, v5, 9, v6
  s_lshl_b32 s11, s5, 14
  buffer_load_dwordx2 v[176:177], v6, s[56:59], s11 offen sc1
  buffer_load_dwordx2 v[178:179], v6, s[56:59], s11 offen offset:256 sc1
  ds_read_b128 v[192:195], v168
  ds_read_b128 v[196:199], v169
  s_waitcnt lgkmcnt(1)
  buffer_store_dwordx4 v[192:195], v170, s[52:55], s15 offen
  s_waitcnt lgkmcnt(0)
  buffer_store_dwordx4 v[196:199], v171, s[52:55], s15 offen
  s_waitcnt vmcnt(2)
  v_mov_b32 v180, v176
  v_mov_b32 v181, v178
  s_nop 1
  s_nop 1
  v_add_f32_dpp v180, v180, v180 row_ror:8 row_mask:0xf bank_mask:0xf
  v_add_f32_dpp v181, v181, v181 row_ror:8 row_mask:0xf bank_mask:0xf
  s_nop 1
  v_add_f32_dpp v180, v180, v180 row_ror:4 row_mask:0xf bank_mask:0xf
  v_add_f32_dpp v181, v181, v181 row_ror:4 row_mask:0xf bank_mask:0xf
  s_nop 1
  v_add_f32_dpp v180, v180, v180 row_ror:2 row_mask:0xf bank_mask:0xf
  v_add_f32_dpp v181, v181, v181 row_ror:2 row_mask:0xf bank_mask:0xf
  s_nop 1
  v_add_f32_dpp v180, v180, v180 row_ror:1 row_mask:0xf bank_mask:0xf
  v_add_f32_dpp v181, v181, v181 row_ror:1 row_mask:0xf bank_mask:0xf
  v_mul_f32 v180, 0x3d800000, v180
  v_mul_f32 v181, 0x3d800000, v181
  v_sub_f32 v176, v176, v180
  v_sub_f32 v178, v178, v181
  v_mul_f32 v176, v176, v176
  v_mul_f32 v178, v178, v178
  s_mov_b32 s10, 0x42400000
  v_fma_f32 v177, v176, s10, v177
  v_fma_f32 v179, v178, s10, v179
  s_nop 1
  s_nop 1
  v_add_f32_dpp v177, v177, v177 row_ror:8 row_mask:0xf bank_mask:0xf
  v_add_f32_dpp v179, v179, v179 row_ror:8 row_mask:0xf bank_mask:0xf
  s_nop 1
  v_add_f32_dpp v177, v177, v177 row_ror:4 row_mask:0xf bank_mask:0xf
  v_add_f32_dpp v179, v179, v179 row_ror:4 row_mask:0xf bank_mask:0xf
  s_nop 1
  v_add_f32_dpp v177, v177, v177 row_ror:2 row_mask:0xf bank_mask:0xf
  v_add_f32_dpp v179, v179, v179 row_ror:2 row_mask:0xf bank_mask:0xf
  s_nop 1
  v_add_f32_dpp v177, v177, v177 row_ror:1 row_mask:0xf bank_mask:0xf
  v_add_f32_dpp v179, v179, v179 row_ror:1 row_mask:0xf bank_mask:0xf
  v_mul_f32 v177, 0x3aaaaaab, v177
  v_mul_f32 v179, 0x3aaaaaab, v179
  v_cvt_pk_bf16_f32 v200, v180, v181
  v_lshlrev_b32 v180, 16, v200
  v_and_b32 v181, 0xffff0000, v200
  v_cvt_pk_bf16_f32 v200, v177, v179
  v_lshlrev_b32 v177, 16, v200
  v_and_b32 v179, 0xffff0000, v200
  v_add_f32 v177, 0x3727c5ac, v177
  v_add_f32 v179, 0x3727c5ac, v179
  v_cvt_pk_bf16_f32 v200, v177, v179
  v_lshlrev_b32 v177, 16, v200
  v_and_b32 v179, 0xffff0000, v200
  v_sqrt_f32 v177, v177
  v_sqrt_f32 v179, v179
  s_nop 0
  v_cvt_pk_bf16_f32 v200, v177, v179
  v_lshlrev_b32 v177, 16, v200
  v_and_b32 v179, 0xffff0000, v200
  v_rcp_f32 v177, v177
  v_rcp_f32 v179, v179
  v_mov_b32 v176, v180
  v_mov_b32 v178, v181
  v_lshrrev_b32 v6, 4, v23
  v_lshlrev_b32 v6, 3, v6
  ds_write_b64 v6, v[176:177] offset:32768
  ds_write_b64 v6, v[178:179] offset:33024
  s_lshl_b32 s10, s14, 8
  v_lshlrev_b32 v7, 5, v3
  v_add_u32 v7, s10, v7
  s_waitcnt lgkmcnt(0)
  s_barrier
  s_cmp_lg_u32 s75, 0
  s_cbranch_scc1 Loc_23
  ds_read_b128 v[176:179], v7 offset:32768
  ds_read_b128 v[180:183], v7 offset:32784
  ds_read_b128 v[184:187], v7 offset:32896
  ds_read_b128 v[188:191], v7 offset:32912
  s_waitcnt lgkmcnt(0)
  v_sub_f32 v120, v120, v176
  v_sub_f32 v121, v121, v178
  v_sub_f32 v122, v122, v180
  v_sub_f32 v123, v123, v182
  v_sub_f32 v124, v124, v184
  v_sub_f32 v125, v125, v186
  v_sub_f32 v126, v126, v188
  v_sub_f32 v127, v127, v190
  v_sub_f32 v128, v128, v176
  v_sub_f32 v129, v129, v178
  v_sub_f32 v130, v130, v180
  v_sub_f32 v131, v131, v182
  v_sub_f32 v132, v132, v184
  v_sub_f32 v133, v133, v186
  v_sub_f32 v134, v134, v188
  v_sub_f32 v135, v135, v190
  v_sub_f32 v136, v136, v176
  v_sub_f32 v137, v137, v178
  v_sub_f32 v138, v138, v180
  v_sub_f32 v139, v139, v182
  v_sub_f32 v140, v140, v184
  v_sub_f32 v141, v141, v186
  v_sub_f32 v142, v142, v188
  v_sub_f32 v143, v143, v190
  v_cvt_pk_bf16_f32 v72, v120, v121
  v_cvt_pk_bf16_f32 v73, v122, v123
  v_cvt_pk_bf16_f32 v74, v124, v125
  v_cvt_pk_bf16_f32 v75, v126, v127
  v_cvt_pk_bf16_f32 v76, v128, v129
  v_cvt_pk_bf16_f32 v77, v130, v131
  v_cvt_pk_bf16_f32 v78, v132, v133
  v_cvt_pk_bf16_f32 v79, v134, v135
  v_cvt_pk_bf16_f32 v80, v136, v137
  v_cvt_pk_bf16_f32 v81, v138, v139
  v_cvt_pk_bf16_f32 v82, v140, v141
  v_cvt_pk_bf16_f32 v83, v142, v143
  v_lshlrev_b32 v120, 16, v72
  v_and_b32 v121, 0xffff0000, v72
  v_lshlrev_b32 v122, 16, v73
  v_and_b32 v123, 0xffff0000, v73
  v_lshlrev_b32 v124, 16, v74
  v_and_b32 v125, 0xffff0000, v74
  v_lshlrev_b32 v126, 16, v75
  v_and_b32 v127, 0xffff0000, v75
  v_lshlrev_b32 v128, 16, v76
  v_and_b32 v129, 0xffff0000, v76
  v_lshlrev_b32 v130, 16, v77
  v_and_b32 v131, 0xffff0000, v77
  v_lshlrev_b32 v132, 16, v78
  v_and_b32 v133, 0xffff0000, v78
  v_lshlrev_b32 v134, 16, v79
  v_and_b32 v135, 0xffff0000, v79
  v_lshlrev_b32 v136, 16, v80
  v_and_b32 v137, 0xffff0000, v80
  v_lshlrev_b32 v138, 16, v81
  v_and_b32 v139, 0xffff0000, v81
  v_lshlrev_b32 v140, 16, v82
  v_and_b32 v141, 0xffff0000, v82
  v_lshlrev_b32 v142, 16, v83
  v_and_b32 v143, 0xffff0000, v83
  v_mul_f32 v120, v120, v177
  v_mul_f32 v121, v121, v179
  v_mul_f32 v122, v122, v181
  v_mul_f32 v123, v123, v183
  v_mul_f32 v124, v124, v185
  v_mul_f32 v125, v125, v187
  v_mul_f32 v126, v126, v189
  v_mul_f32 v127, v127, v191
  v_mul_f32 v128, v128, v177
  v_mul_f32 v129, v129, v179
  v_mul_f32 v130, v130, v181
  v_mul_f32 v131, v131, v183
  v_mul_f32 v132, v132, v185
  v_mul_f32 v133, v133, v187
  v_mul_f32 v134, v134, v189
  v_mul_f32 v135, v135, v191
  v_mul_f32 v136, v136, v177
  v_mul_f32 v137, v137, v179
  v_mul_f32 v138, v138, v181
  v_mul_f32 v139, v139, v183
  v_mul_f32 v140, v140, v185
  v_mul_f32 v141, v141, v187
  v_mul_f32 v142, v142, v189
  v_mul_f32 v143, v143, v191
  v_cvt_pk_bf16_f32 v120, v120, v121
  v_cvt_pk_bf16_f32 v121, v122, v123
  v_cvt_pk_bf16_f32 v124, v124, v125
  v_cvt_pk_bf16_f32 v125, v126, v127
  v_cvt_pk_bf16_f32 v128, v128, v129
  v_cvt_pk_bf16_f32 v129, v130, v131
  v_cvt_pk_bf16_f32 v132, v132, v133
  v_cvt_pk_bf16_f32 v133, v134, v135
  v_cvt_pk_bf16_f32 v136, v136, v137
  v_cvt_pk_bf16_f32 v137, v138, v139
  v_cvt_pk_bf16_f32 v140, v140, v141
  v_cvt_pk_bf16_f32 v141, v142, v143
  ds_write_b64 v21, v[120:121] offset:0
  ds_write_b64 v21, v[124:125] offset:32
  ds_write_b64 v21, v[128:129] offset:2304
  ds_write_b64 v21, v[132:133] offset:2336
  ds_write_b64 v21, v[136:137] offset:4608
  ds_write_b64 v21, v[140:141] offset:4640
  s_waitcnt lgkmcnt(0)
Loc_23:
  s_barrier
  ds_read_b128 v[192:195], v172
  ds_read_b128 v[196:199], v173
  s_waitcnt lgkmcnt(1)
  buffer_store_dwordx4 v[192:195], v174, s[60:63], s72 offen
  s_waitcnt lgkmcnt(0)
  buffer_store_dwordx4 v[196:199], v175, s[60:63], s72 offen
  s_branch Lbody_end
Lbody_g2:
  s_mul_i32 s90, s101, 64
  s_add_u32 s90, s90, s5
  s_add_u32 s90, s90, 0
  s_lshl_b32 s90, s90, 7
  s_add_u32 s91, s5, 32
  s_lshl_b32 s91, s91, 7
  s_add_u32 s93, s5, 160
  s_lshl_b32 s93, s93, 7
  s_mul_i32 s10, s101, 13631488
  s_add_u32 s10, s10, 25165824
  s_add_u32 s44, s42, s10
  s_addc_u32 s45, s43, 0
  s_mov_b32 s46, 3244032
  s_mov_b32 s47, 0x20000
  s_mov_b32 s48, s32
  s_mov_b32 s49, s33
  s_mov_b32 s50, 8388608
  s_mov_b32 s51, 0x20000
  s_add_u32 s52, s42, 29360128
  s_addc_u32 s53, s43, 0
  s_mov_b32 s54, 3145728
  s_mov_b32 s55, 0x20000
  s_add_u32 s56, s42, 18874368
  s_addc_u32 s57, s43, 0
  s_mov_b32 s58, 6291456
  s_mov_b32 s59, 0x20000
  s_mov_b32 s60, s34
  s_mov_b32 s61, s35
  s_mov_b32 s62, 4096
  s_mov_b32 s63, 0x20000
  s_mul_i32 s6, s4, 96
  s_lshl_b32 s7, s5, 6
  s_mul_i32 s8, s6, 4224
  s_mul_i32 s9, s7, 4096
  s_and_b32 s74, s3, 3
  s_add_u32 s10, s74, 0
  s_lshl_b32 s11, s10, 2
  v_add_u32 v6, s11, v3
  v_and_b32 v6, 7, v6
  v_xor_b32 v6, v6, v4
  s_lshl_b32 s11, s10, 3
  v_add_u32 v7, s11, v2
  s_mov_b32 s12, 4224
  v_mul_lo_u32 v7, v7, s12
  v_lshl_add_u32 v24, v6, 4, v7
  s_lshl_b32 s64, s10, 10
  s_add_u32 s10, s74, 4
  s_lshl_b32 s11, s10, 2
  v_add_u32 v6, s11, v3
  v_and_b32 v6, 7, v6
  v_xor_b32 v6, v6, v4
  s_lshl_b32 s11, s10, 3
  v_add_u32 v7, s11, v2
  s_mov_b32 s12, 4224
  v_mul_lo_u32 v7, v7, s12
  v_lshl_add_u32 v25, v6, 4, v7
  s_lshl_b32 s65, s10, 10
  s_add_u32 s10, s74, 8
  s_lshl_b32 s11, s10, 2
  v_add_u32 v6, s11, v3
  v_and_b32 v6, 7, v6
  v_xor_b32 v6, v6, v4
  s_lshl_b32 s11, s10, 3
  v_add_u32 v7, s11, v2
  s_mov_b32 s12, 4224
  v_mul_lo_u32 v7, v7, s12
  v_lshl_add_u32 v26, v6, 4, v7
  s_lshl_b32 s66, s10, 10
  s_add_u32 s10, s74, 0
  s_lshl_b32 s11, s10, 2
  v_add_u32 v6, s11, v3
  v_and_b32 v6, 7, v6
  v_xor_b32 v6, v6, v4
  s_lshl_b32 s11, s10, 3
  v_add_u32 v7, s11, v2
  s_mov_b32 s12, 4096
  v_mul_lo_u32 v7, v7, s12
  v_lshl_add_u32 v27, v6, 4, v7
  s_lshl_b32 s67, s10, 10
  s_add_u32 s67, s67, 12288
  s_add_u32 s10, s74, 4
  s_lshl_b32 s11, s10, 2
  v_add_u32 v6, s11, v3
  v_and_b32 v6, 7, v6
  v_xor_b32 v6, v6, v4
  s_lshl_b32 s11, s10, 3
  v_add_u32 v7, s11, v2
  s_mov_b32 s12, 4096
  v_mul_lo_u32 v7, v7, s12
  v_lshl_add_u32 v28, v6, 4, v7
  s_lshl_b32 s68, s10, 10
  s_add_u32 s68, s68, 12288
  s_lshr_b32 s13, s74, 1
  s_and_b32 s14, s74, 1
  v_lshrrev_b32 v6, 1, v5
  v_xor_b32 v6, v6, v3
  v_lshlrev_b32 v6, 4, v6
  v_lshl_add_u32 v6, v5, 7, v6
  v_xor_b32 v7, 64, v6
  s_mul_i32 s10, s13, 6144
  s_mul_i32 s11, s14, 4096
  s_add_u32 s11, s11, 12288
  v_add_u32 v8, s10, v6
  v_add_u32 v14, s11, v6
  v_add_u32 v9, s10, v7
  v_add_u32 v15, s11, v7
  v_add_u32 v10, s10, v6
  v_add_u32 v16, s11, v6
  v_add_u32 v10, 65536, v10
  v_add_u32 v16, 65536, v16
  v_add_u32 v11, s10, v7
  v_add_u32 v17, s11, v7
  v_add_u32 v11, 65536, v11
  v_add_u32 v17, 65536, v17
  v_add_u32 v12, s10, v6
  v_add_u32 v18, s11, v6
  v_add_u32 v12, 131072, v12
  v_add_u32 v18, 131072, v18
  v_add_u32 v13, s10, v7
  v_add_u32 v19, s11, v7
  v_add_u32 v13, 131072, v13
  v_add_u32 v19, 131072, v19
  s_cmp_eq_u32 s75, 0
  s_cbranch_scc1 Lpr_24
  s_add_u32 m0, s64, 0
  s_nop 0
  buffer_load_dwordx4 v24, s[44:47], s8 offen lds
  s_add_u32 m0, s65, 0
  s_nop 0
  buffer_load_dwordx4 v25, s[44:47], s8 offen lds
  s_add_u32 m0, s66, 0
  s_nop 0
  buffer_load_dwordx4 v26, s[44:47], s8 offen lds
  s_add_u32 m0, s67, 0
  s_nop 0
  buffer_load_dwordx4 v27, s[48:51], s9 offen  lds
  s_add_u32 m0, s68, 0
  s_nop 0
  buffer_load_dwordx4 v28, s[48:51], s9 offen  lds
  s_add_u32 s8, s8, 128
  s_add_u32 s9, s9, 128
  s_add_u32 m0, s64, 20480
  s_nop 0
  buffer_load_dwordx4 v24, s[44:47], s8 offen lds
  s_add_u32 m0, s65, 20480
  s_nop 0
  buffer_load_dwordx4 v25, s[44:47], s8 offen lds
  s_add_u32 m0, s66, 20480
  s_nop 0
  buffer_load_dwordx4 v26, s[44:47], s8 offen lds
  s_add_u32 m0, s67, 20480
  s_nop 0
  buffer_load_dwordx4 v27, s[48:51], s9 offen  lds
  s_add_u32 m0, s68, 20480
  s_nop 0
  buffer_load_dwordx4 v28, s[48:51], s9 offen  lds
  s_add_u32 s8, s8, 128
  s_add_u32 s9, s9, 128
  s_add_u32 m0, s64, 40960
  s_nop 0
  buffer_load_dwordx4 v24, s[44:47], s8 offen lds
  s_add_u32 m0, s65, 40960
  s_nop 0
  buffer_load_dwordx4 v25, s[44:47], s8 offen lds
  s_add_u32 m0, s66, 40960
  s_nop 0
  buffer_load_dwordx4 v26, s[44:47], s8 offen lds
  s_add_u32 m0, s67, 40960
  s_nop 0
  buffer_load_dwordx4 v27, s[48:51], s9 offen  lds
  s_add_u32 m0, s68, 40960
  s_nop 0
  buffer_load_dwordx4 v28, s[48:51], s9 offen  lds
  s_add_u32 s8, s8, 128
  s_add_u32 s9, s9, 128
  s_add_u32 m0, s64, 61440
  s_nop 0
  buffer_load_dwordx4 v24, s[44:47], s8 offen lds
  s_add_u32 m0, s65, 61440
  s_nop 0
  buffer_load_dwordx4 v25, s[44:47], s8 offen lds
  s_add_u32 m0, s66, 61440
  s_nop 0
  buffer_load_dwordx4 v26, s[44:47], s8 offen lds
  s_add_u32 m0, s67, 61440
  s_nop 0
  buffer_load_dwordx4 v27, s[48:51], s9 offen  lds
  s_add_u32 m0, s68, 61440
  s_nop 0
  buffer_load_dwordx4 v28, s[48:51], s9 offen  lds
  s_add_u32 s8, s8, 128
  s_add_u32 s9, s9, 128
  s_add_u32 m0, s64, 81920
  s_nop 0
  buffer_load_dwordx4 v24, s[44:47], s8 offen lds
  s_add_u32 m0, s65, 81920
  s_nop 0
  buffer_load_dwordx4 v25, s[44:47], s8 offen lds
  s_add_u32 m0, s66, 81920
  s_nop 0
  buffer_load_dwordx4 v26, s[44:47], s8 offen lds
  s_add_u32 m0, s67, 81920
  s_nop 0
  buffer_load_dwordx4 v27, s[48:51], s9 offen  lds
  s_add_u32 m0, s68, 81920
  s_nop 0
  buffer_load_dwordx4 v28, s[48:51], s9 offen  lds
  s_add_u32 s8, s8, 128
  s_add_u32 s9, s9, 128
  s_add_u32 m0, s64, 102400
  s_nop 0
  buffer_load_dwordx4 v24, s[44:47], s8 offen lds
  s_add_u32 m0, s65, 102400
  s_nop 0
  buffer_load_dwordx4 v25, s[44:47], s8 offen lds
  s_add_u32 m0, s66, 102400
  s_nop 0
  buffer_load_dwordx4 v26, s[44:47], s8 offen lds
  s_add_u32 m0, s67, 102400
  s_nop 0
  buffer_load_dwordx4 v27, s[48:51], s9 offen  lds
  s_add_u32 m0, s68, 102400
  s_nop 0
  buffer_load_dwordx4 v28, s[48:51], s9 offen  lds
  s_add_u32 s8, s8, 128
  s_add_u32 s9, s9, 128
Lpr_24:
  v_add_u32 v6, 0, v23
  v_mul_u32_u24 v7, 43691, v6
  v_lshrrev_b32 v7, 19, v7
  v_mul_u32_u24 v20, 12, v7
  v_sub_u32 v20, v6, v20
  v_mul_u32_u24 v144, 208, v7
  v_lshl_add_u32 v144, v20, 4, v144
  v_add_u32 v144, 65536, v144
  v_mul_u32_u24 v146, 1536, v7
  v_lshl_add_u32 v146, v20, 4, v146
  v_mul_u32_u24 v148, 3072, v7
  v_lshl_add_u32 v148, v20, 4, v148
  v_add_u32 v6, 512, v23
  v_mul_u32_u24 v7, 43691, v6
  v_lshrrev_b32 v7, 19, v7
  v_mul_u32_u24 v20, 12, v7
  v_sub_u32 v20, v6, v20
  v_mul_u32_u24 v145, 208, v7
  v_lshl_add_u32 v145, v20, 4, v145
  v_add_u32 v145, 65536, v145
  v_mul_u32_u24 v147, 1536, v7
  v_lshl_add_u32 v147, v20, 4, v147
  v_mul_u32_u24 v149, 3072, v7
  v_lshl_add_u32 v149, v20, 4, v149
  v_cmp_gt_u32 vcc, 768, v6
  v_mov_b32 v22, 0x7ffffff0
  s_nop 0
  v_cndmask_b32 v147, v22, v147, vcc
  v_cndmask_b32 v149, v22, v149, vcc
  v_mov_b32 v22, 65536
  v_cndmask_b32 v145, v22, v145, vcc
  s_mul_i32 s15, s7, 1536
  s_lshl_b32 s11, s6, 1
  s_add_u32 s15, s15, s11
  s_mul_i32 s72, s7, 3072
  s_add_u32 s72, s72, s11
  buffer_load_dwordx4 v[152:155], v148, s[56:59], s72 offen
  buffer_load_dwordx4 v[156:159], v149, s[56:59], s72 offen
  s_mul_i32 s10, s14, 32
  s_add_u32 s10, s10, s7
  s_lshl_b32 s73, s10, 1
  v_lshlrev_b32 v22, 1, v5
  buffer_load_ushort v160, v22, s[60:63], s73 offen offset:0
  buffer_load_ushort v161, v22, s[60:63], s73 offen offset:32
  s_mul_i32 s10, s14, 6656
  s_mul_i32 s11, s13, 96
  s_add_u32 s10, s10, s11
  s_add_u32 s10, s10, 65536
  v_mul_u32_u24 v20, 208, v5
  v_lshl_add_u32 v20, v3, 3, v20
  v_add_u32 v20, s10, v20
  s_cmp_lg_u32 s75, 0
  s_cbranch_scc1 Lld_25
  v_mov_b32 v120, 0
  v_mov_b32 v121, 0
  v_mov_b32 v122, 0
  v_mov_b32 v123, 0
  v_mov_b32 v124, 0
  v_mov_b32 v125, 0
  v_mov_b32 v126, 0
  v_mov_b32 v127, 0
  v_mov_b32 v128, 0
  v_mov_b32 v129, 0
  v_mov_b32 v130, 0
  v_mov_b32 v131, 0
  v_mov_b32 v132, 0
  v_mov_b32 v133, 0
  v_mov_b32 v134, 0
  v_mov_b32 v135, 0
  v_mov_b32 v136, 0
  v_mov_b32 v137, 0
  v_mov_b32 v138, 0
  v_mov_b32 v139, 0
  v_mov_b32 v140, 0
  v_mov_b32 v141, 0
  v_mov_b32 v142, 0
  v_mov_b32 v143, 0
  s_barrier
  ds_read_b128 v[40:43], v8 offset:0
  ds_read_b128 v[44:47], v8 offset:2048
  ds_read_b128 v[48:51], v8 offset:4096
  ds_read_b128 v[52:55], v14 offset:0
  ds_read_b128 v[56:59], v14 offset:2048
  ds_read_b128 v[60:63], v9 offset:0
  ds_read_b128 v[64:67], v9 offset:2048
  ds_read_b128 v[68:71], v9 offset:4096
  ds_read_b128 v[72:75], v15 offset:0
  ds_read_b128 v[76:79], v15 offset:2048
  s_waitcnt lgkmcnt(0)
  s_barrier
  ds_read_b128 v[80:83], v8 offset:20480
  ds_read_b128 v[84:87], v8 offset:22528
  ds_read_b128 v[88:91], v8 offset:24576
  ds_read_b128 v[92:95], v14 offset:20480
  ds_read_b128 v[96:99], v14 offset:22528
  ds_read_b128 v[100:103], v9 offset:20480
  ds_read_b128 v[104:107], v9 offset:22528
  ds_read_b128 v[108:111], v9 offset:24576
  ds_read_b128 v[112:115], v15 offset:20480
  ds_read_b128 v[116:119], v15 offset:22528
  v_mfma_f32_16x16x32_bf16 v[120:123], v[40:43], v[52:55], v[120:123]
  v_mfma_f32_16x16x32_bf16 v[124:127], v[40:43], v[56:59], v[124:127]
  v_mfma_f32_16x16x32_bf16 v[128:131], v[44:47], v[52:55], v[128:131]
  v_mfma_f32_16x16x32_bf16 v[132:135], v[44:47], v[56:59], v[132:135]
  v_mfma_f32_16x16x32_bf16 v[136:139], v[48:51], v[52:55], v[136:139]
  v_mfma_f32_16x16x32_bf16 v[140:143], v[48:51], v[56:59], v[140:143]
  v_mfma_f32_16x16x32_bf16 v[120:123], v[60:63], v[72:75], v[120:123]
  v_mfma_f32_16x16x32_bf16 v[124:127], v[60:63], v[76:79], v[124:127]
  v_mfma_f32_16x16x32_bf16 v[128:131], v[64:67], v[72:75], v[128:131]
  v_mfma_f32_16x16x32_bf16 v[132:135], v[64:67], v[76:79], v[132:135]
  v_mfma_f32_16x16x32_bf16 v[136:139], v[68:71], v[72:75], v[136:139]
  v_mfma_f32_16x16x32_bf16 v[140:143], v[68:71], v[76:79], v[140:143]
  s_waitcnt lgkmcnt(0)
  s_barrier
  ds_read_b128 v[40:43], v8 offset:40960
  ds_read_b128 v[44:47], v8 offset:43008
  ds_read_b128 v[48:51], v8 offset:45056
  ds_read_b128 v[52:55], v14 offset:40960
  ds_read_b128 v[56:59], v14 offset:43008
  ds_read_b128 v[60:63], v9 offset:40960
  ds_read_b128 v[64:67], v9 offset:43008
  ds_read_b128 v[68:71], v9 offset:45056
  ds_read_b128 v[72:75], v15 offset:40960
  ds_read_b128 v[76:79], v15 offset:43008
  v_mfma_f32_16x16x32_bf16 v[120:123], v[80:83], v[92:95], v[120:123]
  v_mfma_f32_16x16x32_bf16 v[124:127], v[80:83], v[96:99], v[124:127]
  v_mfma_f32_16x16x32_bf16 v[128:131], v[84:87], v[92:95], v[128:131]
  v_mfma_f32_16x16x32_bf16 v[132:135], v[84:87], v[96:99], v[132:135]
  v_mfma_f32_16x16x32_bf16 v[136:139], v[88:91], v[92:95], v[136:139]
  v_mfma_f32_16x16x32_bf16 v[140:143], v[88:91], v[96:99], v[140:143]
  v_mfma_f32_16x16x32_bf16 v[120:123], v[100:103], v[112:115], v[120:123]
  v_mfma_f32_16x16x32_bf16 v[124:127], v[100:103], v[116:119], v[124:127]
  v_mfma_f32_16x16x32_bf16 v[128:131], v[104:107], v[112:115], v[128:131]
  v_mfma_f32_16x16x32_bf16 v[132:135], v[104:107], v[116:119], v[132:135]
  v_mfma_f32_16x16x32_bf16 v[136:139], v[108:111], v[112:115], v[136:139]
  v_mfma_f32_16x16x32_bf16 v[140:143], v[108:111], v[116:119], v[140:143]
  s_waitcnt lgkmcnt(0)
  s_barrier
  ds_read_b128 v[80:83], v8 offset:61440
  ds_read_b128 v[84:87], v8 offset:63488
  ds_read_b128 v[88:91], v10 offset:0
  ds_read_b128 v[92:95], v14 offset:61440
  ds_read_b128 v[96:99], v14 offset:63488
  ds_read_b128 v[100:103], v9 offset:61440
  ds_read_b128 v[104:107], v9 offset:63488
  ds_read_b128 v[108:111], v11 offset:0
  ds_read_b128 v[112:115], v15 offset:61440
  ds_read_b128 v[116:119], v15 offset:63488
  v_mfma_f32_16x16x32_bf16 v[120:123], v[40:43], v[52:55], v[120:123]
  v_mfma_f32_16x16x32_bf16 v[124:127], v[40:43], v[56:59], v[124:127]
  v_mfma_f32_16x16x32_bf16 v[128:131], v[44:47], v[52:55], v[128:131]
  v_mfma_f32_16x16x32_bf16 v[132:135], v[44:47], v[56:59], v[132:135]
  v_mfma_f32_16x16x32_bf16 v[136:139], v[48:51], v[52:55], v[136:139]
  v_mfma_f32_16x16x32_bf16 v[140:143], v[48:51], v[56:59], v[140:143]
  v_mfma_f32_16x16x32_bf16 v[120:123], v[60:63], v[72:75], v[120:123]
  v_mfma_f32_16x16x32_bf16 v[124:127], v[60:63], v[76:79], v[124:127]
  v_mfma_f32_16x16x32_bf16 v[128:131], v[64:67], v[72:75], v[128:131]
  v_mfma_f32_16x16x32_bf16 v[132:135], v[64:67], v[76:79], v[132:135]
  v_mfma_f32_16x16x32_bf16 v[136:139], v[68:71], v[72:75], v[136:139]
  v_mfma_f32_16x16x32_bf16 v[140:143], v[68:71], v[76:79], v[140:143]
  s_waitcnt lgkmcnt(0)
  s_barrier
  ds_read_b128 v[40:43], v10 offset:16384
  ds_read_b128 v[44:47], v10 offset:18432
  ds_read_b128 v[48:51], v10 offset:20480
  ds_read_b128 v[52:55], v16 offset:16384
  ds_read_b128 v[56:59], v16 offset:18432
  ds_read_b128 v[60:63], v11 offset:16384
  ds_read_b128 v[64:67], v11 offset:18432
  ds_read_b128 v[68:71], v11 offset:20480
  ds_read_b128 v[72:75], v17 offset:16384
  ds_read_b128 v[76:79], v17 offset:18432
  v_mfma_f32_16x16x32_bf16 v[120:123], v[80:83], v[92:95], v[120:123]
  v_mfma_f32_16x16x32_bf16 v[124:127], v[80:83], v[96:99], v[124:127]
  v_mfma_f32_16x16x32_bf16 v[128:131], v[84:87], v[92:95], v[128:131]
  v_mfma_f32_16x16x32_bf16 v[132:135], v[84:87], v[96:99], v[132:135]
  v_mfma_f32_16x16x32_bf16 v[136:139], v[88:91], v[92:95], v[136:139]
  v_mfma_f32_16x16x32_bf16 v[140:143], v[88:91], v[96:99], v[140:143]
  v_mfma_f32_16x16x32_bf16 v[120:123], v[100:103], v[112:115], v[120:123]
  v_mfma_f32_16x16x32_bf16 v[124:127], v[100:103], v[116:119], v[124:127]
  v_mfma_f32_16x16x32_bf16 v[128:131], v[104:107], v[112:115], v[128:131]
  v_mfma_f32_16x16x32_bf16 v[132:135], v[104:107], v[116:119], v[132:135]
  v_mfma_f32_16x16x32_bf16 v[136:139], v[108:111], v[112:115], v[136:139]
  v_mfma_f32_16x16x32_bf16 v[140:143], v[108:111], v[116:119], v[140:143]
  s_waitcnt lgkmcnt(0)
  s_barrier
  ds_read_b128 v[80:83], v10 offset:36864
  ds_read_b128 v[84:87], v10 offset:38912
  ds_read_b128 v[88:91], v10 offset:40960
  ds_read_b128 v[92:95], v16 offset:36864
  ds_read_b128 v[96:99], v16 offset:38912
  ds_read_b128 v[100:103], v11 offset:36864
  ds_read_b128 v[104:107], v11 offset:38912
  ds_read_b128 v[108:111], v11 offset:40960
  ds_read_b128 v[112:115], v17 offset:36864
  ds_read_b128 v[116:119], v17 offset:38912
  v_mfma_f32_16x16x32_bf16 v[120:123], v[40:43], v[52:55], v[120:123]
  v_mfma_f32_16x16x32_bf16 v[124:127], v[40:43], v[56:59], v[124:127]
  v_mfma_f32_16x16x32_bf16 v[128:131], v[44:47], v[52:55], v[128:131]
  v_mfma_f32_16x16x32_bf16 v[132:135], v[44:47], v[56:59], v[132:135]
  v_mfma_f32_16x16x32_bf16 v[136:139], v[48:51], v[52:55], v[136:139]
  v_mfma_f32_16x16x32_bf16 v[140:143], v[48:51], v[56:59], v[140:143]
  v_mfma_f32_16x16x32_bf16 v[120:123], v[60:63], v[72:75], v[120:123]
  v_mfma_f32_16x16x32_bf16 v[124:127], v[60:63], v[76:79], v[124:127]
  v_mfma_f32_16x16x32_bf16 v[128:131], v[64:67], v[72:75], v[128:131]
  v_mfma_f32_16x16x32_bf16 v[132:135], v[64:67], v[76:79], v[132:135]
  v_mfma_f32_16x16x32_bf16 v[136:139], v[68:71], v[72:75], v[136:139]
  v_mfma_f32_16x16x32_bf16 v[140:143], v[68:71], v[76:79], v[140:143]
  s_waitcnt lgkmcnt(0)
  s_barrier
  ds_read_b128 v[40:43], v10 offset:57344
  ds_read_b128 v[44:47], v10 offset:59392
  ds_read_b128 v[48:51], v10 offset:61440
  ds_read_b128 v[52:55], v16 offset:57344
  ds_read_b128 v[56:59], v16 offset:59392
  ds_read_b128 v[60:63], v11 offset:57344
  ds_read_b128 v[64:67], v11 offset:59392
  ds_read_b128 v[68:71], v11 offset:61440
  ds_read_b128 v[72:75], v17 offset:57344
  ds_read_b128 v[76:79], v17 offset:59392
  v_mfma_f32_16x16x32_bf16 v[120:123], v[80:83], v[92:95], v[120:123]
  v_mfma_f32_16x16x32_bf16 v[124:127], v[80:83], v[96:99], v[124:127]
  v_mfma_f32_16x16x32_bf16 v[128:131], v[84:87], v[92:95], v[128:131]
  v_mfma_f32_16x16x32_bf16 v[132:135], v[84:87], v[96:99], v[132:135]
  v_mfma_f32_16x16x32_bf16 v[136:139], v[88:91], v[92:95], v[136:139]
  v_mfma_f32_16x16x32_bf16 v[140:143], v[88:91], v[96:99], v[140:143]
  v_mfma_f32_16x16x32_bf16 v[120:123], v[100:103], v[112:115], v[120:123]
  v_mfma_f32_16x16x32_bf16 v[124:127], v[100:103], v[116:119], v[124:127]
  v_mfma_f32_16x16x32_bf16 v[128:131], v[104:107], v[112:115], v[128:131]
  v_mfma_f32_16x16x32_bf16 v[132:135], v[104:107], v[116:119], v[132:135]
  v_mfma_f32_16x16x32_bf16 v[136:139], v[108:111], v[112:115], v[136:139]
  v_mfma_f32_16x16x32_bf16 v[140:143], v[108:111], v[116:119], v[140:143]
  s_waitcnt lgkmcnt(0)
  s_barrier
  ds_read_b128 v[80:83], v8 offset:0
  ds_read_b128 v[84:87], v8 offset:2048
  ds_read_b128 v[88:91], v8 offset:4096
  ds_read_b128 v[92:95], v14 offset:0
  ds_read_b128 v[96:99], v14 offset:2048
  ds_read_b128 v[100:103], v9 offset:0
  ds_read_b128 v[104:107], v9 offset:2048
  ds_read_b128 v[108:111], v9 offset:4096
  ds_read_b128 v[112:115], v15 offset:0
  ds_read_b128 v[116:119], v15 offset:2048
  v_mfma_f32_16x16x32_bf16 v[120:123], v[40:43], v[52:55], v[120:123]
  v_mfma_f32_16x16x32_bf16 v[124:127], v[40:43], v[56:59], v[124:127]
  v_mfma_f32_16x16x32_bf16 v[128:131], v[44:47], v[52:55], v[128:131]
  v_mfma_f32_16x16x32_bf16 v[132:135], v[44:47], v[56:59], v[132:135]
  v_mfma_f32_16x16x32_bf16 v[136:139], v[48:51], v[52:55], v[136:139]
  v_mfma_f32_16x16x32_bf16 v[140:143], v[48:51], v[56:59], v[140:143]
  v_mfma_f32_16x16x32_bf16 v[120:123], v[60:63], v[72:75], v[120:123]
  v_mfma_f32_16x16x32_bf16 v[124:127], v[60:63], v[76:79], v[124:127]
  v_mfma_f32_16x16x32_bf16 v[128:131], v[64:67], v[72:75], v[128:131]
  v_mfma_f32_16x16x32_bf16 v[132:135], v[64:67], v[76:79], v[132:135]
  v_mfma_f32_16x16x32_bf16 v[136:139], v[68:71], v[72:75], v[136:139]
  v_mfma_f32_16x16x32_bf16 v[140:143], v[68:71], v[76:79], v[140:143]
  s_waitcnt lgkmcnt(0)
  s_barrier
  ds_read_b128 v[40:43], v8 offset:20480
  ds_read_b128 v[44:47], v8 offset:22528
  ds_read_b128 v[48:51], v8 offset:24576
  ds_read_b128 v[52:55], v14 offset:20480
  ds_read_b128 v[56:59], v14 offset:22528
  ds_read_b128 v[60:63], v9 offset:20480
  ds_read_b128 v[64:67], v9 offset:22528
  ds_read_b128 v[68:71], v9 offset:24576
  ds_read_b128 v[72:75], v15 offset:20480
  ds_read_b128 v[76:79], v15 offset:22528
  v_mfma_f32_16x16x32_bf16 v[120:123], v[80:83], v[92:95], v[120:123]
  v_mfma_f32_16x16x32_bf16 v[124:127], v[80:83], v[96:99], v[124:127]
  v_mfma_f32_16x16x32_bf16 v[128:131], v[84:87], v[92:95], v[128:131]
  v_mfma_f32_16x16x32_bf16 v[132:135], v[84:87], v[96:99], v[132:135]
  v_mfma_f32_16x16x32_bf16 v[136:139], v[88:91], v[92:95], v[136:139]
  v_mfma_f32_16x16x32_bf16 v[140:143], v[88:91], v[96:99], v[140:143]
  v_mfma_f32_16x16x32_bf16 v[120:123], v[100:103], v[112:115], v[120:123]
  v_mfma_f32_16x16x32_bf16 v[124:127], v[100:103], v[116:119], v[124:127]
  v_mfma_f32_16x16x32_bf16 v[128:131], v[104:107], v[112:115], v[128:131]
  v_mfma_f32_16x16x32_bf16 v[132:135], v[104:107], v[116:119], v[132:135]
  v_mfma_f32_16x16x32_bf16 v[136:139], v[108:111], v[112:115], v[136:139]
  v_mfma_f32_16x16x32_bf16 v[140:143], v[108:111], v[116:119], v[140:143]
  s_waitcnt lgkmcnt(0)
  s_barrier
  ds_read_b128 v[80:83], v8 offset:40960
  ds_read_b128 v[84:87], v8 offset:43008
  ds_read_b128 v[88:91], v8 offset:45056
  ds_read_b128 v[92:95], v14 offset:40960
  ds_read_b128 v[96:99], v14 offset:43008
  ds_read_b128 v[100:103], v9 offset:40960
  ds_read_b128 v[104:107], v9 offset:43008
  ds_read_b128 v[108:111], v9 offset:45056
  ds_read_b128 v[112:115], v15 offset:40960
  ds_read_b128 v[116:119], v15 offset:43008
  v_mfma_f32_16x16x32_bf16 v[120:123], v[40:43], v[52:55], v[120:123]
  v_mfma_f32_16x16x32_bf16 v[124:127], v[40:43], v[56:59], v[124:127]
  v_mfma_f32_16x16x32_bf16 v[128:131], v[44:47], v[52:55], v[128:131]
  v_mfma_f32_16x16x32_bf16 v[132:135], v[44:47], v[56:59], v[132:135]
  v_mfma_f32_16x16x32_bf16 v[136:139], v[48:51], v[52:55], v[136:139]
  v_mfma_f32_16x16x32_bf16 v[140:143], v[48:51], v[56:59], v[140:143]
  v_mfma_f32_16x16x32_bf16 v[120:123], v[60:63], v[72:75], v[120:123]
  v_mfma_f32_16x16x32_bf16 v[124:127], v[60:63], v[76:79], v[124:127]
  v_mfma_f32_16x16x32_bf16 v[128:131], v[64:67], v[72:75], v[128:131]
  v_mfma_f32_16x16x32_bf16 v[132:135], v[64:67], v[76:79], v[132:135]
  v_mfma_f32_16x16x32_bf16 v[136:139], v[68:71], v[72:75], v[136:139]
  v_mfma_f32_16x16x32_bf16 v[140:143], v[68:71], v[76:79], v[140:143]
  s_waitcnt lgkmcnt(0)
  s_barrier
  ds_read_b128 v[40:43], v8 offset:61440
  ds_read_b128 v[44:47], v8 offset:63488
  ds_read_b128 v[48:51], v10 offset:0
  ds_read_b128 v[52:55], v14 offset:61440
  ds_read_b128 v[56:59], v14 offset:63488
  ds_read_b128 v[60:63], v9 offset:61440
  ds_read_b128 v[64:67], v9 offset:63488
  ds_read_b128 v[68:71], v11 offset:0
  ds_read_b128 v[72:75], v15 offset:61440
  ds_read_b128 v[76:79], v15 offset:63488
  v_mfma_f32_16x16x32_bf16 v[120:123], v[80:83], v[92:95], v[120:123]
  v_mfma_f32_16x16x32_bf16 v[124:127], v[80:83], v[96:99], v[124:127]
  v_mfma_f32_16x16x32_bf16 v[128:131], v[84:87], v[92:95], v[128:131]
  v_mfma_f32_16x16x32_bf16 v[132:135], v[84:87], v[96:99], v[132:135]
  v_mfma_f32_16x16x32_bf16 v[136:139], v[88:91], v[92:95], v[136:139]
  v_mfma_f32_16x16x32_bf16 v[140:143], v[88:91], v[96:99], v[140:143]
  v_mfma_f32_16x16x32_bf16 v[120:123], v[100:103], v[112:115], v[120:123]
  v_mfma_f32_16x16x32_bf16 v[124:127], v[100:103], v[116:119], v[124:127]
  v_mfma_f32_16x16x32_bf16 v[128:131], v[104:107], v[112:115], v[128:131]
  v_mfma_f32_16x16x32_bf16 v[132:135], v[104:107], v[116:119], v[132:135]
  v_mfma_f32_16x16x32_bf16 v[136:139], v[108:111], v[112:115], v[136:139]
  v_mfma_f32_16x16x32_bf16 v[140:143], v[108:111], v[116:119], v[140:143]
  s_waitcnt lgkmcnt(0)
  s_barrier
  ds_read_b128 v[80:83], v10 offset:16384
  ds_read_b128 v[84:87], v10 offset:18432
  ds_read_b128 v[88:91], v10 offset:20480
  ds_read_b128 v[92:95], v16 offset:16384
  ds_read_b128 v[96:99], v16 offset:18432
  ds_read_b128 v[100:103], v11 offset:16384
  ds_read_b128 v[104:107], v11 offset:18432
  ds_read_b128 v[108:111], v11 offset:20480
  ds_read_b128 v[112:115], v17 offset:16384
  ds_read_b128 v[116:119], v17 offset:18432
  v_mfma_f32_16x16x32_bf16 v[120:123], v[40:43], v[52:55], v[120:123]
  v_mfma_f32_16x16x32_bf16 v[124:127], v[40:43], v[56:59], v[124:127]
  v_mfma_f32_16x16x32_bf16 v[128:131], v[44:47], v[52:55], v[128:131]
  v_mfma_f32_16x16x32_bf16 v[132:135], v[44:47], v[56:59], v[132:135]
  v_mfma_f32_16x16x32_bf16 v[136:139], v[48:51], v[52:55], v[136:139]
  v_mfma_f32_16x16x32_bf16 v[140:143], v[48:51], v[56:59], v[140:143]
  v_mfma_f32_16x16x32_bf16 v[120:123], v[60:63], v[72:75], v[120:123]
  v_mfma_f32_16x16x32_bf16 v[124:127], v[60:63], v[76:79], v[124:127]
  v_mfma_f32_16x16x32_bf16 v[128:131], v[64:67], v[72:75], v[128:131]
  v_mfma_f32_16x16x32_bf16 v[132:135], v[64:67], v[76:79], v[132:135]
  v_mfma_f32_16x16x32_bf16 v[136:139], v[68:71], v[72:75], v[136:139]
  v_mfma_f32_16x16x32_bf16 v[140:143], v[68:71], v[76:79], v[140:143]
  s_waitcnt lgkmcnt(0)
  s_barrier
  ds_read_b128 v[40:43], v10 offset:36864
  ds_read_b128 v[44:47], v10 offset:38912
  ds_read_b128 v[48:51], v10 offset:40960
  ds_read_b128 v[52:55], v16 offset:36864
  ds_read_b128 v[56:59], v16 offset:38912
  ds_read_b128 v[60:63], v11 offset:36864
  ds_read_b128 v[64:67], v11 offset:38912
  ds_read_b128 v[68:71], v11 offset:40960
  ds_read_b128 v[72:75], v17 offset:36864
  ds_read_b128 v[76:79], v17 offset:38912
  v_mfma_f32_16x16x32_bf16 v[120:123], v[80:83], v[92:95], v[120:123]
  v_mfma_f32_16x16x32_bf16 v[124:127], v[80:83], v[96:99], v[124:127]
  v_mfma_f32_16x16x32_bf16 v[128:131], v[84:87], v[92:95], v[128:131]
  v_mfma_f32_16x16x32_bf16 v[132:135], v[84:87], v[96:99], v[132:135]
  v_mfma_f32_16x16x32_bf16 v[136:139], v[88:91], v[92:95], v[136:139]
  v_mfma_f32_16x16x32_bf16 v[140:143], v[88:91], v[96:99], v[140:143]
  v_mfma_f32_16x16x32_bf16 v[120:123], v[100:103], v[112:115], v[120:123]
  v_mfma_f32_16x16x32_bf16 v[124:127], v[100:103], v[116:119], v[124:127]
  v_mfma_f32_16x16x32_bf16 v[128:131], v[104:107], v[112:115], v[128:131]
  v_mfma_f32_16x16x32_bf16 v[132:135], v[104:107], v[116:119], v[132:135]
  v_mfma_f32_16x16x32_bf16 v[136:139], v[108:111], v[112:115], v[136:139]
  v_mfma_f32_16x16x32_bf16 v[140:143], v[108:111], v[116:119], v[140:143]
  s_waitcnt lgkmcnt(0)
  s_barrier
  ds_read_b128 v[80:83], v10 offset:57344
  ds_read_b128 v[84:87], v10 offset:59392
  ds_read_b128 v[88:91], v10 offset:61440
  ds_read_b128 v[92:95], v16 offset:57344
  ds_read_b128 v[96:99], v16 offset:59392
  ds_read_b128 v[100:103], v11 offset:57344
  ds_read_b128 v[104:107], v11 offset:59392
  ds_read_b128 v[108:111], v11 offset:61440
  ds_read_b128 v[112:115], v17 offset:57344
  ds_read_b128 v[116:119], v17 offset:59392
  v_mfma_f32_16x16x32_bf16 v[120:123], v[40:43], v[52:55], v[120:123]
  v_mfma_f32_16x16x32_bf16 v[124:127], v[40:43], v[56:59], v[124:127]
  v_mfma_f32_16x16x32_bf16 v[128:131], v[44:47], v[52:55], v[128:131]
  v_mfma_f32_16x16x32_bf16 v[132:135], v[44:47], v[56:59], v[132:135]
  v_mfma_f32_16x16x32_bf16 v[136:139], v[48:51], v[52:55], v[136:139]
  v_mfma_f32_16x16x32_bf16 v[140:143], v[48:51], v[56:59], v[140:143]
  v_mfma_f32_16x16x32_bf16 v[120:123], v[60:63], v[72:75], v[120:123]
  v_mfma_f32_16x16x32_bf16 v[124:127], v[60:63], v[76:79], v[124:127]
  v_mfma_f32_16x16x32_bf16 v[128:131], v[64:67], v[72:75], v[128:131]
  v_mfma_f32_16x16x32_bf16 v[132:135], v[64:67], v[76:79], v[132:135]
  v_mfma_f32_16x16x32_bf16 v[136:139], v[68:71], v[72:75], v[136:139]
  v_mfma_f32_16x16x32_bf16 v[140:143], v[68:71], v[76:79], v[140:143]
  s_waitcnt lgkmcnt(0)
  s_barrier
  ds_read_b128 v[40:43], v8 offset:0
  ds_read_b128 v[44:47], v8 offset:2048
  ds_read_b128 v[48:51], v8 offset:4096
  ds_read_b128 v[52:55], v14 offset:0
  ds_read_b128 v[56:59], v14 offset:2048
  ds_read_b128 v[60:63], v9 offset:0
  ds_read_b128 v[64:67], v9 offset:2048
  ds_read_b128 v[68:71], v9 offset:4096
  ds_read_b128 v[72:75], v15 offset:0
  ds_read_b128 v[76:79], v15 offset:2048
  v_mfma_f32_16x16x32_bf16 v[120:123], v[80:83], v[92:95], v[120:123]
  v_mfma_f32_16x16x32_bf16 v[124:127], v[80:83], v[96:99], v[124:127]
  v_mfma_f32_16x16x32_bf16 v[128:131], v[84:87], v[92:95], v[128:131]
  v_mfma_f32_16x16x32_bf16 v[132:135], v[84:87], v[96:99], v[132:135]
  v_mfma_f32_16x16x32_bf16 v[136:139], v[88:91], v[92:95], v[136:139]
  v_mfma_f32_16x16x32_bf16 v[140:143], v[88:91], v[96:99], v[140:143]
  v_mfma_f32_16x16x32_bf16 v[120:123], v[100:103], v[112:115], v[120:123]
  v_mfma_f32_16x16x32_bf16 v[124:127], v[100:103], v[116:119], v[124:127]
  v_mfma_f32_16x16x32_bf16 v[128:131], v[104:107], v[112:115], v[128:131]
  v_mfma_f32_16x16x32_bf16 v[132:135], v[104:107], v[116:119], v[132:135]
  v_mfma_f32_16x16x32_bf16 v[136:139], v[108:111], v[112:115], v[136:139]
  v_mfma_f32_16x16x32_bf16 v[140:143], v[108:111], v[116:119], v[140:143]
  s_waitcnt lgkmcnt(0)
  s_barrier
  ds_read_b128 v[80:83], v8 offset:20480
  ds_read_b128 v[84:87], v8 offset:22528
  ds_read_b128 v[88:91], v8 offset:24576
  ds_read_b128 v[92:95], v14 offset:20480
  ds_read_b128 v[96:99], v14 offset:22528
  ds_read_b128 v[100:103], v9 offset:20480
  ds_read_b128 v[104:107], v9 offset:22528
  ds_read_b128 v[108:111], v9 offset:24576
  ds_read_b128 v[112:115], v15 offset:20480
  ds_read_b128 v[116:119], v15 offset:22528
  v_mfma_f32_16x16x32_bf16 v[120:123], v[40:43], v[52:55], v[120:123]
  v_mfma_f32_16x16x32_bf16 v[124:127], v[40:43], v[56:59], v[124:127]
  v_mfma_f32_16x16x32_bf16 v[128:131], v[44:47], v[52:55], v[128:131]
  v_mfma_f32_16x16x32_bf16 v[132:135], v[44:47], v[56:59], v[132:135]
  v_mfma_f32_16x16x32_bf16 v[136:139], v[48:51], v[52:55], v[136:139]
  v_mfma_f32_16x16x32_bf16 v[140:143], v[48:51], v[56:59], v[140:143]
  v_mfma_f32_16x16x32_bf16 v[120:123], v[60:63], v[72:75], v[120:123]
  v_mfma_f32_16x16x32_bf16 v[124:127], v[60:63], v[76:79], v[124:127]
  v_mfma_f32_16x16x32_bf16 v[128:131], v[64:67], v[72:75], v[128:131]
  v_mfma_f32_16x16x32_bf16 v[132:135], v[64:67], v[76:79], v[132:135]
  v_mfma_f32_16x16x32_bf16 v[136:139], v[68:71], v[72:75], v[136:139]
  v_mfma_f32_16x16x32_bf16 v[140:143], v[68:71], v[76:79], v[140:143]
  s_waitcnt lgkmcnt(0)
  s_barrier
  ds_read_b128 v[40:43], v8 offset:40960
  ds_read_b128 v[44:47], v8 offset:43008
  ds_read_b128 v[48:51], v8 offset:45056
  ds_read_b128 v[52:55], v14 offset:40960
  ds_read_b128 v[56:59], v14 offset:43008
  ds_read_b128 v[60:63], v9 offset:40960
  ds_read_b128 v[64:67], v9 offset:43008
  ds_read_b128 v[68:71], v9 offset:45056
  ds_read_b128 v[72:75], v15 offset:40960
  ds_read_b128 v[76:79], v15 offset:43008
  v_mfma_f32_16x16x32_bf16 v[120:123], v[80:83], v[92:95], v[120:123]
  v_mfma_f32_16x16x32_bf16 v[124:127], v[80:83], v[96:99], v[124:127]
  v_mfma_f32_16x16x32_bf16 v[128:131], v[84:87], v[92:95], v[128:131]
  v_mfma_f32_16x16x32_bf16 v[132:135], v[84:87], v[96:99], v[132:135]
  v_mfma_f32_16x16x32_bf16 v[136:139], v[88:91], v[92:95], v[136:139]
  v_mfma_f32_16x16x32_bf16 v[140:143], v[88:91], v[96:99], v[140:143]
  v_mfma_f32_16x16x32_bf16 v[120:123], v[100:103], v[112:115], v[120:123]
  v_mfma_f32_16x16x32_bf16 v[124:127], v[100:103], v[116:119], v[124:127]
  v_mfma_f32_16x16x32_bf16 v[128:131], v[104:107], v[112:115], v[128:131]
  v_mfma_f32_16x16x32_bf16 v[132:135], v[104:107], v[116:119], v[132:135]
  v_mfma_f32_16x16x32_bf16 v[136:139], v[108:111], v[112:115], v[136:139]
  v_mfma_f32_16x16x32_bf16 v[140:143], v[108:111], v[116:119], v[140:143]
  s_waitcnt lgkmcnt(0)
  s_barrier
  ds_read_b128 v[80:83], v8 offset:61440
  ds_read_b128 v[84:87], v8 offset:63488
  ds_read_b128 v[88:91], v10 offset:0
  ds_read_b128 v[92:95], v14 offset:61440
  ds_read_b128 v[96:99], v14 offset:63488
  ds_read_b128 v[100:103], v9 offset:61440
  ds_read_b128 v[104:107], v9 offset:63488
  ds_read_b128 v[108:111], v11 offset:0
  ds_read_b128 v[112:115], v15 offset:61440
  ds_read_b128 v[116:119], v15 offset:63488
  v_mfma_f32_16x16x32_bf16 v[120:123], v[40:43], v[52:55], v[120:123]
  v_mfma_f32_16x16x32_bf16 v[124:127], v[40:43], v[56:59], v[124:127]
  v_mfma_f32_16x16x32_bf16 v[128:131], v[44:47], v[52:55], v[128:131]
  v_mfma_f32_16x16x32_bf16 v[132:135], v[44:47], v[56:59], v[132:135]
  v_mfma_f32_16x16x32_bf16 v[136:139], v[48:51], v[52:55], v[136:139]
  v_mfma_f32_16x16x32_bf16 v[140:143], v[48:51], v[56:59], v[140:143]
  v_mfma_f32_16x16x32_bf16 v[120:123], v[60:63], v[72:75], v[120:123]
  v_mfma_f32_16x16x32_bf16 v[124:127], v[60:63], v[76:79], v[124:127]
  v_mfma_f32_16x16x32_bf16 v[128:131], v[64:67], v[72:75], v[128:131]
  v_mfma_f32_16x16x32_bf16 v[132:135], v[64:67], v[76:79], v[132:135]
  v_mfma_f32_16x16x32_bf16 v[136:139], v[68:71], v[72:75], v[136:139]
  v_mfma_f32_16x16x32_bf16 v[140:143], v[68:71], v[76:79], v[140:143]
  s_waitcnt lgkmcnt(0)
  s_barrier
  ds_read_b128 v[40:43], v10 offset:16384
  ds_read_b128 v[44:47], v10 offset:18432
  ds_read_b128 v[48:51], v10 offset:20480
  ds_read_b128 v[52:55], v16 offset:16384
  ds_read_b128 v[56:59], v16 offset:18432
  ds_read_b128 v[60:63], v11 offset:16384
  ds_read_b128 v[64:67], v11 offset:18432
  ds_read_b128 v[68:71], v11 offset:20480
  ds_read_b128 v[72:75], v17 offset:16384
  ds_read_b128 v[76:79], v17 offset:18432
  v_mfma_f32_16x16x32_bf16 v[120:123], v[80:83], v[92:95], v[120:123]
  v_mfma_f32_16x16x32_bf16 v[124:127], v[80:83], v[96:99], v[124:127]
  v_mfma_f32_16x16x32_bf16 v[128:131], v[84:87], v[92:95], v[128:131]
  v_mfma_f32_16x16x32_bf16 v[132:135], v[84:87], v[96:99], v[132:135]
  v_mfma_f32_16x16x32_bf16 v[136:139], v[88:91], v[92:95], v[136:139]
  v_mfma_f32_16x16x32_bf16 v[140:143], v[88:91], v[96:99], v[140:143]
  v_mfma_f32_16x16x32_bf16 v[120:123], v[100:103], v[112:115], v[120:123]
  v_mfma_f32_16x16x32_bf16 v[124:127], v[100:103], v[116:119], v[124:127]
  v_mfma_f32_16x16x32_bf16 v[128:131], v[104:107], v[112:115], v[128:131]
  v_mfma_f32_16x16x32_bf16 v[132:135], v[104:107], v[116:119], v[132:135]
  v_mfma_f32_16x16x32_bf16 v[136:139], v[108:111], v[112:115], v[136:139]
  v_mfma_f32_16x16x32_bf16 v[140:143], v[108:111], v[116:119], v[140:143]
  s_waitcnt lgkmcnt(0)
  s_barrier
  ds_read_b128 v[80:83], v10 offset:36864
  ds_read_b128 v[84:87], v10 offset:38912
  ds_read_b128 v[88:91], v10 offset:40960
  ds_read_b128 v[92:95], v16 offset:36864
  ds_read_b128 v[96:99], v16 offset:38912
  ds_read_b128 v[100:103], v11 offset:36864
  ds_read_b128 v[104:107], v11 offset:38912
  ds_read_b128 v[108:111], v11 offset:40960
  ds_read_b128 v[112:115], v17 offset:36864
  ds_read_b128 v[116:119], v17 offset:38912
  v_mfma_f32_16x16x32_bf16 v[120:123], v[40:43], v[52:55], v[120:123]
  v_mfma_f32_16x16x32_bf16 v[124:127], v[40:43], v[56:59], v[124:127]
  v_mfma_f32_16x16x32_bf16 v[128:131], v[44:47], v[52:55], v[128:131]
  v_mfma_f32_16x16x32_bf16 v[132:135], v[44:47], v[56:59], v[132:135]
  v_mfma_f32_16x16x32_bf16 v[136:139], v[48:51], v[52:55], v[136:139]
  v_mfma_f32_16x16x32_bf16 v[140:143], v[48:51], v[56:59], v[140:143]
  v_mfma_f32_16x16x32_bf16 v[120:123], v[60:63], v[72:75], v[120:123]
  v_mfma_f32_16x16x32_bf16 v[124:127], v[60:63], v[76:79], v[124:127]
  v_mfma_f32_16x16x32_bf16 v[128:131], v[64:67], v[72:75], v[128:131]
  v_mfma_f32_16x16x32_bf16 v[132:135], v[64:67], v[76:79], v[132:135]
  v_mfma_f32_16x16x32_bf16 v[136:139], v[68:71], v[72:75], v[136:139]
  v_mfma_f32_16x16x32_bf16 v[140:143], v[68:71], v[76:79], v[140:143]
  s_waitcnt lgkmcnt(0)
  s_barrier
  ds_read_b128 v[40:43], v10 offset:57344
  ds_read_b128 v[44:47], v10 offset:59392
  ds_read_b128 v[48:51], v10 offset:61440
  ds_read_b128 v[52:55], v16 offset:57344
  ds_read_b128 v[56:59], v16 offset:59392
  ds_read_b128 v[60:63], v11 offset:57344
  ds_read_b128 v[64:67], v11 offset:59392
  ds_read_b128 v[68:71], v11 offset:61440
  ds_read_b128 v[72:75], v17 offset:57344
  ds_read_b128 v[76:79], v17 offset:59392
  v_mfma_f32_16x16x32_bf16 v[120:123], v[80:83], v[92:95], v[120:123]
  v_mfma_f32_16x16x32_bf16 v[124:127], v[80:83], v[96:99], v[124:127]
  v_mfma_f32_16x16x32_bf16 v[128:131], v[84:87], v[92:95], v[128:131]
  v_mfma_f32_16x16x32_bf16 v[132:135], v[84:87], v[96:99], v[132:135]
  v_mfma_f32_16x16x32_bf16 v[136:139], v[88:91], v[92:95], v[136:139]
  v_mfma_f32_16x16x32_bf16 v[140:143], v[88:91], v[96:99], v[140:143]
  v_mfma_f32_16x16x32_bf16 v[120:123], v[100:103], v[112:115], v[120:123]
  v_mfma_f32_16x16x32_bf16 v[124:127], v[100:103], v[116:119], v[124:127]
  v_mfma_f32_16x16x32_bf16 v[128:131], v[104:107], v[112:115], v[128:131]
  v_mfma_f32_16x16x32_bf16 v[132:135], v[104:107], v[116:119], v[132:135]
  v_mfma_f32_16x16x32_bf16 v[136:139], v[108:111], v[112:115], v[136:139]
  v_mfma_f32_16x16x32_bf16 v[140:143], v[108:111], v[116:119], v[140:143]
  s_waitcnt lgkmcnt(0)
  s_barrier
  ds_read_b128 v[80:83], v8 offset:0
  ds_read_b128 v[84:87], v8 offset:2048
  ds_read_b128 v[88:91], v8 offset:4096
  ds_read_b128 v[92:95], v14 offset:0
  ds_read_b128 v[96:99], v14 offset:2048
  ds_read_b128 v[100:103], v9 offset:0
  ds_read_b128 v[104:107], v9 offset:2048
  ds_read_b128 v[108:111], v9 offset:4096
  ds_read_b128 v[112:115], v15 offset:0
  ds_read_b128 v[116:119], v15 offset:2048
  v_mfma_f32_16x16x32_bf16 v[120:123], v[40:43], v[52:55], v[120:123]
  v_mfma_f32_16x16x32_bf16 v[124:127], v[40:43], v[56:59], v[124:127]
  v_mfma_f32_16x16x32_bf16 v[128:131], v[44:47], v[52:55], v[128:131]
  v_mfma_f32_16x16x32_bf16 v[132:135], v[44:47], v[56:59], v[132:135]
  v_mfma_f32_16x16x32_bf16 v[136:139], v[48:51], v[52:55], v[136:139]
  v_mfma_f32_16x16x32_bf16 v[140:143], v[48:51], v[56:59], v[140:143]
  v_mfma_f32_16x16x32_bf16 v[120:123], v[60:63], v[72:75], v[120:123]
  v_mfma_f32_16x16x32_bf16 v[124:127], v[60:63], v[76:79], v[124:127]
  v_mfma_f32_16x16x32_bf16 v[128:131], v[64:67], v[72:75], v[128:131]
  v_mfma_f32_16x16x32_bf16 v[132:135], v[64:67], v[76:79], v[132:135]
  v_mfma_f32_16x16x32_bf16 v[136:139], v[68:71], v[72:75], v[136:139]
  v_mfma_f32_16x16x32_bf16 v[140:143], v[68:71], v[76:79], v[140:143]
  s_waitcnt lgkmcnt(0)
  s_barrier
  ds_read_b128 v[40:43], v8 offset:20480
  ds_read_b128 v[44:47], v8 offset:22528
  ds_read_b128 v[48:51], v8 offset:24576
  ds_read_b128 v[52:55], v14 offset:20480
  ds_read_b128 v[56:59], v14 offset:22528
  ds_read_b128 v[60:63], v9 offset:20480
  ds_read_b128 v[64:67], v9 offset:22528
  ds_read_b128 v[68:71], v9 offset:24576
  ds_read_b128 v[72:75], v15 offset:20480
  ds_read_b128 v[76:79], v15 offset:22528
  v_mfma_f32_16x16x32_bf16 v[120:123], v[80:83], v[92:95], v[120:123]
  v_mfma_f32_16x16x32_bf16 v[124:127], v[80:83], v[96:99], v[124:127]
  v_mfma_f32_16x16x32_bf16 v[128:131], v[84:87], v[92:95], v[128:131]
  v_mfma_f32_16x16x32_bf16 v[132:135], v[84:87], v[96:99], v[132:135]
  v_mfma_f32_16x16x32_bf16 v[136:139], v[88:91], v[92:95], v[136:139]
  v_mfma_f32_16x16x32_bf16 v[140:143], v[88:91], v[96:99], v[140:143]
  v_mfma_f32_16x16x32_bf16 v[120:123], v[100:103], v[112:115], v[120:123]
  v_mfma_f32_16x16x32_bf16 v[124:127], v[100:103], v[116:119], v[124:127]
  v_mfma_f32_16x16x32_bf16 v[128:131], v[104:107], v[112:115], v[128:131]
  v_mfma_f32_16x16x32_bf16 v[132:135], v[104:107], v[116:119], v[132:135]
  v_mfma_f32_16x16x32_bf16 v[136:139], v[108:111], v[112:115], v[136:139]
  v_mfma_f32_16x16x32_bf16 v[140:143], v[108:111], v[116:119], v[140:143]
  s_waitcnt lgkmcnt(0)
  s_barrier
  ds_read_b128 v[80:83], v8 offset:40960
  ds_read_b128 v[84:87], v8 offset:43008
  ds_read_b128 v[88:91], v8 offset:45056
  ds_read_b128 v[92:95], v14 offset:40960
  ds_read_b128 v[96:99], v14 offset:43008
  ds_read_b128 v[100:103], v9 offset:40960
  ds_read_b128 v[104:107], v9 offset:43008
  ds_read_b128 v[108:111], v9 offset:45056
  ds_read_b128 v[112:115], v15 offset:40960
  ds_read_b128 v[116:119], v15 offset:43008
  v_mfma_f32_16x16x32_bf16 v[120:123], v[40:43], v[52:55], v[120:123]
  v_mfma_f32_16x16x32_bf16 v[124:127], v[40:43], v[56:59], v[124:127]
  v_mfma_f32_16x16x32_bf16 v[128:131], v[44:47], v[52:55], v[128:131]
  v_mfma_f32_16x16x32_bf16 v[132:135], v[44:47], v[56:59], v[132:135]
  v_mfma_f32_16x16x32_bf16 v[136:139], v[48:51], v[52:55], v[136:139]
  v_mfma_f32_16x16x32_bf16 v[140:143], v[48:51], v[56:59], v[140:143]
  v_mfma_f32_16x16x32_bf16 v[120:123], v[60:63], v[72:75], v[120:123]
  v_mfma_f32_16x16x32_bf16 v[124:127], v[60:63], v[76:79], v[124:127]
  v_mfma_f32_16x16x32_bf16 v[128:131], v[64:67], v[72:75], v[128:131]
  v_mfma_f32_16x16x32_bf16 v[132:135], v[64:67], v[76:79], v[132:135]
  v_mfma_f32_16x16x32_bf16 v[136:139], v[68:71], v[72:75], v[136:139]
  v_mfma_f32_16x16x32_bf16 v[140:143], v[68:71], v[76:79], v[140:143]
  s_waitcnt lgkmcnt(0)
  s_barrier
  ds_read_b128 v[40:43], v8 offset:61440
  ds_read_b128 v[44:47], v8 offset:63488
  ds_read_b128 v[48:51], v10 offset:0
  ds_read_b128 v[52:55], v14 offset:61440
  ds_read_b128 v[56:59], v14 offset:63488
  ds_read_b128 v[60:63], v9 offset:61440
  ds_read_b128 v[64:67], v9 offset:63488
  ds_read_b128 v[68:71], v11 offset:0
  ds_read_b128 v[72:75], v15 offset:61440
  ds_read_b128 v[76:79], v15 offset:63488
  v_mfma_f32_16x16x32_bf16 v[120:123], v[80:83], v[92:95], v[120:123]
  v_mfma_f32_16x16x32_bf16 v[124:127], v[80:83], v[96:99], v[124:127]
  v_mfma_f32_16x16x32_bf16 v[128:131], v[84:87], v[92:95], v[128:131]
  v_mfma_f32_16x16x32_bf16 v[132:135], v[84:87], v[96:99], v[132:135]
  v_mfma_f32_16x16x32_bf16 v[136:139], v[88:91], v[92:95], v[136:139]
  v_mfma_f32_16x16x32_bf16 v[140:143], v[88:91], v[96:99], v[140:143]
  v_mfma_f32_16x16x32_bf16 v[120:123], v[100:103], v[112:115], v[120:123]
  v_mfma_f32_16x16x32_bf16 v[124:127], v[100:103], v[116:119], v[124:127]
  v_mfma_f32_16x16x32_bf16 v[128:131], v[104:107], v[112:115], v[128:131]
  v_mfma_f32_16x16x32_bf16 v[132:135], v[104:107], v[116:119], v[132:135]
  v_mfma_f32_16x16x32_bf16 v[136:139], v[108:111], v[112:115], v[136:139]
  v_mfma_f32_16x16x32_bf16 v[140:143], v[108:111], v[116:119], v[140:143]
  s_waitcnt lgkmcnt(0)
  s_barrier
  ds_read_b128 v[80:83], v10 offset:16384
  ds_read_b128 v[84:87], v10 offset:18432
  ds_read_b128 v[88:91], v10 offset:20480
  ds_read_b128 v[92:95], v16 offset:16384
  ds_read_b128 v[96:99], v16 offset:18432
  ds_read_b128 v[100:103], v11 offset:16384
  ds_read_b128 v[104:107], v11 offset:18432
  ds_read_b128 v[108:111], v11 offset:20480
  ds_read_b128 v[112:115], v17 offset:16384
  ds_read_b128 v[116:119], v17 offset:18432
  v_mfma_f32_16x16x32_bf16 v[120:123], v[40:43], v[52:55], v[120:123]
  v_mfma_f32_16x16x32_bf16 v[124:127], v[40:43], v[56:59], v[124:127]
  v_mfma_f32_16x16x32_bf16 v[128:131], v[44:47], v[52:55], v[128:131]
  v_mfma_f32_16x16x32_bf16 v[132:135], v[44:47], v[56:59], v[132:135]
  v_mfma_f32_16x16x32_bf16 v[136:139], v[48:51], v[52:55], v[136:139]
  v_mfma_f32_16x16x32_bf16 v[140:143], v[48:51], v[56:59], v[140:143]
  v_mfma_f32_16x16x32_bf16 v[120:123], v[60:63], v[72:75], v[120:123]
  v_mfma_f32_16x16x32_bf16 v[124:127], v[60:63], v[76:79], v[124:127]
  v_mfma_f32_16x16x32_bf16 v[128:131], v[64:67], v[72:75], v[128:131]
  v_mfma_f32_16x16x32_bf16 v[132:135], v[64:67], v[76:79], v[132:135]
  v_mfma_f32_16x16x32_bf16 v[136:139], v[68:71], v[72:75], v[136:139]
  v_mfma_f32_16x16x32_bf16 v[140:143], v[68:71], v[76:79], v[140:143]
  s_waitcnt lgkmcnt(0)
  s_barrier
  ds_read_b128 v[40:43], v10 offset:36864
  ds_read_b128 v[44:47], v10 offset:38912
  ds_read_b128 v[48:51], v10 offset:40960
  ds_read_b128 v[52:55], v16 offset:36864
  ds_read_b128 v[56:59], v16 offset:38912
  ds_read_b128 v[60:63], v11 offset:36864
  ds_read_b128 v[64:67], v11 offset:38912
  ds_read_b128 v[68:71], v11 offset:40960
  ds_read_b128 v[72:75], v17 offset:36864
  ds_read_b128 v[76:79], v17 offset:38912
  v_mfma_f32_16x16x32_bf16 v[120:123], v[80:83], v[92:95], v[120:123]
  v_mfma_f32_16x16x32_bf16 v[124:127], v[80:83], v[96:99], v[124:127]
  v_mfma_f32_16x16x32_bf16 v[128:131], v[84:87], v[92:95], v[128:131]
  v_mfma_f32_16x16x32_bf16 v[132:135], v[84:87], v[96:99], v[132:135]
  v_mfma_f32_16x16x32_bf16 v[136:139], v[88:91], v[92:95], v[136:139]
  v_mfma_f32_16x16x32_bf16 v[140:143], v[88:91], v[96:99], v[140:143]
  v_mfma_f32_16x16x32_bf16 v[120:123], v[100:103], v[112:115], v[120:123]
  v_mfma_f32_16x16x32_bf16 v[124:127], v[100:103], v[116:119], v[124:127]
  v_mfma_f32_16x16x32_bf16 v[128:131], v[104:107], v[112:115], v[128:131]
  v_mfma_f32_16x16x32_bf16 v[132:135], v[104:107], v[116:119], v[132:135]
  v_mfma_f32_16x16x32_bf16 v[136:139], v[108:111], v[112:115], v[136:139]
  v_mfma_f32_16x16x32_bf16 v[140:143], v[108:111], v[116:119], v[140:143]
  s_waitcnt lgkmcnt(0)
  s_barrier
  ds_read_b128 v[80:83], v10 offset:57344
  ds_read_b128 v[84:87], v10 offset:59392
  ds_read_b128 v[88:91], v10 offset:61440
  ds_read_b128 v[92:95], v16 offset:57344
  ds_read_b128 v[96:99], v16 offset:59392
  ds_read_b128 v[100:103], v11 offset:57344
  ds_read_b128 v[104:107], v11 offset:59392
  ds_read_b128 v[108:111], v11 offset:61440
  ds_read_b128 v[112:115], v17 offset:57344
  ds_read_b128 v[116:119], v17 offset:59392
  v_mfma_f32_16x16x32_bf16 v[120:123], v[40:43], v[52:55], v[120:123]
  v_mfma_f32_16x16x32_bf16 v[124:127], v[40:43], v[56:59], v[124:127]
  v_mfma_f32_16x16x32_bf16 v[128:131], v[44:47], v[52:55], v[128:131]
  v_mfma_f32_16x16x32_bf16 v[132:135], v[44:47], v[56:59], v[132:135]
  v_mfma_f32_16x16x32_bf16 v[136:139], v[48:51], v[52:55], v[136:139]
  v_mfma_f32_16x16x32_bf16 v[140:143], v[48:51], v[56:59], v[140:143]
  v_mfma_f32_16x16x32_bf16 v[120:123], v[60:63], v[72:75], v[120:123]
  v_mfma_f32_16x16x32_bf16 v[124:127], v[60:63], v[76:79], v[124:127]
  v_mfma_f32_16x16x32_bf16 v[128:131], v[64:67], v[72:75], v[128:131]
  v_mfma_f32_16x16x32_bf16 v[132:135], v[64:67], v[76:79], v[132:135]
  v_mfma_f32_16x16x32_bf16 v[136:139], v[68:71], v[72:75], v[136:139]
  v_mfma_f32_16x16x32_bf16 v[140:143], v[68:71], v[76:79], v[140:143]
  s_waitcnt lgkmcnt(0)
  s_barrier
  ds_read_b128 v[40:43], v8 offset:0
  ds_read_b128 v[44:47], v8 offset:2048
  ds_read_b128 v[48:51], v8 offset:4096
  ds_read_b128 v[52:55], v14 offset:0
  ds_read_b128 v[56:59], v14 offset:2048
  ds_read_b128 v[60:63], v9 offset:0
  ds_read_b128 v[64:67], v9 offset:2048
  ds_read_b128 v[68:71], v9 offset:4096
  ds_read_b128 v[72:75], v15 offset:0
  ds_read_b128 v[76:79], v15 offset:2048
  v_mfma_f32_16x16x32_bf16 v[120:123], v[80:83], v[92:95], v[120:123]
  v_mfma_f32_16x16x32_bf16 v[124:127], v[80:83], v[96:99], v[124:127]
  v_mfma_f32_16x16x32_bf16 v[128:131], v[84:87], v[92:95], v[128:131]
  v_mfma_f32_16x16x32_bf16 v[132:135], v[84:87], v[96:99], v[132:135]
  v_mfma_f32_16x16x32_bf16 v[136:139], v[88:91], v[92:95], v[136:139]
  v_mfma_f32_16x16x32_bf16 v[140:143], v[88:91], v[96:99], v[140:143]
  v_mfma_f32_16x16x32_bf16 v[120:123], v[100:103], v[112:115], v[120:123]
  v_mfma_f32_16x16x32_bf16 v[124:127], v[100:103], v[116:119], v[124:127]
  v_mfma_f32_16x16x32_bf16 v[128:131], v[104:107], v[112:115], v[128:131]
  v_mfma_f32_16x16x32_bf16 v[132:135], v[104:107], v[116:119], v[132:135]
  v_mfma_f32_16x16x32_bf16 v[136:139], v[108:111], v[112:115], v[136:139]
  v_mfma_f32_16x16x32_bf16 v[140:143], v[108:111], v[116:119], v[140:143]
  s_waitcnt lgkmcnt(0)
  s_barrier
  ds_read_b128 v[80:83], v8 offset:20480
  ds_read_b128 v[84:87], v8 offset:22528
  ds_read_b128 v[88:91], v8 offset:24576
  ds_read_b128 v[92:95], v14 offset:20480
  ds_read_b128 v[96:99], v14 offset:22528
  ds_read_b128 v[100:103], v9 offset:20480
  ds_read_b128 v[104:107], v9 offset:22528
  ds_read_b128 v[108:111], v9 offset:24576
  ds_read_b128 v[112:115], v15 offset:20480
  ds_read_b128 v[116:119], v15 offset:22528
  v_mfma_f32_16x16x32_bf16 v[120:123], v[40:43], v[52:55], v[120:123]
  v_mfma_f32_16x16x32_bf16 v[124:127], v[40:43], v[56:59], v[124:127]
  v_mfma_f32_16x16x32_bf16 v[128:131], v[44:47], v[52:55], v[128:131]
  v_mfma_f32_16x16x32_bf16 v[132:135], v[44:47], v[56:59], v[132:135]
  v_mfma_f32_16x16x32_bf16 v[136:139], v[48:51], v[52:55], v[136:139]
  v_mfma_f32_16x16x32_bf16 v[140:143], v[48:51], v[56:59], v[140:143]
  v_mfma_f32_16x16x32_bf16 v[120:123], v[60:63], v[72:75], v[120:123]
  v_mfma_f32_16x16x32_bf16 v[124:127], v[60:63], v[76:79], v[124:127]
  v_mfma_f32_16x16x32_bf16 v[128:131], v[64:67], v[72:75], v[128:131]
  v_mfma_f32_16x16x32_bf16 v[132:135], v[64:67], v[76:79], v[132:135]
  v_mfma_f32_16x16x32_bf16 v[136:139], v[68:71], v[72:75], v[136:139]
  v_mfma_f32_16x16x32_bf16 v[140:143], v[68:71], v[76:79], v[140:143]
  s_waitcnt lgkmcnt(0)
  s_barrier
  ds_read_b128 v[40:43], v8 offset:40960
  ds_read_b128 v[44:47], v8 offset:43008
  ds_read_b128 v[48:51], v8 offset:45056
  ds_read_b128 v[52:55], v14 offset:40960
  ds_read_b128 v[56:59], v14 offset:43008
  ds_read_b128 v[60:63], v9 offset:40960
  ds_read_b128 v[64:67], v9 offset:43008
  ds_read_b128 v[68:71], v9 offset:45056
  ds_read_b128 v[72:75], v15 offset:40960
  ds_read_b128 v[76:79], v15 offset:43008
  v_mfma_f32_16x16x32_bf16 v[120:123], v[80:83], v[92:95], v[120:123]
  v_mfma_f32_16x16x32_bf16 v[124:127], v[80:83], v[96:99], v[124:127]
  v_mfma_f32_16x16x32_bf16 v[128:131], v[84:87], v[92:95], v[128:131]
  v_mfma_f32_16x16x32_bf16 v[132:135], v[84:87], v[96:99], v[132:135]
  v_mfma_f32_16x16x32_bf16 v[136:139], v[88:91], v[92:95], v[136:139]
  v_mfma_f32_16x16x32_bf16 v[140:143], v[88:91], v[96:99], v[140:143]
  v_mfma_f32_16x16x32_bf16 v[120:123], v[100:103], v[112:115], v[120:123]
  v_mfma_f32_16x16x32_bf16 v[124:127], v[100:103], v[116:119], v[124:127]
  v_mfma_f32_16x16x32_bf16 v[128:131], v[104:107], v[112:115], v[128:131]
  v_mfma_f32_16x16x32_bf16 v[132:135], v[104:107], v[116:119], v[132:135]
  v_mfma_f32_16x16x32_bf16 v[136:139], v[108:111], v[112:115], v[136:139]
  v_mfma_f32_16x16x32_bf16 v[140:143], v[108:111], v[116:119], v[140:143]
  s_waitcnt lgkmcnt(0)
  s_barrier
  ds_read_b128 v[80:83], v8 offset:61440
  ds_read_b128 v[84:87], v8 offset:63488
  ds_read_b128 v[88:91], v10 offset:0
  ds_read_b128 v[92:95], v14 offset:61440
  ds_read_b128 v[96:99], v14 offset:63488
  ds_read_b128 v[100:103], v9 offset:61440
  ds_read_b128 v[104:107], v9 offset:63488
  ds_read_b128 v[108:111], v11 offset:0
  ds_read_b128 v[112:115], v15 offset:61440
  ds_read_b128 v[116:119], v15 offset:63488
  v_mfma_f32_16x16x32_bf16 v[120:123], v[40:43], v[52:55], v[120:123]
  v_mfma_f32_16x16x32_bf16 v[124:127], v[40:43], v[56:59], v[124:127]
  v_mfma_f32_16x16x32_bf16 v[128:131], v[44:47], v[52:55], v[128:131]
  v_mfma_f32_16x16x32_bf16 v[132:135], v[44:47], v[56:59], v[132:135]
  v_mfma_f32_16x16x32_bf16 v[136:139], v[48:51], v[52:55], v[136:139]
  v_mfma_f32_16x16x32_bf16 v[140:143], v[48:51], v[56:59], v[140:143]
  v_mfma_f32_16x16x32_bf16 v[120:123], v[60:63], v[72:75], v[120:123]
  v_mfma_f32_16x16x32_bf16 v[124:127], v[60:63], v[76:79], v[124:127]
  v_mfma_f32_16x16x32_bf16 v[128:131], v[64:67], v[72:75], v[128:131]
  v_mfma_f32_16x16x32_bf16 v[132:135], v[64:67], v[76:79], v[132:135]
  v_mfma_f32_16x16x32_bf16 v[136:139], v[68:71], v[72:75], v[136:139]
  v_mfma_f32_16x16x32_bf16 v[140:143], v[68:71], v[76:79], v[140:143]
  s_waitcnt lgkmcnt(0)
  v_mfma_f32_16x16x32_bf16 v[120:123], v[80:83], v[92:95], v[120:123]
  v_mfma_f32_16x16x32_bf16 v[124:127], v[80:83], v[96:99], v[124:127]
  v_mfma_f32_16x16x32_bf16 v[128:131], v[84:87], v[92:95], v[128:131]
  v_mfma_f32_16x16x32_bf16 v[132:135], v[84:87], v[96:99], v[132:135]
  v_mfma_f32_16x16x32_bf16 v[136:139], v[88:91], v[92:95], v[136:139]
  v_mfma_f32_16x16x32_bf16 v[140:143], v[88:91], v[96:99], v[140:143]
  v_mfma_f32_16x16x32_bf16 v[120:123], v[100:103], v[112:115], v[120:123]
  v_mfma_f32_16x16x32_bf16 v[124:127], v[100:103], v[116:119], v[124:127]
  v_mfma_f32_16x16x32_bf16 v[128:131], v[104:107], v[112:115], v[128:131]
  v_mfma_f32_16x16x32_bf16 v[132:135], v[104:107], v[116:119], v[132:135]
  v_mfma_f32_16x16x32_bf16 v[136:139], v[108:111], v[112:115], v[136:139]
  v_mfma_f32_16x16x32_bf16 v[140:143], v[108:111], v[116:119], v[140:143]
  s_branch Ljn_26
Lld_25:
  s_waitcnt vmcnt(29)
  s_barrier
  s_add_u32 m0, s64, 122880
  s_nop 0
  buffer_load_dwordx4 v24, s[44:47], s8 offen lds
  s_add_u32 m0, s65, 122880
  s_nop 0
  buffer_load_dwordx4 v25, s[44:47], s8 offen lds
  s_add_u32 m0, s66, 122880
  s_nop 0
  buffer_load_dwordx4 v26, s[44:47], s8 offen lds
  s_add_u32 m0, s67, 122880
  s_nop 0
  buffer_load_dwordx4 v27, s[48:51], s9 offen  lds
  s_add_u32 m0, s68, 122880
  s_nop 0
  buffer_load_dwordx4 v28, s[48:51], s9 offen  lds
  s_add_u32 s8, s8, 128
  s_add_u32 s9, s9, 128
  s_waitcnt vmcnt(25)
  s_barrier
  s_add_u32 m0, s64, 0
  s_nop 0
  buffer_load_dwordx4 v24, s[44:47], s8 offen lds
  s_add_u32 m0, s65, 0
  s_nop 0
  buffer_load_dwordx4 v25, s[44:47], s8 offen lds
  s_add_u32 m0, s66, 0
  s_nop 0
  buffer_load_dwordx4 v26, s[44:47], s8 offen lds
  s_add_u32 m0, s67, 0
  s_nop 0
  buffer_load_dwordx4 v27, s[48:51], s9 offen  lds
  s_add_u32 m0, s68, 0
  s_nop 0
  buffer_load_dwordx4 v28, s[48:51], s9 offen  lds
  s_add_u32 s8, s8, 128
  s_add_u32 s9, s9, 128
  s_waitcnt vmcnt(25)
  s_barrier
  s_add_u32 m0, s64, 20480
  s_nop 0
  buffer_load_dwordx4 v24, s[44:47], s8 offen lds
  s_add_u32 m0, s65, 20480
  s_nop 0
  buffer_load_dwordx4 v25, s[44:47], s8 offen lds
  s_add_u32 m0, s66, 20480
  s_nop 0
  buffer_load_dwordx4 v26, s[44:47], s8 offen lds
  s_add_u32 m0, s67, 20480
  s_nop 0
  buffer_load_dwordx4 v27, s[48:51], s9 offen  lds
  s_add_u32 m0, s68, 20480
  s_nop 0
  buffer_load_dwordx4 v28, s[48:51], s9 offen  lds
  s_add_u32 s8, s8, 128
  s_add_u32 s9, s9, 128
  s_waitcnt vmcnt(25)
  s_barrier
  s_add_u32 m0, s64, 40960
  s_nop 0
  buffer_load_dwordx4 v24, s[44:47], s8 offen lds
  s_add_u32 m0, s65, 40960
  s_nop 0
  buffer_load_dwordx4 v25, s[44:47], s8 offen lds
  s_add_u32 m0, s66, 40960
  s_nop 0
  buffer_load_dwordx4 v26, s[44:47], s8 offen lds
  s_add_u32 m0, s67, 40960
  s_nop 0
  buffer_load_dwordx4 v27, s[48:51], s9 offen  lds
  s_add_u32 m0, s68, 40960
  s_nop 0
  buffer_load_dwordx4 v28, s[48:51], s9 offen  lds
  s_add_u32 s8, s8, 128
  s_add_u32 s9, s9, 128
  s_waitcnt vmcnt(25)
  s_barrier
  s_add_u32 m0, s64, 61440
  s_nop 0
  buffer_load_dwordx4 v24, s[44:47], s8 offen lds
  s_add_u32 m0, s65, 61440
  s_nop 0
  buffer_load_dwordx4 v25, s[44:47], s8 offen lds
  s_add_u32 m0, s66, 61440
  s_nop 0
  buffer_load_dwordx4 v26, s[44:47], s8 offen lds
  s_add_u32 m0, s67, 61440
  s_nop 0
  buffer_load_dwordx4 v27, s[48:51], s9 offen  lds
  s_add_u32 m0, s68, 61440
  s_nop 0
  buffer_load_dwordx4 v28, s[48:51], s9 offen  lds
  s_add_u32 s8, s8, 128
  s_add_u32 s9, s9, 128
  s_waitcnt vmcnt(25)
  s_barrier
  s_add_u32 m0, s64, 81920
  s_nop 0
  buffer_load_dwordx4 v24, s[44:47], s8 offen lds
  s_add_u32 m0, s65, 81920
  s_nop 0
  buffer_load_dwordx4 v25, s[44:47], s8 offen lds
  s_add_u32 m0, s66, 81920
  s_nop 0
  buffer_load_dwordx4 v26, s[44:47], s8 offen lds
  s_add_u32 m0, s67, 81920
  s_nop 0
  buffer_load_dwordx4 v27, s[48:51], s9 offen  lds
  s_add_u32 m0, s68, 81920
  s_nop 0
  buffer_load_dwordx4 v28, s[48:51], s9 offen  lds
  s_add_u32 s8, s8, 128
  s_add_u32 s9, s9, 128
  s_waitcnt vmcnt(25)
  s_barrier
  s_add_u32 m0, s64, 102400
  s_nop 0
  buffer_load_dwordx4 v24, s[44:47], s8 offen lds
  s_add_u32 m0, s65, 102400
  s_nop 0
  buffer_load_dwordx4 v25, s[44:47], s8 offen lds
  s_add_u32 m0, s66, 102400
  s_nop 0
  buffer_load_dwordx4 v26, s[44:47], s8 offen lds
  s_add_u32 m0, s67, 102400
  s_nop 0
  buffer_load_dwordx4 v27, s[48:51], s9 offen  lds
  s_add_u32 m0, s68, 102400
  s_nop 0
  buffer_load_dwordx4 v28, s[48:51], s9 offen  lds
  s_add_u32 s8, s8, 128
  s_add_u32 s9, s9, 128
  s_waitcnt vmcnt(25)
  s_barrier
  s_add_u32 m0, s64, 122880
  s_nop 0
  buffer_load_dwordx4 v24, s[44:47], s8 offen lds
  s_add_u32 m0, s65, 122880
  s_nop 0
  buffer_load_dwordx4 v25, s[44:47], s8 offen lds
  s_add_u32 m0, s66, 122880
  s_nop 0
  buffer_load_dwordx4 v26, s[44:47], s8 offen lds
  s_add_u32 m0, s67, 122880
  s_nop 0
  buffer_load_dwordx4 v27, s[48:51], s9 offen  lds
  s_add_u32 m0, s68, 122880
  s_nop 0
  buffer_load_dwordx4 v28, s[48:51], s9 offen  lds
  s_add_u32 s8, s8, 128
  s_add_u32 s9, s9, 128
  s_waitcnt vmcnt(25)
  s_barrier
  s_add_u32 m0, s64, 0
  s_nop 0
  buffer_load_dwordx4 v24, s[44:47], s8 offen lds
  s_add_u32 m0, s65, 0
  s_nop 0
  buffer_load_dwordx4 v25, s[44:47], s8 offen lds
  s_add_u32 m0, s66, 0
  s_nop 0
  buffer_load_dwordx4 v26, s[44:47], s8 offen lds
  s_add_u32 m0, s67, 0
  s_nop 0
  buffer_load_dwordx4 v27, s[48:51], s9 offen  lds
  s_add_u32 m0, s68, 0
  s_nop 0
  buffer_load_dwordx4 v28, s[48:51], s9 offen  lds
  s_add_u32 s8, s8, 128
  s_add_u32 s9, s9, 128
  s_waitcnt vmcnt(25)
  s_barrier
  s_add_u32 m0, s64, 20480
  s_nop 0
  buffer_load_dwordx4 v24, s[44:47], s8 offen lds
  s_add_u32 m0, s65, 20480
  s_nop 0
  buffer_load_dwordx4 v25, s[44:47], s8 offen lds
  s_add_u32 m0, s66, 20480
  s_nop 0
  buffer_load_dwordx4 v26, s[44:47], s8 offen lds
  s_add_u32 m0, s67, 20480
  s_nop 0
  buffer_load_dwordx4 v27, s[48:51], s9 offen  lds
  s_add_u32 m0, s68, 20480
  s_nop 0
  buffer_load_dwordx4 v28, s[48:51], s9 offen  lds
  s_add_u32 s8, s8, 128
  s_add_u32 s9, s9, 128
  s_waitcnt vmcnt(25)
  s_barrier
  s_add_u32 m0, s64, 40960
  s_nop 0
  buffer_load_dwordx4 v24, s[44:47], s8 offen lds
  s_add_u32 m0, s65, 40960
  s_nop 0
  buffer_load_dwordx4 v25, s[44:47], s8 offen lds
  s_add_u32 m0, s66, 40960
  s_nop 0
  buffer_load_dwordx4 v26, s[44:47], s8 offen lds
  s_add_u32 m0, s67, 40960
  s_nop 0
  buffer_load_dwordx4 v27, s[48:51], s9 offen  lds
  s_add_u32 m0, s68, 40960
  s_nop 0
  buffer_load_dwordx4 v28, s[48:51], s9 offen  lds
  s_add_u32 s8, s8, 128
  s_add_u32 s9, s9, 128
  s_waitcnt vmcnt(25)
  s_barrier
  s_add_u32 m0, s64, 61440
  s_nop 0
  buffer_load_dwordx4 v24, s[44:47], s8 offen lds
  s_add_u32 m0, s65, 61440
  s_nop 0
  buffer_load_dwordx4 v25, s[44:47], s8 offen lds
  s_add_u32 m0, s66, 61440
  s_nop 0
  buffer_load_dwordx4 v26, s[44:47], s8 offen lds
  s_add_u32 m0, s67, 61440
  s_nop 0
  buffer_load_dwordx4 v27, s[48:51], s9 offen  lds
  s_add_u32 m0, s68, 61440
  s_nop 0
  buffer_load_dwordx4 v28, s[48:51], s9 offen  lds
  s_add_u32 s8, s8, 128
  s_add_u32 s9, s9, 128
  s_waitcnt vmcnt(25)
  s_barrier
  s_add_u32 m0, s64, 81920
  s_nop 0
  buffer_load_dwordx4 v24, s[44:47], s8 offen lds
  s_add_u32 m0, s65, 81920
  s_nop 0
  buffer_load_dwordx4 v25, s[44:47], s8 offen lds
  s_add_u32 m0, s66, 81920
  s_nop 0
  buffer_load_dwordx4 v26, s[44:47], s8 offen lds
  s_add_u32 m0, s67, 81920
  s_nop 0
  buffer_load_dwordx4 v27, s[48:51], s9 offen  lds
  s_add_u32 m0, s68, 81920
  s_nop 0
  buffer_load_dwordx4 v28, s[48:51], s9 offen  lds
  s_add_u32 s8, s8, 128
  s_add_u32 s9, s9, 128
  s_waitcnt vmcnt(25)
  s_barrier
  s_add_u32 m0, s64, 102400
  s_nop 0
  buffer_load_dwordx4 v24, s[44:47], s8 offen lds
  s_add_u32 m0, s65, 102400
  s_nop 0
  buffer_load_dwordx4 v25, s[44:47], s8 offen lds
  s_add_u32 m0, s66, 102400
  s_nop 0
  buffer_load_dwordx4 v26, s[44:47], s8 offen lds
  s_add_u32 m0, s67, 102400
  s_nop 0
  buffer_load_dwordx4 v27, s[48:51], s9 offen  lds
  s_add_u32 m0, s68, 102400
  s_nop 0
  buffer_load_dwordx4 v28, s[48:51], s9 offen  lds
  s_add_u32 s8, s8, 128
  s_add_u32 s9, s9, 128
  s_waitcnt vmcnt(25)
  s_barrier
  s_add_u32 m0, s64, 122880
  s_nop 0
  buffer_load_dwordx4 v24, s[44:47], s8 offen lds
  s_add_u32 m0, s65, 122880
  s_nop 0
  buffer_load_dwordx4 v25, s[44:47], s8 offen lds
  s_add_u32 m0, s66, 122880
  s_nop 0
  buffer_load_dwordx4 v26, s[44:47], s8 offen lds
  s_add_u32 m0, s67, 122880
  s_nop 0
  buffer_load_dwordx4 v27, s[48:51], s9 offen  lds
  s_add_u32 m0, s68, 122880
  s_nop 0
  buffer_load_dwordx4 v28, s[48:51], s9 offen  lds
  s_add_u32 s8, s8, 128
  s_add_u32 s9, s9, 128
  s_waitcnt vmcnt(25)
  s_barrier
  s_add_u32 m0, s64, 0
  s_nop 0
  buffer_load_dwordx4 v24, s[44:47], s8 offen lds
  s_add_u32 m0, s65, 0
  s_nop 0
  buffer_load_dwordx4 v25, s[44:47], s8 offen lds
  s_add_u32 m0, s66, 0
  s_nop 0
  buffer_load_dwordx4 v26, s[44:47], s8 offen lds
  s_add_u32 m0, s67, 0
  s_nop 0
  buffer_load_dwordx4 v27, s[48:51], s9 offen  lds
  s_add_u32 m0, s68, 0
  s_nop 0
  buffer_load_dwordx4 v28, s[48:51], s9 offen  lds
  s_add_u32 s8, s8, 128
  s_add_u32 s9, s9, 128
  s_waitcnt vmcnt(25)
  s_barrier
  s_add_u32 m0, s64, 20480
  s_nop 0
  buffer_load_dwordx4 v24, s[44:47], s8 offen lds
  s_add_u32 m0, s65, 20480
  s_nop 0
  buffer_load_dwordx4 v25, s[44:47], s8 offen lds
  s_add_u32 m0, s66, 20480
  s_nop 0
  buffer_load_dwordx4 v26, s[44:47], s8 offen lds
  s_add_u32 m0, s67, 20480
  s_nop 0
  buffer_load_dwordx4 v27, s[48:51], s9 offen  lds
  s_add_u32 m0, s68, 20480
  s_nop 0
  buffer_load_dwordx4 v28, s[48:51], s9 offen  lds
  s_add_u32 s8, s8, 128
  s_add_u32 s9, s9, 128
  s_waitcnt vmcnt(25)
  s_barrier
  s_add_u32 m0, s64, 40960
  s_nop 0
  buffer_load_dwordx4 v24, s[44:47], s8 offen lds
  s_add_u32 m0, s65, 40960
  s_nop 0
  buffer_load_dwordx4 v25, s[44:47], s8 offen lds
  s_add_u32 m0, s66, 40960
  s_nop 0
  buffer_load_dwordx4 v26, s[44:47], s8 offen lds
  s_add_u32 m0, s67, 40960
  s_nop 0
  buffer_load_dwordx4 v27, s[48:51], s9 offen  lds
  s_add_u32 m0, s68, 40960
  s_nop 0
  buffer_load_dwordx4 v28, s[48:51], s9 offen  lds
  s_add_u32 s8, s8, 128
  s_add_u32 s9, s9, 128
  s_waitcnt vmcnt(25)
  s_barrier
  s_add_u32 m0, s64, 61440
  s_nop 0
  buffer_load_dwordx4 v24, s[44:47], s8 offen lds
  s_add_u32 m0, s65, 61440
  s_nop 0
  buffer_load_dwordx4 v25, s[44:47], s8 offen lds
  s_add_u32 m0, s66, 61440
  s_nop 0
  buffer_load_dwordx4 v26, s[44:47], s8 offen lds
  s_add_u32 m0, s67, 61440
  s_nop 0
  buffer_load_dwordx4 v27, s[48:51], s9 offen  lds
  s_add_u32 m0, s68, 61440
  s_nop 0
  buffer_load_dwordx4 v28, s[48:51], s9 offen  lds
  s_add_u32 s8, s8, 128
  s_add_u32 s9, s9, 128
  s_waitcnt vmcnt(25)
  s_barrier
  s_add_u32 m0, s64, 81920
  s_nop 0
  buffer_load_dwordx4 v24, s[44:47], s8 offen lds
  s_add_u32 m0, s65, 81920
  s_nop 0
  buffer_load_dwordx4 v25, s[44:47], s8 offen lds
  s_add_u32 m0, s66, 81920
  s_nop 0
  buffer_load_dwordx4 v26, s[44:47], s8 offen lds
  s_add_u32 m0, s67, 81920
  s_nop 0
  buffer_load_dwordx4 v27, s[48:51], s9 offen  lds
  s_add_u32 m0, s68, 81920
  s_nop 0
  buffer_load_dwordx4 v28, s[48:51], s9 offen  lds
  s_add_u32 s8, s8, 128
  s_add_u32 s9, s9, 128
  s_waitcnt vmcnt(25)
  s_barrier
  s_add_u32 m0, s64, 102400
  s_nop 0
  buffer_load_dwordx4 v24, s[44:47], s8 offen lds
  s_add_u32 m0, s65, 102400
  s_nop 0
  buffer_load_dwordx4 v25, s[44:47], s8 offen lds
  s_add_u32 m0, s66, 102400
  s_nop 0
  buffer_load_dwordx4 v26, s[44:47], s8 offen lds
  s_add_u32 m0, s67, 102400
  s_nop 0
  buffer_load_dwordx4 v27, s[48:51], s9 offen  lds
  s_add_u32 m0, s68, 102400
  s_nop 0
  buffer_load_dwordx4 v28, s[48:51], s9 offen  lds
  s_add_u32 s8, s8, 128
  s_add_u32 s9, s9, 128
  s_waitcnt vmcnt(25)
  s_barrier
  s_add_u32 m0, s64, 122880
  s_nop 0
  buffer_load_dwordx4 v24, s[44:47], s8 offen lds
  s_add_u32 m0, s65, 122880
  s_nop 0
  buffer_load_dwordx4 v25, s[44:47], s8 offen lds
  s_add_u32 m0, s66, 122880
  s_nop 0
  buffer_load_dwordx4 v26, s[44:47], s8 offen lds
  s_add_u32 m0, s67, 122880
  s_nop 0
  buffer_load_dwordx4 v27, s[48:51], s9 offen  lds
  s_add_u32 m0, s68, 122880
  s_nop 0
  buffer_load_dwordx4 v28, s[48:51], s9 offen  lds
  s_add_u32 s8, s8, 128
  s_add_u32 s9, s9, 128
  s_waitcnt vmcnt(25)
  s_barrier
  s_add_u32 m0, s64, 0
  s_nop 0
  buffer_load_dwordx4 v24, s[44:47], s8 offen lds
  s_add_u32 m0, s65, 0
  s_nop 0
  buffer_load_dwordx4 v25, s[44:47], s8 offen lds
  s_add_u32 m0, s66, 0
  s_nop 0
  buffer_load_dwordx4 v26, s[44:47], s8 offen lds
  s_add_u32 m0, s67, 0
  s_nop 0
  buffer_load_dwordx4 v27, s[48:51], s9 offen  lds
  s_add_u32 m0, s68, 0
  s_nop 0
  buffer_load_dwordx4 v28, s[48:51], s9 offen  lds
  s_add_u32 s8, s8, 128
  s_add_u32 s9, s9, 128
  s_waitcnt vmcnt(25)
  s_barrier
  s_add_u32 m0, s64, 20480
  s_nop 0
  buffer_load_dwordx4 v24, s[44:47], s8 offen lds
  s_add_u32 m0, s65, 20480
  s_nop 0
  buffer_load_dwordx4 v25, s[44:47], s8 offen lds
  s_add_u32 m0, s66, 20480
  s_nop 0
  buffer_load_dwordx4 v26, s[44:47], s8 offen lds
  s_add_u32 m0, s67, 20480
  s_nop 0
  buffer_load_dwordx4 v27, s[48:51], s9 offen  lds
  s_add_u32 m0, s68, 20480
  s_nop 0
  buffer_load_dwordx4 v28, s[48:51], s9 offen  lds
  s_add_u32 s8, s8, 128
  s_add_u32 s9, s9, 128
  s_waitcnt vmcnt(25)
  s_barrier
  s_add_u32 m0, s64, 40960
  s_nop 0
  buffer_load_dwordx4 v24, s[44:47], s8 offen lds
  s_add_u32 m0, s65, 40960
  s_nop 0
  buffer_load_dwordx4 v25, s[44:47], s8 offen lds
  s_add_u32 m0, s66, 40960
  s_nop 0
  buffer_load_dwordx4 v26, s[44:47], s8 offen lds
  s_add_u32 m0, s67, 40960
  s_nop 0
  buffer_load_dwordx4 v27, s[48:51], s9 offen  lds
  s_add_u32 m0, s68, 40960
  s_nop 0
  buffer_load_dwordx4 v28, s[48:51], s9 offen  lds
  s_add_u32 s8, s8, 128
  s_add_u32 s9, s9, 128
  s_waitcnt vmcnt(25)
  s_barrier
  s_add_u32 m0, s64, 61440
  s_nop 0
  buffer_load_dwordx4 v24, s[44:47], s8 offen lds
  s_add_u32 m0, s65, 61440
  s_nop 0
  buffer_load_dwordx4 v25, s[44:47], s8 offen lds
  s_add_u32 m0, s66, 61440
  s_nop 0
  buffer_load_dwordx4 v26, s[44:47], s8 offen lds
  s_add_u32 m0, s67, 61440
  s_nop 0
  buffer_load_dwordx4 v27, s[48:51], s9 offen  lds
  s_add_u32 m0, s68, 61440
  s_nop 0
  buffer_load_dwordx4 v28, s[48:51], s9 offen  lds
  s_add_u32 s8, s8, 128
  s_add_u32 s9, s9, 128
  s_waitcnt vmcnt(25)
  s_barrier
  s_waitcnt vmcnt(20)
  s_barrier
  s_waitcnt vmcnt(15)
  s_barrier
  s_waitcnt vmcnt(10)
  s_barrier
  s_waitcnt vmcnt(5)
  s_barrier
  s_waitcnt vmcnt(0)
  s_barrier
Ljn_26:
  s_waitcnt vmcnt(0)
  s_barrier
  s_cmp_lg_u32 s75, 0
  s_cbranch_scc1 Loc_27
  v_lshlrev_b32 v160, 16, v160
  v_lshlrev_b32 v161, 16, v161
  s_nop 3
  v_cvt_pk_bf16_f32 v40, v120, v121
  v_cvt_pk_bf16_f32 v41, v122, v123
  v_cvt_pk_bf16_f32 v42, v124, v125
  v_cvt_pk_bf16_f32 v43, v126, v127
  v_cvt_pk_bf16_f32 v44, v128, v129
  v_cvt_pk_bf16_f32 v45, v130, v131
  v_cvt_pk_bf16_f32 v46, v132, v133
  v_cvt_pk_bf16_f32 v47, v134, v135
  v_cvt_pk_bf16_f32 v48, v136, v137
  v_cvt_pk_bf16_f32 v49, v138, v139
  v_cvt_pk_bf16_f32 v50, v140, v141
  v_cvt_pk_bf16_f32 v51, v142, v143
  v_lshlrev_b32 v120, 16, v40
  v_and_b32 v121, 0xffff0000, v40
  v_lshlrev_b32 v122, 16, v41
  v_and_b32 v123, 0xffff0000, v41
  v_lshlrev_b32 v124, 16, v42
  v_and_b32 v125, 0xffff0000, v42
  v_lshlrev_b32 v126, 16, v43
  v_and_b32 v127, 0xffff0000, v43
  v_lshlrev_b32 v128, 16, v44
  v_and_b32 v129, 0xffff0000, v44
  v_lshlrev_b32 v130, 16, v45
  v_and_b32 v131, 0xffff0000, v45
  v_lshlrev_b32 v132, 16, v46
  v_and_b32 v133, 0xffff0000, v46
  v_lshlrev_b32 v134, 16, v47
  v_and_b32 v135, 0xffff0000, v47
  v_lshlrev_b32 v136, 16, v48
  v_and_b32 v137, 0xffff0000, v48
  v_lshlrev_b32 v138, 16, v49
  v_and_b32 v139, 0xffff0000, v49
  v_lshlrev_b32 v140, 16, v50
  v_and_b32 v141, 0xffff0000, v50
  v_lshlrev_b32 v142, 16, v51
  v_and_b32 v143, 0xffff0000, v51
  v_add_f32 v120, v120, v160
  v_add_f32 v121, v121, v160
  v_add_f32 v122, v122, v160
  v_add_f32 v123, v123, v160
  v_add_f32 v124, v124, v161
  v_add_f32 v125, v125, v161
  v_add_f32 v126, v126, v161
  v_add_f32 v127, v127, v161
  v_add_f32 v128, v128, v160
  v_add_f32 v129, v129, v160
  v_add_f32 v130, v130, v160
  v_add_f32 v131, v131, v160
  v_add_f32 v132, v132, v161
  v_add_f32 v133, v133, v161
  v_add_f32 v134, v134, v161
  v_add_f32 v135, v135, v161
  v_add_f32 v136, v136, v160
  v_add_f32 v137, v137, v160
  v_add_f32 v138, v138, v160
  v_add_f32 v139, v139, v160
  v_add_f32 v140, v140, v161
  v_add_f32 v141, v141, v161
  v_add_f32 v142, v142, v161
  v_add_f32 v143, v143, v161
  v_cvt_pk_bf16_f32 v120, v120, v121
  v_cvt_pk_bf16_f32 v121, v122, v123
  v_cvt_pk_bf16_f32 v124, v124, v125
  v_cvt_pk_bf16_f32 v125, v126, v127
  v_cvt_pk_bf16_f32 v128, v128, v129
  v_cvt_pk_bf16_f32 v129, v130, v131
  v_cvt_pk_bf16_f32 v132, v132, v133
  v_cvt_pk_bf16_f32 v133, v134, v135
  v_cvt_pk_bf16_f32 v136, v136, v137
  v_cvt_pk_bf16_f32 v137, v138, v139
  v_cvt_pk_bf16_f32 v140, v140, v141
  v_cvt_pk_bf16_f32 v141, v142, v143
  ds_write_b64 v20, v[120:121] offset:0
  ds_write_b64 v20, v[124:125] offset:3328
  ds_write_b64 v20, v[128:129] offset:32
  ds_write_b64 v20, v[132:133] offset:3360
  ds_write_b64 v20, v[136:137] offset:64
  ds_write_b64 v20, v[140:141] offset:3392
  s_waitcnt lgkmcnt(0)
Loc_27:
  s_barrier
  ds_read_b128 v[164:167], v144
  ds_read_b128 v[168:171], v145
  s_waitcnt lgkmcnt(1)
  v_lshlrev_b32 v40, 16, v164
  v_and_b32 v41, 0xffff0000, v164
  v_lshlrev_b32 v42, 16, v152
  v_and_b32 v43, 0xffff0000, v152
  v_pk_mul_f32 v[40:41], v[40:41], v[42:43]
  v_cvt_pk_bf16_f32 v164, v40, v41
  v_lshlrev_b32 v44, 16, v165
  v_and_b32 v45, 0xffff0000, v165
  v_lshlrev_b32 v46, 16, v153
  v_and_b32 v47, 0xffff0000, v153
  v_pk_mul_f32 v[44:45], v[44:45], v[46:47]
  v_cvt_pk_bf16_f32 v165, v44, v45
  v_lshlrev_b32 v40, 16, v166
  v_and_b32 v41, 0xffff0000, v166
  v_lshlrev_b32 v42, 16, v154
  v_and_b32 v43, 0xffff0000, v154
  v_pk_mul_f32 v[40:41], v[40:41], v[42:43]
  v_cvt_pk_bf16_f32 v166, v40, v41
  v_lshlrev_b32 v44, 16, v167
  v_and_b32 v45, 0xffff0000, v167
  v_lshlrev_b32 v46, 16, v155
  v_and_b32 v47, 0xffff0000, v155
  v_pk_mul_f32 v[44:45], v[44:45], v[46:47]
  v_cvt_pk_bf16_f32 v167, v44, v45
  buffer_store_dwordx4 v[164:167], v146, s[52:55], s15 offen sc1
  s_waitcnt lgkmcnt(0)
  v_lshlrev_b32 v40, 16, v168
  v_and_b32 v41, 0xffff0000, v168
  v_lshlrev_b32 v42, 16, v156
  v_and_b32 v43, 0xffff0000, v156
  v_pk_mul_f32 v[40:41], v[40:41], v[42:43]
  v_cvt_pk_bf16_f32 v168, v40, v41
  v_lshlrev_b32 v44, 16, v169
  v_and_b32 v45, 0xffff0000, v169
  v_lshlrev_b32 v46, 16, v157
  v_and_b32 v47, 0xffff0000, v157
  v_pk_mul_f32 v[44:45], v[44:45], v[46:47]
  v_cvt_pk_bf16_f32 v169, v44, v45
  v_lshlrev_b32 v40, 16, v170
  v_and_b32 v41, 0xffff0000, v170
  v_lshlrev_b32 v42, 16, v158
  v_and_b32 v43, 0xffff0000, v158
  v_pk_mul_f32 v[40:41], v[40:41], v[42:43]
  v_cvt_pk_bf16_f32 v170, v40, v41
  v_lshlrev_b32 v44, 16, v171
  v_and_b32 v45, 0xffff0000, v171
  v_lshlrev_b32 v46, 16, v159
  v_and_b32 v47, 0xffff0000, v159
  v_pk_mul_f32 v[44:45], v[44:45], v[46:47]
  v_cvt_pk_bf16_f32 v171, v44, v45
  buffer_store_dwordx4 v[168:171], v147, s[52:55], s15 offen sc1
  s_waitcnt vmcnt(0)
  s_barrier
  s_cmp_lg_u32 s3, 0
  s_cbranch_scc1 Lsg_28
  v_mov_b32 v6, 0
  v_mov_b32 v7, 1
  s_mov_b64 s[88:89], exec
  s_mov_b64 exec, 1
  buffer_atomic_add v7, v6, s[84:87], s90 offen sc1
  s_mov_b64 exec, s[88:89]
Lsg_28:
  s_add_u32 s44, s42, 2097152
  s_addc_u32 s45, s43, 0
  s_mov_b32 s46, 983040
  s_mov_b32 s47, 0x20000
  s_add_u32 s48, s42, 29360128
  s_addc_u32 s49, s43, 0
  s_mov_b32 s50, 3145728
  s_mov_b32 s51, 0x20000
  s_mul_i32 s6, s4, 80
  s_lshl_b32 s7, s5, 6
  s_mul_i32 s8, s6, 1536
  s_mul_i32 s9, s7, 1536
  s_and_b32 s74, s3, 3
  s_add_u32 s10, s74, 0
  s_lshl_b32 s11, s10, 2
  v_add_u32 v6, s11, v3
  v_and_b32 v6, 7, v6
  v_xor_b32 v6, v6, v4
  s_lshl_b32 s11, s10, 3
  v_add_u32 v7, s11, v2
  s_mov_b32 s12, 1536
  v_mul_lo_u32 v7, v7, s12
  v_lshl_add_u32 v24, v6, 4, v7
  s_lshl_b32 s64, s10, 10
  s_add_u32 s10, s74, 4
  s_lshl_b32 s11, s10, 2
  v_add_u32 v6, s11, v3
  v_and_b32 v6, 7, v6
  v_xor_b32 v6, v6, v4
  s_lshl_b32 s11, s10, 3
  v_add_u32 v7, s11, v2
  s_mov_b32 s12, 1536
  v_mul_lo_u32 v7, v7, s12
  v_lshl_add_u32 v25, v6, 4, v7
  s_lshl_b32 s65, s10, 10
  s_add_u32 s10, s74, 8
  s_lshl_b32 s11, s10, 2
  v_add_u32 v6, s11, v3
  v_and_b32 v6, 7, v6
  v_xor_b32 v6, v6, v4
  s_lshl_b32 s11, s10, 3
  v_add_u32 v7, s11, v2
  s_mov_b32 s12, 1536
  v_mul_lo_u32 v7, v7, s12
  v_lshl_add_u32 v26, v6, 4, v7
  s_lshl_b32 s66, s10, 10
  s_add_u32 s10, s74, 0
  s_lshl_b32 s11, s10, 2
  v_add_u32 v6, s11, v3
  v_and_b32 v6, 7, v6
  v_xor_b32 v6, v6, v4
  s_lshl_b32 s11, s10, 3
  v_add_u32 v7, s11, v2
  s_mov_b32 s12, 1536
  v_mul_lo_u32 v7, v7, s12
  v_lshl_add_u32 v27, v6, 4, v7
  s_lshl_b32 s67, s10, 10
  s_add_u32 s67, s67, 10240
  s_add_u32 s10, s74, 4
  s_lshl_b32 s11, s10, 2
  v_add_u32 v6, s11, v3
  v_and_b32 v6, 7, v6
  v_xor_b32 v6, v6, v4
  s_lshl_b32 s11, s10, 3
  v_add_u32 v7, s11, v2
  s_mov_b32 s12, 1536
  v_mul_lo_u32 v7, v7, s12
  v_lshl_add_u32 v28, v6, 4, v7
  s_lshl_b32 s68, s10, 10
  s_add_u32 s68, s68, 10240
  s_mov_b32 s13, 0
  s_mov_b32 s14, s74
  v_lshrrev_b32 v6, 1, v5
  v_xor_b32 v6, v6, v3
  v_lshlrev_b32 v6, 4, v6
  v_lshl_add_u32 v6, v5, 7, v6
  v_xor_b32 v7, 64, v6
  s_mul_i32 s10, s13, 10240
  s_mul_i32 s11, s14, 2048
  s_add_u32 s11, s11, 10240
  v_add_u32 v8, s10, v6
  v_add_u32 v14, s11, v6
  v_add_u32 v9, s10, v7
  v_add_u32 v15, s11, v7
  v_add_u32 v10, s10, v6
  v_add_u32 v16, s11, v6
  v_add_u32 v10, 65536, v10
  v_add_u32 v16, 65536, v16
  v_add_u32 v11, s10, v7
  v_add_u32 v17, s11, v7
  v_add_u32 v11, 65536, v11
  v_add_u32 v17, 65536, v17
  v_add_u32 v12, s10, v6
  v_add_u32 v18, s11, v6
  v_add_u32 v12, 131072, v12
  v_add_u32 v18, 131072, v18
  v_add_u32 v13, s10, v7
  v_add_u32 v19, s11, v7
  v_add_u32 v13, 131072, v13
  v_add_u32 v19, 131072, v19
  s_add_u32 s60, s42, 12582912
  s_addc_u32 s61, s43, 0
  s_mov_b32 s62, 2621440
  s_mov_b32 s63, 0x20000
  s_add_u32 s10, s42, 32505856
  s_addc_u32 s11, s43, 0
  s_cmp_lg_u32 s101, 0
  s_cselect_b32 s52, s38, s10
  s_cselect_b32 s53, s39, s11
  s_mov_b32 s54, 2621440
  s_mov_b32 s55, 0x20000
  v_add_u32 v6, 0, v23
  v_mul_u32_u24 v7, 52429, v6
  v_lshrrev_b32 v7, 19, v7
  v_mul_u32_u24 v20, 10, v7
  v_sub_u32 v20, v6, v20
  v_mul_u32_u24 v156, 176, v7
  v_lshl_add_u32 v156, v20, 4, v156
  v_add_u32 v156, 65536, v156
  v_mul_u32_u24 v158, 1280, v7
  v_lshl_add_u32 v158, v20, 4, v158
  v_add_u32 v6, 512, v23
  v_mul_u32_u24 v7, 52429, v6
  v_lshrrev_b32 v7, 19, v7
  v_mul_u32_u24 v20, 10, v7
  v_sub_u32 v20, v6, v20
  v_mul_u32_u24 v157, 176, v7
  v_lshl_add_u32 v157, v20, 4, v157
  v_add_u32 v157, 65536, v157
  v_mul_u32_u24 v159, 1280, v7
  v_lshl_add_u32 v159, v20, 4, v159
  v_cmp_gt_u32 vcc, 640, v6
  v_mov_b32 v22, 0x7ffffff0
  s_nop 0
  v_cndmask_b32 v159, v22, v159, vcc
  v_mov_b32 v22, 65536
  v_cndmask_b32 v157, v22, v157, vcc
  s_mul_i32 s15, s7, 1280
  s_lshl_b32 s11, s6, 1
  s_add_u32 s15, s15, s11
  buffer_load_dwordx4 v[160:163], v158, s[60:63], s15 offen
  buffer_load_dwordx4 v[164:167], v159, s[60:63], s15 offen
  s_mul_i32 s10, s14, 2816
  s_mul_i32 s11, s13, 160
  s_add_u32 s10, s10, s11
  s_add_u32 s10, s10, 65536
  v_mul_u32_u24 v20, 176, v5
  v_lshl_add_u32 v20, v3, 3, v20
  v_add_u32 v20, s10, v20
  s_cmp_lg_u32 s3, 0
  s_cbranch_scc1 Lsw_29
  v_mov_b32 v6, 0
  s_setprio 3
Lsp_30:
  buffer_load_dword v7, v6, s[84:87], s90 offen sc1
  s_waitcnt vmcnt(0)
  v_cmp_gt_u32 vcc, 8, v7
  s_cbranch_vccnz Lsp_30
  s_setprio 0
Lsw_29:
  s_cmp_eq_u32 s75, 0
  s_cbranch_scc1 Lpr_31
  s_add_u32 m0, s64, 0
  s_nop 0
  buffer_load_dwordx4 v24, s[44:47], s8 offen lds
  s_add_u32 m0, s65, 0
  s_nop 0
  buffer_load_dwordx4 v25, s[44:47], s8 offen lds
  s_cmp_ge_u32 s74, 2
  s_cbranch_scc1 Lsk_32
  s_add_u32 m0, s66, 0
  s_nop 0
  buffer_load_dwordx4 v26, s[44:47], s8 offen lds
Lsk_32:
  s_add_u32 s8, s8, 128
  s_add_u32 m0, s64, 18432
  s_nop 0
  buffer_load_dwordx4 v24, s[44:47], s8 offen lds
  s_add_u32 m0, s65, 18432
  s_nop 0
  buffer_load_dwordx4 v25, s[44:47], s8 offen lds
  s_cmp_ge_u32 s74, 2
  s_cbranch_scc1 Lsk_33
  s_add_u32 m0, s66, 18432
  s_nop 0
  buffer_load_dwordx4 v26, s[44:47], s8 offen lds
Lsk_33:
  s_add_u32 s8, s8, 128
  s_add_u32 m0, s64, 36864
  s_nop 0
  buffer_load_dwordx4 v24, s[44:47], s8 offen lds
  s_add_u32 m0, s65, 36864
  s_nop 0
  buffer_load_dwordx4 v25, s[44:47], s8 offen lds
  s_cmp_ge_u32 s74, 2
  s_cbranch_scc1 Lsk_34
  s_add_u32 m0, s66, 36864
  s_nop 0
  buffer_load_dwordx4 v26, s[44:47], s8 offen lds
Lsk_34:
  s_add_u32 s8, s8, 128
  s_add_u32 m0, s64, 55296
  s_nop 0
  buffer_load_dwordx4 v24, s[44:47], s8 offen lds
  s_add_u32 m0, s65, 55296
  s_nop 0
  buffer_load_dwordx4 v25, s[44:47], s8 offen lds
  s_cmp_ge_u32 s74, 2
  s_cbranch_scc1 Lsk_35
  s_add_u32 m0, s66, 55296
  s_nop 0
  buffer_load_dwordx4 v26, s[44:47], s8 offen lds
Lsk_35:
  s_add_u32 s8, s8, 128
  s_add_u32 m0, s64, 73728
  s_nop 0
  buffer_load_dwordx4 v24, s[44:47], s8 offen lds
  s_add_u32 m0, s65, 73728
  s_nop 0
  buffer_load_dwordx4 v25, s[44:47], s8 offen lds
  s_cmp_ge_u32 s74, 2
  s_cbranch_scc1 Lsk_36
  s_add_u32 m0, s66, 73728
  s_nop 0
  buffer_load_dwordx4 v26, s[44:47], s8 offen lds
Lsk_36:
  s_add_u32 s8, s8, 128
  s_add_u32 m0, s64, 92160
  s_nop 0
  buffer_load_dwordx4 v24, s[44:47], s8 offen lds
  s_add_u32 m0, s65, 92160
  s_nop 0
  buffer_load_dwordx4 v25, s[44:47], s8 offen lds
  s_cmp_ge_u32 s74, 2
  s_cbranch_scc1 Lsk_37
  s_add_u32 m0, s66, 92160
  s_nop 0
  buffer_load_dwordx4 v26, s[44:47], s8 offen lds
Lsk_37:
  s_add_u32 s8, s8, 128
  s_add_u32 m0, s64, 110592
  s_nop 0
  buffer_load_dwordx4 v24, s[44:47], s8 offen lds
  s_add_u32 m0, s65, 110592
  s_nop 0
  buffer_load_dwordx4 v25, s[44:47], s8 offen lds
  s_cmp_ge_u32 s74, 2
  s_cbranch_scc1 Lsk_38
  s_add_u32 m0, s66, 110592
  s_nop 0
  buffer_load_dwordx4 v26, s[44:47], s8 offen lds
Lsk_38:
  s_add_u32 s8, s8, 128
Lpr_31:
  s_barrier
  s_cmp_eq_u32 s75, 0
  s_cbranch_scc1 Lpr_39
  s_add_u32 m0, s67, 0
  s_nop 0
  buffer_load_dwordx4 v27, s[48:51], s9 offen sc1 lds
  s_add_u32 m0, s68, 0
  s_nop 0
  buffer_load_dwordx4 v28, s[48:51], s9 offen sc1 lds
  s_add_u32 s9, s9, 128
  s_add_u32 m0, s67, 18432
  s_nop 0
  buffer_load_dwordx4 v27, s[48:51], s9 offen sc1 lds
  s_add_u32 m0, s68, 18432
  s_nop 0
  buffer_load_dwordx4 v28, s[48:51], s9 offen sc1 lds
  s_add_u32 s9, s9, 128
  s_add_u32 m0, s67, 36864
  s_nop 0
  buffer_load_dwordx4 v27, s[48:51], s9 offen sc1 lds
  s_add_u32 m0, s68, 36864
  s_nop 0
  buffer_load_dwordx4 v28, s[48:51], s9 offen sc1 lds
  s_add_u32 s9, s9, 128
  s_add_u32 m0, s67, 55296
  s_nop 0
  buffer_load_dwordx4 v27, s[48:51], s9 offen sc1 lds
  s_add_u32 m0, s68, 55296
  s_nop 0
  buffer_load_dwordx4 v28, s[48:51], s9 offen sc1 lds
  s_add_u32 s9, s9, 128
  s_add_u32 m0, s67, 73728
  s_nop 0
  buffer_load_dwordx4 v27, s[48:51], s9 offen sc1 lds
  s_add_u32 m0, s68, 73728
  s_nop 0
  buffer_load_dwordx4 v28, s[48:51], s9 offen sc1 lds
  s_add_u32 s9, s9, 128
  s_add_u32 m0, s67, 92160
  s_nop 0
  buffer_load_dwordx4 v27, s[48:51], s9 offen sc1 lds
  s_add_u32 m0, s68, 92160
  s_nop 0
  buffer_load_dwordx4 v28, s[48:51], s9 offen sc1 lds
  s_add_u32 s9, s9, 128
  s_add_u32 m0, s67, 110592
  s_nop 0
  buffer_load_dwordx4 v27, s[48:51], s9 offen sc1 lds
  s_add_u32 m0, s68, 110592
  s_nop 0
  buffer_load_dwordx4 v28, s[48:51], s9 offen sc1 lds
  s_add_u32 s9, s9, 128
Lpr_39:
  s_cmp_lg_u32 s75, 0
  s_cbranch_scc1 Lld_40
  v_mov_b32 v136, 0
  v_mov_b32 v137, 0
  v_mov_b32 v138, 0
  v_mov_b32 v139, 0
  v_mov_b32 v140, 0
  v_mov_b32 v141, 0
  v_mov_b32 v142, 0
  v_mov_b32 v143, 0
  v_mov_b32 v144, 0
  v_mov_b32 v145, 0
  v_mov_b32 v146, 0
  v_mov_b32 v147, 0
  v_mov_b32 v148, 0
  v_mov_b32 v149, 0
  v_mov_b32 v150, 0
  v_mov_b32 v151, 0
  v_mov_b32 v152, 0
  v_mov_b32 v153, 0
  v_mov_b32 v154, 0
  v_mov_b32 v155, 0
  s_barrier
  ds_read_b128 v[40:43], v8 offset:0
  ds_read_b128 v[44:47], v8 offset:2048
  ds_read_b128 v[48:51], v8 offset:4096
  ds_read_b128 v[52:55], v8 offset:6144
  ds_read_b128 v[56:59], v8 offset:8192
  ds_read_b128 v[60:63], v14 offset:0
  ds_read_b128 v[64:67], v9 offset:0
  ds_read_b128 v[68:71], v9 offset:2048
  ds_read_b128 v[72:75], v9 offset:4096
  ds_read_b128 v[76:79], v9 offset:6144
  ds_read_b128 v[80:83], v9 offset:8192
  ds_read_b128 v[84:87], v15 offset:0
  s_waitcnt lgkmcnt(0)
  s_barrier
  ds_read_b128 v[88:91], v8 offset:18432
  ds_read_b128 v[92:95], v8 offset:20480
  ds_read_b128 v[96:99], v8 offset:22528
  ds_read_b128 v[100:103], v8 offset:24576
  ds_read_b128 v[104:107], v8 offset:26624
  ds_read_b128 v[108:111], v14 offset:18432
  ds_read_b128 v[112:115], v9 offset:18432
  ds_read_b128 v[116:119], v9 offset:20480
  ds_read_b128 v[120:123], v9 offset:22528
  ds_read_b128 v[124:127], v9 offset:24576
  ds_read_b128 v[128:131], v9 offset:26624
  ds_read_b128 v[132:135], v15 offset:18432
  v_mfma_f32_16x16x32_bf16 v[136:139], v[40:43], v[60:63], v[136:139]
  v_mfma_f32_16x16x32_bf16 v[140:143], v[44:47], v[60:63], v[140:143]
  v_mfma_f32_16x16x32_bf16 v[144:147], v[48:51], v[60:63], v[144:147]
  v_mfma_f32_16x16x32_bf16 v[148:151], v[52:55], v[60:63], v[148:151]
  v_mfma_f32_16x16x32_bf16 v[152:155], v[56:59], v[60:63], v[152:155]
  v_mfma_f32_16x16x32_bf16 v[136:139], v[64:67], v[84:87], v[136:139]
  v_mfma_f32_16x16x32_bf16 v[140:143], v[68:71], v[84:87], v[140:143]
  v_mfma_f32_16x16x32_bf16 v[144:147], v[72:75], v[84:87], v[144:147]
  v_mfma_f32_16x16x32_bf16 v[148:151], v[76:79], v[84:87], v[148:151]
  v_mfma_f32_16x16x32_bf16 v[152:155], v[80:83], v[84:87], v[152:155]
  s_waitcnt lgkmcnt(0)
  s_barrier
  ds_read_b128 v[40:43], v8 offset:36864
  ds_read_b128 v[44:47], v8 offset:38912
  ds_read_b128 v[48:51], v8 offset:40960
  ds_read_b128 v[52:55], v8 offset:43008
  ds_read_b128 v[56:59], v8 offset:45056
  ds_read_b128 v[60:63], v14 offset:36864
  ds_read_b128 v[64:67], v9 offset:36864
  ds_read_b128 v[68:71], v9 offset:38912
  ds_read_b128 v[72:75], v9 offset:40960
  ds_read_b128 v[76:79], v9 offset:43008
  ds_read_b128 v[80:83], v9 offset:45056
  ds_read_b128 v[84:87], v15 offset:36864
  v_mfma_f32_16x16x32_bf16 v[136:139], v[88:91], v[108:111], v[136:139]
  v_mfma_f32_16x16x32_bf16 v[140:143], v[92:95], v[108:111], v[140:143]
  v_mfma_f32_16x16x32_bf16 v[144:147], v[96:99], v[108:111], v[144:147]
  v_mfma_f32_16x16x32_bf16 v[148:151], v[100:103], v[108:111], v[148:151]
  v_mfma_f32_16x16x32_bf16 v[152:155], v[104:107], v[108:111], v[152:155]
  v_mfma_f32_16x16x32_bf16 v[136:139], v[112:115], v[132:135], v[136:139]
  v_mfma_f32_16x16x32_bf16 v[140:143], v[116:119], v[132:135], v[140:143]
  v_mfma_f32_16x16x32_bf16 v[144:147], v[120:123], v[132:135], v[144:147]
  v_mfma_f32_16x16x32_bf16 v[148:151], v[124:127], v[132:135], v[148:151]
  v_mfma_f32_16x16x32_bf16 v[152:155], v[128:131], v[132:135], v[152:155]
  s_waitcnt lgkmcnt(0)
  s_barrier
  ds_read_b128 v[88:91], v8 offset:55296
  ds_read_b128 v[92:95], v8 offset:57344
  ds_read_b128 v[96:99], v8 offset:59392
  ds_read_b128 v[100:103], v8 offset:61440
  ds_read_b128 v[104:107], v8 offset:63488
  ds_read_b128 v[108:111], v14 offset:55296
  ds_read_b128 v[112:115], v9 offset:55296
  ds_read_b128 v[116:119], v9 offset:57344
  ds_read_b128 v[120:123], v9 offset:59392
  ds_read_b128 v[124:127], v9 offset:61440
  ds_read_b128 v[128:131], v9 offset:63488
  ds_read_b128 v[132:135], v15 offset:55296
  v_mfma_f32_16x16x32_bf16 v[136:139], v[40:43], v[60:63], v[136:139]
  v_mfma_f32_16x16x32_bf16 v[140:143], v[44:47], v[60:63], v[140:143]
  v_mfma_f32_16x16x32_bf16 v[144:147], v[48:51], v[60:63], v[144:147]
  v_mfma_f32_16x16x32_bf16 v[148:151], v[52:55], v[60:63], v[148:151]
  v_mfma_f32_16x16x32_bf16 v[152:155], v[56:59], v[60:63], v[152:155]
  v_mfma_f32_16x16x32_bf16 v[136:139], v[64:67], v[84:87], v[136:139]
  v_mfma_f32_16x16x32_bf16 v[140:143], v[68:71], v[84:87], v[140:143]
  v_mfma_f32_16x16x32_bf16 v[144:147], v[72:75], v[84:87], v[144:147]
  v_mfma_f32_16x16x32_bf16 v[148:151], v[76:79], v[84:87], v[148:151]
  v_mfma_f32_16x16x32_bf16 v[152:155], v[80:83], v[84:87], v[152:155]
  s_waitcnt lgkmcnt(0)
  s_barrier
  ds_read_b128 v[40:43], v10 offset:8192
  ds_read_b128 v[44:47], v10 offset:10240
  ds_read_b128 v[48:51], v10 offset:12288
  ds_read_b128 v[52:55], v10 offset:14336
  ds_read_b128 v[56:59], v10 offset:16384
  ds_read_b128 v[60:63], v16 offset:8192
  ds_read_b128 v[64:67], v11 offset:8192
  ds_read_b128 v[68:71], v11 offset:10240
  ds_read_b128 v[72:75], v11 offset:12288
  ds_read_b128 v[76:79], v11 offset:14336
  ds_read_b128 v[80:83], v11 offset:16384
  ds_read_b128 v[84:87], v17 offset:8192
  v_mfma_f32_16x16x32_bf16 v[136:139], v[88:91], v[108:111], v[136:139]
  v_mfma_f32_16x16x32_bf16 v[140:143], v[92:95], v[108:111], v[140:143]
  v_mfma_f32_16x16x32_bf16 v[144:147], v[96:99], v[108:111], v[144:147]
  v_mfma_f32_16x16x32_bf16 v[148:151], v[100:103], v[108:111], v[148:151]
  v_mfma_f32_16x16x32_bf16 v[152:155], v[104:107], v[108:111], v[152:155]
  v_mfma_f32_16x16x32_bf16 v[136:139], v[112:115], v[132:135], v[136:139]
  v_mfma_f32_16x16x32_bf16 v[140:143], v[116:119], v[132:135], v[140:143]
  v_mfma_f32_16x16x32_bf16 v[144:147], v[120:123], v[132:135], v[144:147]
  v_mfma_f32_16x16x32_bf16 v[148:151], v[124:127], v[132:135], v[148:151]
  v_mfma_f32_16x16x32_bf16 v[152:155], v[128:131], v[132:135], v[152:155]
  s_waitcnt lgkmcnt(0)
  s_barrier
  ds_read_b128 v[88:91], v10 offset:26624
  ds_read_b128 v[92:95], v10 offset:28672
  ds_read_b128 v[96:99], v10 offset:30720
  ds_read_b128 v[100:103], v10 offset:32768
  ds_read_b128 v[104:107], v10 offset:34816
  ds_read_b128 v[108:111], v16 offset:26624
  ds_read_b128 v[112:115], v11 offset:26624
  ds_read_b128 v[116:119], v11 offset:28672
  ds_read_b128 v[120:123], v11 offset:30720
  ds_read_b128 v[124:127], v11 offset:32768
  ds_read_b128 v[128:131], v11 offset:34816
  ds_read_b128 v[132:135], v17 offset:26624
  v_mfma_f32_16x16x32_bf16 v[136:139], v[40:43], v[60:63], v[136:139]
  v_mfma_f32_16x16x32_bf16 v[140:143], v[44:47], v[60:63], v[140:143]
  v_mfma_f32_16x16x32_bf16 v[144:147], v[48:51], v[60:63], v[144:147]
  v_mfma_f32_16x16x32_bf16 v[148:151], v[52:55], v[60:63], v[148:151]
  v_mfma_f32_16x16x32_bf16 v[152:155], v[56:59], v[60:63], v[152:155]
  v_mfma_f32_16x16x32_bf16 v[136:139], v[64:67], v[84:87], v[136:139]
  v_mfma_f32_16x16x32_bf16 v[140:143], v[68:71], v[84:87], v[140:143]
  v_mfma_f32_16x16x32_bf16 v[144:147], v[72:75], v[84:87], v[144:147]
  v_mfma_f32_16x16x32_bf16 v[148:151], v[76:79], v[84:87], v[148:151]
  v_mfma_f32_16x16x32_bf16 v[152:155], v[80:83], v[84:87], v[152:155]
  s_waitcnt lgkmcnt(0)
  s_barrier
  ds_read_b128 v[40:43], v10 offset:45056
  ds_read_b128 v[44:47], v10 offset:47104
  ds_read_b128 v[48:51], v10 offset:49152
  ds_read_b128 v[52:55], v10 offset:51200
  ds_read_b128 v[56:59], v10 offset:53248
  ds_read_b128 v[60:63], v16 offset:45056
  ds_read_b128 v[64:67], v11 offset:45056
  ds_read_b128 v[68:71], v11 offset:47104
  ds_read_b128 v[72:75], v11 offset:49152
  ds_read_b128 v[76:79], v11 offset:51200
  ds_read_b128 v[80:83], v11 offset:53248
  ds_read_b128 v[84:87], v17 offset:45056
  v_mfma_f32_16x16x32_bf16 v[136:139], v[88:91], v[108:111], v[136:139]
  v_mfma_f32_16x16x32_bf16 v[140:143], v[92:95], v[108:111], v[140:143]
  v_mfma_f32_16x16x32_bf16 v[144:147], v[96:99], v[108:111], v[144:147]
  v_mfma_f32_16x16x32_bf16 v[148:151], v[100:103], v[108:111], v[148:151]
  v_mfma_f32_16x16x32_bf16 v[152:155], v[104:107], v[108:111], v[152:155]
  v_mfma_f32_16x16x32_bf16 v[136:139], v[112:115], v[132:135], v[136:139]
  v_mfma_f32_16x16x32_bf16 v[140:143], v[116:119], v[132:135], v[140:143]
  v_mfma_f32_16x16x32_bf16 v[144:147], v[120:123], v[132:135], v[144:147]
  v_mfma_f32_16x16x32_bf16 v[148:151], v[124:127], v[132:135], v[148:151]
  v_mfma_f32_16x16x32_bf16 v[152:155], v[128:131], v[132:135], v[152:155]
  s_waitcnt lgkmcnt(0)
  s_barrier
  ds_read_b128 v[88:91], v10 offset:63488
  ds_read_b128 v[92:95], v12 offset:0
  ds_read_b128 v[96:99], v12 offset:2048
  ds_read_b128 v[100:103], v12 offset:4096
  ds_read_b128 v[104:107], v12 offset:6144
  ds_read_b128 v[108:111], v16 offset:63488
  ds_read_b128 v[112:115], v11 offset:63488
  ds_read_b128 v[116:119], v13 offset:0
  ds_read_b128 v[120:123], v13 offset:2048
  ds_read_b128 v[124:127], v13 offset:4096
  ds_read_b128 v[128:131], v13 offset:6144
  ds_read_b128 v[132:135], v17 offset:63488
  v_mfma_f32_16x16x32_bf16 v[136:139], v[40:43], v[60:63], v[136:139]
  v_mfma_f32_16x16x32_bf16 v[140:143], v[44:47], v[60:63], v[140:143]
  v_mfma_f32_16x16x32_bf16 v[144:147], v[48:51], v[60:63], v[144:147]
  v_mfma_f32_16x16x32_bf16 v[148:151], v[52:55], v[60:63], v[148:151]
  v_mfma_f32_16x16x32_bf16 v[152:155], v[56:59], v[60:63], v[152:155]
  v_mfma_f32_16x16x32_bf16 v[136:139], v[64:67], v[84:87], v[136:139]
  v_mfma_f32_16x16x32_bf16 v[140:143], v[68:71], v[84:87], v[140:143]
  v_mfma_f32_16x16x32_bf16 v[144:147], v[72:75], v[84:87], v[144:147]
  v_mfma_f32_16x16x32_bf16 v[148:151], v[76:79], v[84:87], v[148:151]
  v_mfma_f32_16x16x32_bf16 v[152:155], v[80:83], v[84:87], v[152:155]
  s_waitcnt lgkmcnt(0)
  s_barrier
  ds_read_b128 v[40:43], v8 offset:0
  ds_read_b128 v[44:47], v8 offset:2048
  ds_read_b128 v[48:51], v8 offset:4096
  ds_read_b128 v[52:55], v8 offset:6144
  ds_read_b128 v[56:59], v8 offset:8192
  ds_read_b128 v[60:63], v14 offset:0
  ds_read_b128 v[64:67], v9 offset:0
  ds_read_b128 v[68:71], v9 offset:2048
  ds_read_b128 v[72:75], v9 offset:4096
  ds_read_b128 v[76:79], v9 offset:6144
  ds_read_b128 v[80:83], v9 offset:8192
  ds_read_b128 v[84:87], v15 offset:0
  v_mfma_f32_16x16x32_bf16 v[136:139], v[88:91], v[108:111], v[136:139]
  v_mfma_f32_16x16x32_bf16 v[140:143], v[92:95], v[108:111], v[140:143]
  v_mfma_f32_16x16x32_bf16 v[144:147], v[96:99], v[108:111], v[144:147]
  v_mfma_f32_16x16x32_bf16 v[148:151], v[100:103], v[108:111], v[148:151]
  v_mfma_f32_16x16x32_bf16 v[152:155], v[104:107], v[108:111], v[152:155]
  v_mfma_f32_16x16x32_bf16 v[136:139], v[112:115], v[132:135], v[136:139]
  v_mfma_f32_16x16x32_bf16 v[140:143], v[116:119], v[132:135], v[140:143]
  v_mfma_f32_16x16x32_bf16 v[144:147], v[120:123], v[132:135], v[144:147]
  v_mfma_f32_16x16x32_bf16 v[148:151], v[124:127], v[132:135], v[148:151]
  v_mfma_f32_16x16x32_bf16 v[152:155], v[128:131], v[132:135], v[152:155]
  s_waitcnt lgkmcnt(0)
  s_barrier
  ds_read_b128 v[88:91], v8 offset:18432
  ds_read_b128 v[92:95], v8 offset:20480
  ds_read_b128 v[96:99], v8 offset:22528
  ds_read_b128 v[100:103], v8 offset:24576
  ds_read_b128 v[104:107], v8 offset:26624
  ds_read_b128 v[108:111], v14 offset:18432
  ds_read_b128 v[112:115], v9 offset:18432
  ds_read_b128 v[116:119], v9 offset:20480
  ds_read_b128 v[120:123], v9 offset:22528
  ds_read_b128 v[124:127], v9 offset:24576
  ds_read_b128 v[128:131], v9 offset:26624
  ds_read_b128 v[132:135], v15 offset:18432
  v_mfma_f32_16x16x32_bf16 v[136:139], v[40:43], v[60:63], v[136:139]
  v_mfma_f32_16x16x32_bf16 v[140:143], v[44:47], v[60:63], v[140:143]
  v_mfma_f32_16x16x32_bf16 v[144:147], v[48:51], v[60:63], v[144:147]
  v_mfma_f32_16x16x32_bf16 v[148:151], v[52:55], v[60:63], v[148:151]
  v_mfma_f32_16x16x32_bf16 v[152:155], v[56:59], v[60:63], v[152:155]
  v_mfma_f32_16x16x32_bf16 v[136:139], v[64:67], v[84:87], v[136:139]
  v_mfma_f32_16x16x32_bf16 v[140:143], v[68:71], v[84:87], v[140:143]
  v_mfma_f32_16x16x32_bf16 v[144:147], v[72:75], v[84:87], v[144:147]
  v_mfma_f32_16x16x32_bf16 v[148:151], v[76:79], v[84:87], v[148:151]
  v_mfma_f32_16x16x32_bf16 v[152:155], v[80:83], v[84:87], v[152:155]
  s_waitcnt lgkmcnt(0)
  s_barrier
  ds_read_b128 v[40:43], v8 offset:36864
  ds_read_b128 v[44:47], v8 offset:38912
  ds_read_b128 v[48:51], v8 offset:40960
  ds_read_b128 v[52:55], v8 offset:43008
  ds_read_b128 v[56:59], v8 offset:45056
  ds_read_b128 v[60:63], v14 offset:36864
  ds_read_b128 v[64:67], v9 offset:36864
  ds_read_b128 v[68:71], v9 offset:38912
  ds_read_b128 v[72:75], v9 offset:40960
  ds_read_b128 v[76:79], v9 offset:43008
  ds_read_b128 v[80:83], v9 offset:45056
  ds_read_b128 v[84:87], v15 offset:36864
  v_mfma_f32_16x16x32_bf16 v[136:139], v[88:91], v[108:111], v[136:139]
  v_mfma_f32_16x16x32_bf16 v[140:143], v[92:95], v[108:111], v[140:143]
  v_mfma_f32_16x16x32_bf16 v[144:147], v[96:99], v[108:111], v[144:147]
  v_mfma_f32_16x16x32_bf16 v[148:151], v[100:103], v[108:111], v[148:151]
  v_mfma_f32_16x16x32_bf16 v[152:155], v[104:107], v[108:111], v[152:155]
  v_mfma_f32_16x16x32_bf16 v[136:139], v[112:115], v[132:135], v[136:139]
  v_mfma_f32_16x16x32_bf16 v[140:143], v[116:119], v[132:135], v[140:143]
  v_mfma_f32_16x16x32_bf16 v[144:147], v[120:123], v[132:135], v[144:147]
  v_mfma_f32_16x16x32_bf16 v[148:151], v[124:127], v[132:135], v[148:151]
  v_mfma_f32_16x16x32_bf16 v[152:155], v[128:131], v[132:135], v[152:155]
  s_waitcnt lgkmcnt(0)
  s_barrier
  ds_read_b128 v[88:91], v8 offset:55296
  ds_read_b128 v[92:95], v8 offset:57344
  ds_read_b128 v[96:99], v8 offset:59392
  ds_read_b128 v[100:103], v8 offset:61440
  ds_read_b128 v[104:107], v8 offset:63488
  ds_read_b128 v[108:111], v14 offset:55296
  ds_read_b128 v[112:115], v9 offset:55296
  ds_read_b128 v[116:119], v9 offset:57344
  ds_read_b128 v[120:123], v9 offset:59392
  ds_read_b128 v[124:127], v9 offset:61440
  ds_read_b128 v[128:131], v9 offset:63488
  ds_read_b128 v[132:135], v15 offset:55296
  v_mfma_f32_16x16x32_bf16 v[136:139], v[40:43], v[60:63], v[136:139]
  v_mfma_f32_16x16x32_bf16 v[140:143], v[44:47], v[60:63], v[140:143]
  v_mfma_f32_16x16x32_bf16 v[144:147], v[48:51], v[60:63], v[144:147]
  v_mfma_f32_16x16x32_bf16 v[148:151], v[52:55], v[60:63], v[148:151]
  v_mfma_f32_16x16x32_bf16 v[152:155], v[56:59], v[60:63], v[152:155]
  v_mfma_f32_16x16x32_bf16 v[136:139], v[64:67], v[84:87], v[136:139]
  v_mfma_f32_16x16x32_bf16 v[140:143], v[68:71], v[84:87], v[140:143]
  v_mfma_f32_16x16x32_bf16 v[144:147], v[72:75], v[84:87], v[144:147]
  v_mfma_f32_16x16x32_bf16 v[148:151], v[76:79], v[84:87], v[148:151]
  v_mfma_f32_16x16x32_bf16 v[152:155], v[80:83], v[84:87], v[152:155]
  s_waitcnt lgkmcnt(0)
  v_mfma_f32_16x16x32_bf16 v[136:139], v[88:91], v[108:111], v[136:139]
  v_mfma_f32_16x16x32_bf16 v[140:143], v[92:95], v[108:111], v[140:143]
  v_mfma_f32_16x16x32_bf16 v[144:147], v[96:99], v[108:111], v[144:147]
  v_mfma_f32_16x16x32_bf16 v[148:151], v[100:103], v[108:111], v[148:151]
  v_mfma_f32_16x16x32_bf16 v[152:155], v[104:107], v[108:111], v[152:155]
  v_mfma_f32_16x16x32_bf16 v[136:139], v[112:115], v[132:135], v[136:139]
  v_mfma_f32_16x16x32_bf16 v[140:143], v[116:119], v[132:135], v[140:143]
  v_mfma_f32_16x16x32_bf16 v[144:147], v[120:123], v[132:135], v[144:147]
  v_mfma_f32_16x16x32_bf16 v[148:151], v[124:127], v[132:135], v[148:151]
  v_mfma_f32_16x16x32_bf16 v[152:155], v[128:131], v[132:135], v[152:155]
  s_branch Ljn_41
Lld_40:
  s_waitcnt vmcnt(12)
  s_barrier
  s_add_u32 m0, s64, 129024
  s_nop 0
  buffer_load_dwordx4 v24, s[44:47], s8 offen lds
  s_add_u32 m0, s65, 129024
  s_nop 0
  buffer_load_dwordx4 v25, s[44:47], s8 offen lds
  s_cmp_ge_u32 s74, 2
  s_cbranch_scc1 Lsk_42
  s_add_u32 m0, s66, 129024
  s_nop 0
  buffer_load_dwordx4 v26, s[44:47], s8 offen lds
Lsk_42:
  s_add_u32 m0, s67, 129024
  s_nop 0
  buffer_load_dwordx4 v27, s[48:51], s9 offen sc1 lds
  s_add_u32 m0, s68, 129024
  s_nop 0
  buffer_load_dwordx4 v28, s[48:51], s9 offen sc1 lds
  s_add_u32 s8, s8, 128
  s_add_u32 s9, s9, 128
  s_waitcnt vmcnt(14)
  s_barrier
  s_add_u32 m0, s64, 0
  s_nop 0
  buffer_load_dwordx4 v24, s[44:47], s8 offen lds
  s_add_u32 m0, s65, 0
  s_nop 0
  buffer_load_dwordx4 v25, s[44:47], s8 offen lds
  s_cmp_ge_u32 s74, 2
  s_cbranch_scc1 Lsk_43
  s_add_u32 m0, s66, 0
  s_nop 0
  buffer_load_dwordx4 v26, s[44:47], s8 offen lds
Lsk_43:
  s_add_u32 m0, s67, 0
  s_nop 0
  buffer_load_dwordx4 v27, s[48:51], s9 offen sc1 lds
  s_add_u32 m0, s68, 0
  s_nop 0
  buffer_load_dwordx4 v28, s[48:51], s9 offen sc1 lds
  s_add_u32 s8, s8, 128
  s_add_u32 s9, s9, 128
  s_waitcnt vmcnt(16)
  s_barrier
  s_add_u32 m0, s64, 18432
  s_nop 0
  buffer_load_dwordx4 v24, s[44:47], s8 offen lds
  s_add_u32 m0, s65, 18432
  s_nop 0
  buffer_load_dwordx4 v25, s[44:47], s8 offen lds
  s_cmp_ge_u32 s74, 2
  s_cbranch_scc1 Lsk_44
  s_add_u32 m0, s66, 18432
  s_nop 0
  buffer_load_dwordx4 v26, s[44:47], s8 offen lds
Lsk_44:
  s_add_u32 m0, s67, 18432
  s_nop 0
  buffer_load_dwordx4 v27, s[48:51], s9 offen sc1 lds
  s_add_u32 m0, s68, 18432
  s_nop 0
  buffer_load_dwordx4 v28, s[48:51], s9 offen sc1 lds
  s_add_u32 s8, s8, 128
  s_add_u32 s9, s9, 128
  s_waitcnt vmcnt(18)
  s_barrier
  s_add_u32 m0, s64, 36864
  s_nop 0
  buffer_load_dwordx4 v24, s[44:47], s8 offen lds
  s_add_u32 m0, s65, 36864
  s_nop 0
  buffer_load_dwordx4 v25, s[44:47], s8 offen lds
  s_cmp_ge_u32 s74, 2
  s_cbranch_scc1 Lsk_45
  s_add_u32 m0, s66, 36864
  s_nop 0
  buffer_load_dwordx4 v26, s[44:47], s8 offen lds
Lsk_45:
  s_add_u32 m0, s67, 36864
  s_nop 0
  buffer_load_dwordx4 v27, s[48:51], s9 offen sc1 lds
  s_add_u32 m0, s68, 36864
  s_nop 0
  buffer_load_dwordx4 v28, s[48:51], s9 offen sc1 lds
  s_add_u32 s8, s8, 128
  s_add_u32 s9, s9, 128
  s_waitcnt vmcnt(20)
  s_barrier
  s_add_u32 m0, s64, 55296
  s_nop 0
  buffer_load_dwordx4 v24, s[44:47], s8 offen lds
  s_add_u32 m0, s65, 55296
  s_nop 0
  buffer_load_dwordx4 v25, s[44:47], s8 offen lds
  s_cmp_ge_u32 s74, 2
  s_cbranch_scc1 Lsk_46
  s_add_u32 m0, s66, 55296
  s_nop 0
  buffer_load_dwordx4 v26, s[44:47], s8 offen lds
Lsk_46:
  s_add_u32 m0, s67, 55296
  s_nop 0
  buffer_load_dwordx4 v27, s[48:51], s9 offen sc1 lds
  s_add_u32 m0, s68, 55296
  s_nop 0
  buffer_load_dwordx4 v28, s[48:51], s9 offen sc1 lds
  s_add_u32 s8, s8, 128
  s_add_u32 s9, s9, 128
  s_waitcnt vmcnt(22)
  s_barrier
  s_waitcnt vmcnt(20)
  s_barrier
  s_waitcnt vmcnt(16)
  s_barrier
  s_waitcnt vmcnt(12)
  s_barrier
  s_waitcnt vmcnt(8)
  s_barrier
  s_waitcnt vmcnt(4)
  s_barrier
  s_waitcnt vmcnt(0)
  s_barrier
Ljn_41:
  s_waitcnt vmcnt(0)
  s_barrier
  s_cmp_lg_u32 s75, 0
  s_cbranch_scc1 Loc_47
  s_nop 4
  v_cvt_pk_bf16_f32 v136, v136, v137
  v_cvt_pk_bf16_f32 v137, v138, v139
  ds_write_b64 v20, v[136:137] offset:0
  v_cvt_pk_bf16_f32 v140, v140, v141
  v_cvt_pk_bf16_f32 v141, v142, v143
  ds_write_b64 v20, v[140:141] offset:32
  v_cvt_pk_bf16_f32 v144, v144, v145
  v_cvt_pk_bf16_f32 v145, v146, v147
  ds_write_b64 v20, v[144:145] offset:64
  v_cvt_pk_bf16_f32 v148, v148, v149
  v_cvt_pk_bf16_f32 v149, v150, v151
  ds_write_b64 v20, v[148:149] offset:96
  v_cvt_pk_bf16_f32 v152, v152, v153
  v_cvt_pk_bf16_f32 v153, v154, v155
  ds_write_b64 v20, v[152:153] offset:128
  s_waitcnt lgkmcnt(0)
Loc_47:
  s_barrier
  ds_read_b128 v[168:171], v156
  ds_read_b128 v[172:175], v157
  s_waitcnt lgkmcnt(1)
  v_lshlrev_b32 v40, 16, v168
  v_and_b32 v41, 0xffff0000, v168
  v_lshlrev_b32 v42, 16, v160
  v_and_b32 v43, 0xffff0000, v160
  v_pk_add_f32 v[40:41], v[40:41], v[42:43]
  v_cvt_pk_bf16_f32 v168, v40, v41
  v_lshlrev_b32 v44, 16, v169
  v_and_b32 v45, 0xffff0000, v169
  v_lshlrev_b32 v46, 16, v161
  v_and_b32 v47, 0xffff0000, v161
  v_pk_add_f32 v[44:45], v[44:45], v[46:47]
  v_cvt_pk_bf16_f32 v169, v44, v45
  v_lshlrev_b32 v40, 16, v170
  v_and_b32 v41, 0xffff0000, v170
  v_lshlrev_b32 v42, 16, v162
  v_and_b32 v43, 0xffff0000, v162
  v_pk_add_f32 v[40:41], v[40:41], v[42:43]
  v_cvt_pk_bf16_f32 v170, v40, v41
  v_lshlrev_b32 v44, 16, v171
  v_and_b32 v45, 0xffff0000, v171
  v_lshlrev_b32 v46, 16, v163
  v_and_b32 v47, 0xffff0000, v163
  v_pk_add_f32 v[44:45], v[44:45], v[46:47]
  v_cvt_pk_bf16_f32 v171, v44, v45
  buffer_store_dwordx4 v[168:171], v158, s[52:55], s15 offen sc1
  s_waitcnt lgkmcnt(0)
  v_lshlrev_b32 v40, 16, v172
  v_and_b32 v41, 0xffff0000, v172
  v_lshlrev_b32 v42, 16, v164
  v_and_b32 v43, 0xffff0000, v164
  v_pk_add_f32 v[40:41], v[40:41], v[42:43]
  v_cvt_pk_bf16_f32 v172, v40, v41
  v_lshlrev_b32 v44, 16, v173
  v_and_b32 v45, 0xffff0000, v173
  v_lshlrev_b32 v46, 16, v165
  v_and_b32 v47, 0xffff0000, v165
  v_pk_add_f32 v[44:45], v[44:45], v[46:47]
  v_cvt_pk_bf16_f32 v173, v44, v45
  v_lshlrev_b32 v40, 16, v174
  v_and_b32 v41, 0xffff0000, v174
  v_lshlrev_b32 v42, 16, v166
  v_and_b32 v43, 0xffff0000, v166
  v_pk_add_f32 v[40:41], v[40:41], v[42:43]
  v_cvt_pk_bf16_f32 v174, v40, v41
  v_lshlrev_b32 v44, 16, v175
  v_and_b32 v45, 0xffff0000, v175
  v_lshlrev_b32 v46, 16, v167
  v_and_b32 v47, 0xffff0000, v167
  v_pk_add_f32 v[44:45], v[44:45], v[46:47]
  v_cvt_pk_bf16_f32 v175, v44, v45
  buffer_store_dwordx4 v[172:175], v159, s[52:55], s15 offen sc1
  s_cmp_lg_u32 s101, 0
  s_cbranch_scc1 Lbody_end
  s_add_u32 s56, s42, 9437184
  s_addc_u32 s57, s43, 0
  s_mov_b32 s58, 2621440
  s_mov_b32 s59, 0x20000
  s_lshl_b32 s10, s4, 3
  s_add_u32 s10, s10, s7
  s_add_u32 s10, s10, s3
  s_mul_i32 s15, s10, 1280
  v_lshlrev_b32 v21, 2, v0
  buffer_load_dword v30, v21, s[56:59], s15 offen offset:0
  buffer_load_dword v31, v21, s[56:59], s15 offen offset:256
  buffer_load_dword v32, v21, s[56:59], s15 offen offset:512
  buffer_load_dword v33, v21, s[56:59], s15 offen offset:768
  buffer_load_dword v34, v21, s[56:59], s15 offen offset:1024
  s_waitcnt vmcnt(5)
  s_barrier
  s_cmp_lg_u32 s3, 0
  s_cbranch_scc1 Lsg_48
  v_mov_b32 v6, 0
  v_mov_b32 v7, 1
  s_mov_b64 s[88:89], exec
  s_mov_b64 exec, 1
  buffer_atomic_add v7, v6, s[84:87], s93 offen sc1
  s_mov_b64 exec, s[88:89]
Lsg_48:
  s_cmp_lg_u32 s3, 0
  s_cbranch_scc1 Lsw_49
  v_mov_b32 v6, 0
  s_setprio 3
Lsp_50:
  buffer_load_dword v7, v6, s[84:87], s93 offen sc1
  s_waitcnt vmcnt(0)
  v_cmp_gt_u32 vcc, 8, v7
  s_cbranch_vccnz Lsp_50
  s_setprio 0
Lsw_49:
  s_barrier
  buffer_load_dword v24, v21, s[52:55], s15 offen offset:0 sc1
  buffer_load_dword v25, v21, s[52:55], s15 offen offset:256 sc1
  buffer_load_dword v26, v21, s[52:55], s15 offen offset:512 sc1
  buffer_load_dword v27, v21, s[52:55], s15 offen offset:768 sc1
  buffer_load_dword v28, v21, s[52:55], s15 offen offset:1024 sc1
  s_add_u32 s52, s42, 15728640
  s_addc_u32 s53, s43, 0
  s_mov_b32 s54, 2621440
  s_mov_b32 s55, 0x20000
  s_waitcnt vmcnt(0)
  v_lshlrev_b32 v48, 16, v24
  v_and_b32 v49, 0xffff0000, v24
  v_lshlrev_b32 v50, 16, v25
  v_and_b32 v51, 0xffff0000, v25
  v_lshlrev_b32 v52, 16, v26
  v_and_b32 v53, 0xffff0000, v26
  v_lshlrev_b32 v54, 16, v27
  v_and_b32 v55, 0xffff0000, v27
  v_lshlrev_b32 v56, 16, v28
  v_and_b32 v57, 0xffff0000, v28
  s_nop 0
  v_readfirstlane_b32 s72, v48
  s_nop 1
  v_subrev_f32 v80, s72, v48
  v_subrev_f32 v81, s72, v49
  v_subrev_f32 v82, s72, v50
  v_subrev_f32 v83, s72, v51
  v_subrev_f32 v84, s72, v52
  v_subrev_f32 v85, s72, v53
  v_subrev_f32 v86, s72, v54
  v_subrev_f32 v87, s72, v55
  v_subrev_f32 v88, s72, v56
  v_subrev_f32 v89, s72, v57
  v_add_f32 v72, v80, v81
  v_mul_f32 v73, v80, v80
  v_fmac_f32 v73, v81, v81
  v_add_f32 v72, v72, v82
  v_fmac_f32 v73, v82, v82
  v_add_f32 v72, v72, v83
  v_fmac_f32 v73, v83, v83
  v_add_f32 v72, v72, v84
  v_fmac_f32 v73, v84, v84
  v_add_f32 v72, v72, v85
  v_fmac_f32 v73, v85, v85
  v_add_f32 v72, v72, v86
  v_fmac_f32 v73, v86, v86
  v_add_f32 v72, v72, v87
  v_fmac_f32 v73, v87, v87
  v_add_f32 v72, v72, v88
  v_fmac_f32 v73, v88, v88
  v_add_f32 v72, v72, v89
  v_fmac_f32 v73, v89, v89
  s_nop 1
  v_add_f32_dpp v72, v72, v72 row_ror:8 row_mask:0xf bank_mask:0xf
  v_add_f32_dpp v73, v73, v73 row_ror:8 row_mask:0xf bank_mask:0xf
  s_nop 1
  v_add_f32_dpp v72, v72, v72 row_ror:4 row_mask:0xf bank_mask:0xf
  v_add_f32_dpp v73, v73, v73 row_ror:4 row_mask:0xf bank_mask:0xf
  s_nop 1
  v_add_f32_dpp v72, v72, v72 row_ror:2 row_mask:0xf bank_mask:0xf
  v_add_f32_dpp v73, v73, v73 row_ror:2 row_mask:0xf bank_mask:0xf
  s_nop 1
  v_add_f32_dpp v72, v72, v72 row_ror:1 row_mask:0xf bank_mask:0xf
  v_add_f32_dpp v73, v73, v73 row_ror:1 row_mask:0xf bank_mask:0xf
  s_nop 0
  v_readlane_b32 s64, v72, 0
  v_readlane_b32 s65, v72, 16
  v_readlane_b32 s66, v72, 32
  v_readlane_b32 s67, v72, 48
  v_readlane_b32 s68, v73, 0
  v_readlane_b32 s69, v73, 16
  v_readlane_b32 s70, v73, 32
  v_readlane_b32 s71, v73, 48
  v_mov_b32 v72, s64
  v_add_f32 v72, s65, v72
  v_add_f32 v72, s66, v72
  v_add_f32 v72, s67, v72
  v_mov_b32 v73, s68
  v_add_f32 v73, s69, v73
  v_add_f32 v73, s70, v73
  v_add_f32 v73, s71, v73
  v_mul_f32 v72, 0x3acccccd, v72
  v_mul_f32 v73, 0x3acccccd, v73
  v_fma_f32 v73, -v72, v72, v73
  v_max_f32 v73, 0, v73
  v_add_f32 v74, s72, v72
  v_cvt_pk_bf16_f32 v76, v74, v73
  v_lshlrev_b32 v74, 16, v76
  v_and_b32 v73, 0xffff0000, v76
  v_add_f32 v73, 0x3727c5ac, v73
  v_cvt_pk_bf16_f32 v76, v73, v73
  v_lshlrev_b32 v73, 16, v76
  v_sqrt_f32 v73, v73
  s_nop 0
  v_cvt_pk_bf16_f32 v76, v73, v73
  v_lshlrev_b32 v73, 16, v76
  v_rcp_f32 v75, v73
  v_sub_f32 v60, v48, v74
  v_sub_f32 v61, v49, v74
  v_sub_f32 v62, v50, v74
  v_sub_f32 v63, v51, v74
  v_sub_f32 v64, v52, v74
  v_sub_f32 v65, v53, v74
  v_sub_f32 v66, v54, v74
  v_sub_f32 v67, v55, v74
  v_sub_f32 v68, v56, v74
  v_sub_f32 v69, v57, v74
  v_cvt_pk_bf16_f32 v76, v60, v61
  v_lshlrev_b32 v60, 16, v76
  v_and_b32 v61, 0xffff0000, v76
  v_cvt_pk_bf16_f32 v77, v62, v63
  v_lshlrev_b32 v62, 16, v77
  v_and_b32 v63, 0xffff0000, v77
  v_cvt_pk_bf16_f32 v76, v64, v65
  v_lshlrev_b32 v64, 16, v76
  v_and_b32 v65, 0xffff0000, v76
  v_cvt_pk_bf16_f32 v77, v66, v67
  v_lshlrev_b32 v66, 16, v77
  v_and_b32 v67, 0xffff0000, v77
  v_cvt_pk_bf16_f32 v76, v68, v69
  v_lshlrev_b32 v68, 16, v76
  v_and_b32 v69, 0xffff0000, v76
  v_mul_f32 v60, v60, v75
  v_mul_f32 v61, v61, v75
  v_mul_f32 v62, v62, v75
  v_mul_f32 v63, v63, v75
  v_mul_f32 v64, v64, v75
  v_mul_f32 v65, v65, v75
  v_mul_f32 v66, v66, v75
  v_mul_f32 v67, v67, v75
  v_mul_f32 v68, v68, v75
  v_mul_f32 v69, v69, v75
  v_cvt_pk_bf16_f32 v76, v60, v61
  v_lshlrev_b32 v60, 16, v76
  v_and_b32 v61, 0xffff0000, v76
  v_cvt_pk_bf16_f32 v77, v62, v63
  v_lshlrev_b32 v62, 16, v77
  v_and_b32 v63, 0xffff0000, v77
  v_cvt_pk_bf16_f32 v76, v64, v65
  v_lshlrev_b32 v64, 16, v76
  v_and_b32 v65, 0xffff0000, v76
  v_cvt_pk_bf16_f32 v77, v66, v67
  v_lshlrev_b32 v66, 16, v77
  v_and_b32 v67, 0xffff0000, v77
  v_cvt_pk_bf16_f32 v76, v68, v69
  v_lshlrev_b32 v68, 16, v76
  v_and_b32 v69, 0xffff0000, v76
  v_lshlrev_b32 v72, 16, v30
  v_and_b32 v73, 0xffff0000, v30
  v_lshlrev_b32 v74, 16, v31
  v_and_b32 v75, 0xffff0000, v31
  v_lshlrev_b32 v76, 16, v32
  v_and_b32 v77, 0xffff0000, v32
  v_lshlrev_b32 v78, 16, v33
  v_and_b32 v79, 0xffff0000, v33
  v_lshlrev_b32 v80, 16, v34
  v_and_b32 v81, 0xffff0000, v34
  v_pk_mul_f32 v[60:61], v[60:61], v[72:73]
  v_pk_mul_f32 v[62:63], v[62:63], v[74:75]
  v_pk_mul_f32 v[64:65], v[64:65], v[76:77]
  v_pk_mul_f32 v[66:67], v[66:67], v[78:79]
  v_pk_mul_f32 v[68:69], v[68:69], v[80:81]
  v_cvt_pk_bf16_f32 v82, v60, v61
  v_lshlrev_b32 v60, 16, v82
  v_and_b32 v61, 0xffff0000, v82
  v_cvt_pk_bf16_f32 v83, v62, v63
  v_lshlrev_b32 v62, 16, v83
  v_and_b32 v63, 0xffff0000, v83
  v_cvt_pk_bf16_f32 v82, v64, v65
  v_lshlrev_b32 v64, 16, v82
  v_and_b32 v65, 0xffff0000, v82
  v_cvt_pk_bf16_f32 v83, v66, v67
  v_lshlrev_b32 v66, 16, v83
  v_and_b32 v67, 0xffff0000, v83
  v_cvt_pk_bf16_f32 v82, v68, v69
  v_lshlrev_b32 v68, 16, v82
  v_and_b32 v69, 0xffff0000, v82
  v_pk_add_f32 v[48:49], v[48:49], v[60:61]
  v_pk_add_f32 v[50:51], v[50:51], v[62:63]
  v_pk_add_f32 v[52:53], v[52:53], v[64:65]
  v_pk_add_f32 v[54:55], v[54:55], v[66:67]
  v_pk_add_f32 v[56:57], v[56:57], v[68:69]
  v_cvt_pk_bf16_f32 v24, v48, v49
  v_lshlrev_b32 v48, 16, v24
  v_and_b32 v49, 0xffff0000, v24
  buffer_store_dword v24, v21, s[60:63], s15 offen offset:0
  v_cvt_pk_bf16_f32 v25, v50, v51
  v_lshlrev_b32 v50, 16, v25
  v_and_b32 v51, 0xffff0000, v25
  buffer_store_dword v25, v21, s[60:63], s15 offen offset:256
  v_cvt_pk_bf16_f32 v26, v52, v53
  v_lshlrev_b32 v52, 16, v26
  v_and_b32 v53, 0xffff0000, v26
  buffer_store_dword v26, v21, s[60:63], s15 offen offset:512
  v_cvt_pk_bf16_f32 v27, v54, v55
  v_lshlrev_b32 v54, 16, v27
  v_and_b32 v55, 0xffff0000, v27
  buffer_store_dword v27, v21, s[60:63], s15 offen offset:768
  v_cvt_pk_bf16_f32 v28, v56, v57
  v_lshlrev_b32 v56, 16, v28
  v_and_b32 v57, 0xffff0000, v28
  buffer_store_dword v28, v21, s[60:63], s15 offen offset:1024
  s_nop 0
  v_readfirstlane_b32 s72, v48
  s_nop 1
  v_subrev_f32 v80, s72, v48
  v_subrev_f32 v81, s72, v49
  v_subrev_f32 v82, s72, v50
  v_subrev_f32 v83, s72, v51
  v_subrev_f32 v84, s72, v52
  v_subrev_f32 v85, s72, v53
  v_subrev_f32 v86, s72, v54
  v_subrev_f32 v87, s72, v55
  v_subrev_f32 v88, s72, v56
  v_subrev_f32 v89, s72, v57
  v_add_f32 v72, v80, v81
  v_mul_f32 v73, v80, v80
  v_fmac_f32 v73, v81, v81
  v_add_f32 v72, v72, v82
  v_fmac_f32 v73, v82, v82
  v_add_f32 v72, v72, v83
  v_fmac_f32 v73, v83, v83
  v_add_f32 v72, v72, v84
  v_fmac_f32 v73, v84, v84
  v_add_f32 v72, v72, v85
  v_fmac_f32 v73, v85, v85
  v_add_f32 v72, v72, v86
  v_fmac_f32 v73, v86, v86
  v_add_f32 v72, v72, v87
  v_fmac_f32 v73, v87, v87
  v_add_f32 v72, v72, v88
  v_fmac_f32 v73, v88, v88
  v_add_f32 v72, v72, v89
  v_fmac_f32 v73, v89, v89
  s_nop 1
  v_add_f32_dpp v72, v72, v72 row_ror:8 row_mask:0xf bank_mask:0xf
  v_add_f32_dpp v73, v73, v73 row_ror:8 row_mask:0xf bank_mask:0xf
  s_nop 1
  v_add_f32_dpp v72, v72, v72 row_ror:4 row_mask:0xf bank_mask:0xf
  v_add_f32_dpp v73, v73, v73 row_ror:4 row_mask:0xf bank_mask:0xf
  s_nop 1
  v_add_f32_dpp v72, v72, v72 row_ror:2 row_mask:0xf bank_mask:0xf
  v_add_f32_dpp v73, v73, v73 row_ror:2 row_mask:0xf bank_mask:0xf
  s_nop 1
  v_add_f32_dpp v72, v72, v72 row_ror:1 row_mask:0xf bank_mask:0xf
  v_add_f32_dpp v73, v73, v73 row_ror:1 row_mask:0xf bank_mask:0xf
  s_nop 0
  v_readlane_b32 s64, v72, 0
  v_readlane_b32 s65, v72, 16
  v_readlane_b32 s66, v72, 32
  v_readlane_b32 s67, v72, 48
  v_readlane_b32 s68, v73, 0
  v_readlane_b32 s69, v73, 16
  v_readlane_b32 s70, v73, 32
  v_readlane_b32 s71, v73, 48
  v_mov_b32 v72, s64
  v_add_f32 v72, s65, v72
  v_add_f32 v72, s66, v72
  v_add_f32 v72, s67, v72
  v_mov_b32 v73, s68
  v_add_f32 v73, s69, v73
  v_add_f32 v73, s70, v73
  v_add_f32 v73, s71, v73
  v_mul_f32 v72, 0x3acccccd, v72
  v_mul_f32 v73, 0x3acccccd, v73
  v_fma_f32 v73, -v72, v72, v73
  v_max_f32 v73, 0, v73
  v_add_f32 v74, s72, v72
  v_cvt_pk_bf16_f32 v76, v74, v73
  v_lshlrev_b32 v74, 16, v76
  v_and_b32 v73, 0xffff0000, v76
  v_add_f32 v73, 0x3727c5ac, v73
  v_cvt_pk_bf16_f32 v76, v73, v73
  v_lshlrev_b32 v73, 16, v76
  v_sqrt_f32 v73, v73
  s_nop 0
  v_cvt_pk_bf16_f32 v76, v73, v73
  v_lshlrev_b32 v73, 16, v76
  v_rcp_f32 v75, v73
  v_sub_f32 v60, v48, v74
  v_sub_f32 v61, v49, v74
  v_sub_f32 v62, v50, v74
  v_sub_f32 v63, v51, v74
  v_sub_f32 v64, v52, v74
  v_sub_f32 v65, v53, v74
  v_sub_f32 v66, v54, v74
  v_sub_f32 v67, v55, v74
  v_sub_f32 v68, v56, v74
  v_sub_f32 v69, v57, v74
  v_cvt_pk_bf16_f32 v76, v60, v61
  v_lshlrev_b32 v60, 16, v76
  v_and_b32 v61, 0xffff0000, v76
  v_cvt_pk_bf16_f32 v77, v62, v63
  v_lshlrev_b32 v62, 16, v77
  v_and_b32 v63, 0xffff0000, v77
  v_cvt_pk_bf16_f32 v76, v64, v65
  v_lshlrev_b32 v64, 16, v76
  v_and_b32 v65, 0xffff0000, v76
  v_cvt_pk_bf16_f32 v77, v66, v67
  v_lshlrev_b32 v66, 16, v77
  v_and_b32 v67, 0xffff0000, v77
  v_cvt_pk_bf16_f32 v76, v68, v69
  v_lshlrev_b32 v68, 16, v76
  v_and_b32 v69, 0xffff0000, v76
  v_mul_f32 v60, v60, v75
  v_mul_f32 v61, v61, v75
  v_mul_f32 v62, v62, v75
  v_mul_f32 v63, v63, v75
  v_mul_f32 v64, v64, v75
  v_mul_f32 v65, v65, v75
  v_mul_f32 v66, v66, v75
  v_mul_f32 v67, v67, v75
  v_mul_f32 v68, v68, v75
  v_mul_f32 v69, v69, v75
  v_cvt_pk_bf16_f32 v76, v60, v61
  v_lshlrev_b32 v60, 16, v76
  v_and_b32 v61, 0xffff0000, v76
  v_cvt_pk_bf16_f32 v77, v62, v63
  v_lshlrev_b32 v62, 16, v77
  v_and_b32 v63, 0xffff0000, v77
  v_cvt_pk_bf16_f32 v76, v64, v65
  v_lshlrev_b32 v64, 16, v76
  v_and_b32 v65, 0xffff0000, v76
  v_cvt_pk_bf16_f32 v77, v66, v67
  v_lshlrev_b32 v66, 16, v77
  v_and_b32 v67, 0xffff0000, v77
  v_cvt_pk_bf16_f32 v76, v68, v69
  v_lshlrev_b32 v68, 16, v76
  v_and_b32 v69, 0xffff0000, v76
  v_cvt_pk_bf16_f32 v30, v60, v61
  buffer_store_dword v30, v21, s[52:55], s15 offen offset:0 sc1
  v_cvt_pk_bf16_f32 v31, v62, v63
  buffer_store_dword v31, v21, s[52:55], s15 offen offset:256 sc1
  v_cvt_pk_bf16_f32 v32, v64, v65
  buffer_store_dword v32, v21, s[52:55], s15 offen offset:512 sc1
  v_cvt_pk_bf16_f32 v33, v66, v67
  buffer_store_dword v33, v21, s[52:55], s15 offen offset:768 sc1
  v_cvt_pk_bf16_f32 v34, v68, v69
  buffer_store_dword v34, v21, s[52:55], s15 offen offset:1024 sc1
  s_waitcnt vmcnt(0)
  s_barrier
  s_cmp_lg_u32 s3, 0
  s_cbranch_scc1 Lsg_51
  v_mov_b32 v6, 0
  v_mov_b32 v7, 1
  s_mov_b64 s[88:89], exec
  s_mov_b64 exec, 1
  buffer_atomic_add v7, v6, s[84:87], s91 offen sc1
  s_mov_b64 exec, s[88:89]
Lsg_51:
  s_mov_b32 s101, 1
  s_branch Lbody_g1
Lbody_end:
  s_endpgm
.section .rodata,"a"
.p2align 6
.amdhsa_kernel prep_kernel
  .amdhsa_next_free_vgpr 96
  .amdhsa_next_free_sgpr 72
  .amdhsa_accum_offset 96
  .amdhsa_group_segment_fixed_size 0
  .amdhsa_kernarg_size 112
  .amdhsa_user_sgpr_count 2
  .amdhsa_user_sgpr_kernarg_segment_ptr 1
  .amdhsa_system_sgpr_workgroup_id_x 1
.end_amdhsa_kernel
.p2align 6
.amdhsa_kernel conv_kernel
  .amdhsa_next_free_vgpr 184
  .amdhsa_next_free_sgpr 72
  .amdhsa_accum_offset 184
  .amdhsa_group_segment_fixed_size 0
  .amdhsa_kernarg_size 112
  .amdhsa_user_sgpr_count 2
  .amdhsa_user_sgpr_kernarg_segment_ptr 1
  .amdhsa_system_sgpr_workgroup_id_x 1
.end_amdhsa_kernel
.p2align 6
.amdhsa_kernel g1f0_kernel
  .amdhsa_next_free_vgpr 256
  .amdhsa_next_free_sgpr 102
  .amdhsa_accum_offset 256
  .amdhsa_group_segment_fixed_size 0
  .amdhsa_kernarg_size 112
  .amdhsa_user_sgpr_count 2
  .amdhsa_user_sgpr_kernarg_segment_ptr 1
  .amdhsa_system_sgpr_workgroup_id_x 1
.end_amdhsa_kernel
.p2align 6
.amdhsa_kernel mid_kernel
  .amdhsa_next_free_vgpr 256
  .amdhsa_next_free_sgpr 102
  .amdhsa_accum_offset 256
  .amdhsa_group_segment_fixed_size 0
  .amdhsa_kernarg_size 112
  .amdhsa_user_sgpr_count 2
  .amdhsa_user_sgpr_kernarg_segment_ptr 1
  .amdhsa_system_sgpr_workgroup_id_x 1
.end_amdhsa_kernel
.p2align 6
.amdhsa_kernel last_kernel
  .amdhsa_next_free_vgpr 256
  .amdhsa_next_free_sgpr 102
  .amdhsa_accum_offset 256
  .amdhsa_group_segment_fixed_size 0
  .amdhsa_kernarg_size 112
  .amdhsa_user_sgpr_count 2
  .amdhsa_user_sgpr_kernarg_segment_ptr 1
  .amdhsa_system_sgpr_workgroup_id_x 1
.end_amdhsa_kernel
```
